```python
import torch

def _softmax(x, axis=-1):
    return torch.softmax(x, dim=axis)
def _gelu(x):
    return torch.nn.functional.gelu(x, approximate="tanh")
def _silu(x):
    return torch.nn.functional.silu(x)
def _sigmoid(x):
    return torch.sigmoid(x)
def _layernorm(x, axis=-1, eps=1e-5):
    m = x.mean(dim=axis, keepdim=True)
    v = x.var(dim=axis, keepdim=True, unbiased=False)
    return (x - m) / torch.sqrt(v + eps)
def _scatter_add(tgt, idx, src, axis=0):
    return tgt.clone().index_add_(axis, idx, src)
def _segment_sum(src, seg, n):
    out = torch.zeros((n,) + src.shape[1:], dtype=src.dtype)
    return out.index_add_(0, seg, src)
def _pad(x, pw):
    flat = tuple(v for pair in reversed(pw) for v in pair)
    return torch.nn.functional.pad(x, flat)

kernel_name = 'concat_heads__ssm_conv_h3__linear_kernel_hedgehog__prompt'

def setup_inputs():

    _w = (lambda a: (lambda t: t.to(torch.bfloat16) if t.is_floating_point() else t)(torch.as_tensor(a)))
    def _A_setup():
        B, S, D = 1, 2048, 1024
        ks = 4
        return {
            "q": _w((lambda *s: torch.randn(*s, dtype=torch.bfloat16) * 0.05)(B, S, D)),
            "k": _w((lambda *s: torch.randn(*s, dtype=torch.bfloat16) * 0.8)(B, S, D)),
            "v": _w((lambda *s: torch.randn(*s, dtype=torch.bfloat16) * 0.8)(B, S, D)),
            "shift_k": _w((lambda *s: torch.randn(*s, dtype=torch.bfloat16) * 0.8)(D, ks) * 0.5),
            "ssm_k": _w((lambda *s: torch.randn(*s, dtype=torch.bfloat16) * 0.8)(D, S) * (1.0 / S ** 0.5)),
            "ssm_D": _w((lambda *s: torch.randn(*s, dtype=torch.bfloat16) * 0.8)(D)),
        }
    _A_in = _A_setup()

    def _B_setup():
        B, S, D, H = 1, 2048, 1024, 32
        Dh = D // H
        return {
            "x": _w((lambda *s: torch.randn(*s, dtype=torch.bfloat16) * 0.4)(B, S, D)),
            "wqkv": _w((lambda *s: torch.randn(*s, dtype=torch.bfloat16) * 0.4)(D, 3 * D)),
            "w_phi": _w((lambda *s: torch.randn(*s, dtype=torch.bfloat16) * 0.4)(H, Dh, Dh) * (Dh ** -0.5)),
            "wo": _w((lambda *s: torch.randn(*s, dtype=torch.bfloat16) * 0.05)(D, D)),
        }
    _B_in = _B_setup()

    return {
        "A_q": _A_in["q"],
        "A_k": _A_in["k"],
        "A_v": _A_in["v"],
        "A_shift_k": _A_in["shift_k"],
        "A_ssm_k": _A_in["ssm_k"],
        "A_ssm_D": _A_in["ssm_D"],
        "B_x": _B_in["x"],
        "B_wqkv": _B_in["wqkv"],
        "B_w_phi": _B_in["w_phi"],
        "B_wo": _B_in["wo"],
    }

def reference(A_q, A_k, A_v, A_shift_k, A_ssm_k, A_ssm_D, B_x, B_wqkv, B_w_phi, B_wo):
    def _A_ref(q, k, v, shift_k, ssm_k, ssm_D):
        B, S, D = q.shape
        ks = shift_k.shape[-1]
        k_pad = _pad(k, ((0, 0), (ks - 1, 0), (0, 0)))
        k_shift = torch.zeros_like(k)
        for t in range(ks):
            k_shift = k_shift + k_pad[:, t:t + S, :] * shift_k[:, ks - 1 - t][None, None, :]
        kv = k_shift * v
        L = 2 * S
        kv_pad = _pad(kv, ((0, 0), (0, S), (0, 0)))
        kf_pad = _pad(ssm_k, ((0, 0), (0, S)))
        kv_f = (lambda x, axes=(-2,-1): torch.fft.rfft2(x.float(), dim=axes))(kv_pad[:, None, :, :], axes=(1, 2))
        kf_f = (lambda x, axes=(-2,-1): torch.fft.rfft2(x.float(), dim=axes))(kf_pad[:, None, :], axes=(1, 2))
        kf_f = (lambda x, *d: x.permute(*d))(kf_f, 1, 2, 0)
        y_f = kv_f * kf_f[None, :, :, :]
        y = (lambda x, s, axes=(-2,-1): torch.fft.irfft2(x, s=s, dim=axes).to(torch.bfloat16))(y_f, (1, L), axes=(1, 2))[:, 0, :S, :]
        y = y + kv * ssm_D[None, None, :]
        return q * y

    def _B_ref(x, wqkv, w_phi, wo):
        B, S, D = x.shape
        H = 32; Dh = D // H
        qkv = (lambda x, *d: x.permute(*d))((x @ wqkv).reshape(B, S, 3, H, Dh), 2, 0, 3, 1, 4)
        q, k, v = qkv[0], qkv[1], qkv[2]
        pq = torch.einsum("bhsd,hdf->bhsf", q, w_phi)
        pk = torch.einsum("bhsd,hdf->bhsf", k, w_phi)
        phi_q = torch.concatenate([_softmax(pq, axis=-1), _softmax(-pq, axis=-1)], axis=-1)
        phi_k = torch.concatenate([_softmax(pk, axis=-1), _softmax(-pk, axis=-1)], axis=-1)
        kv = torch.einsum("bhsf,bhsd->bhfd", phi_k, v)
        z  = torch.einsum("bhsf->bhf", phi_k)
        num = torch.einsum("bhqf,bhfd->bhqd", phi_q, kv)
        den = torch.einsum("bhqf,bhf->bhq", phi_q, z)[..., None] + 1e-6
        o = num / den
        return (lambda x, *d: x.permute(*d))(o, 0, 2, 1, 3).reshape(B, S, D) @ wo

    a = _A_ref(A_q, A_k, A_v, A_shift_k, A_ssm_k, A_ssm_D)
    b = _B_ref(B_x, B_wqkv, B_w_phi, B_wo)
    return torch.concatenate([a, b], axis=-1)
```

```asm
; @launch kernel=k1_kernel grid=(256,1,1) block=(512,1,1) lds=122944
; @launch kernel=k2_kernel grid=(256,1,1) block=(512,1,1) lds=116800
; @launch kernel=k3_kernel grid=(256,1,1) block=(512,1,1) lds=98304
.amdgcn_target "amdgcn-amd-amdhsa--gfx950"
.text
.globl k1_kernel
.p2align 8
.type k1_kernel,@function
k1_kernel:
    s_cmp_ge_u32 s2, 256
    s_cbranch_scc1 K1_END
    s_load_dwordx2 s[60:61], s[0:1], 48
    s_load_dwordx2 s[62:63], s[0:1], 56
    s_load_dwordx2 s[64:65], s[0:1], 96
    s_load_dwordx2 s[66:67], s[0:1], 64
    s_load_dwordx4 s[68:71], s[0:1], 8
    s_load_dwordx2 s[72:73], s[0:1], 24
    v_and_b32 v210, 255, v0
    v_and_b32 v200, 63, v0
    v_lshrrev_b32 v201, 6, v0
    s_nop 0
    v_readfirstlane_b32 s32, v201
    s_mov_b32 s41, 1069066811
    s_and_b32 s42, s2, 7
    s_lshr_b32 s43, s2, 3
    s_and_b32 s35, s42, 1
    s_lshl_b32 s35, s35, 3
    s_and_b32 s36, s43, 7
    s_add_u32 s35, s35, s36
    s_lshr_b32 s36, s42, 1
    s_lshl_b32 s36, s36, 2
    s_lshr_b32 s43, s43, 3
    s_add_u32 s36, s36, s43
    s_and_b32 s45, s32, 3
    s_waitcnt lgkmcnt(0)
    s_mov_b32 s12, s64
    s_and_b32 s13, s65, 0xffff
    s_mov_b32 s14, 268435456
    s_mov_b32 s15, 0x00020000
    s_cmp_ge_u32 s32, 4
    s_cbranch_scc1 K1_AUX
    s_mov_b32 s16, s66
    s_and_b32 s17, s67, 0xffff
    s_mov_b32 s18, 65536
    s_mov_b32 s19, 0x00020000
    s_lshr_b32 s33, s32, 1
    s_and_b32 s34, s32, 1
    s_lshl_b32 s44, s36, 1
    s_add_u32 s44, s44, s34
    v_lshrrev_b32 v201, 4, v200
    v_lshlrev_b32 v201, 8, v201
    v_and_b32 v202, 15, v200
    v_lshlrev_b32 v202, 1, v202
    v_add_u32 v201, v201, v202
    s_lshl_b32 s42, s44, 11
    buffer_load_ushort v184, v201, s[16:19], s42 offen offset:0
    buffer_load_ushort v185, v201, s[16:19], s42 offen offset:64
    buffer_load_ushort v186, v201, s[16:19], s42 offen offset:128
    buffer_load_ushort v187, v201, s[16:19], s42 offen offset:192
    buffer_load_ushort v188, v201, s[16:19], s42 offen offset:1024
    buffer_load_ushort v189, v201, s[16:19], s42 offen offset:1088
    buffer_load_ushort v190, v201, s[16:19], s42 offen offset:1152
    buffer_load_ushort v191, v201, s[16:19], s42 offen offset:1216
    buffer_load_ushort v192, v201, s[16:19], s42 offen offset:32
    buffer_load_ushort v193, v201, s[16:19], s42 offen offset:96
    buffer_load_ushort v194, v201, s[16:19], s42 offen offset:160
    buffer_load_ushort v195, v201, s[16:19], s42 offen offset:224
    buffer_load_ushort v196, v201, s[16:19], s42 offen offset:1056
    buffer_load_ushort v197, v201, s[16:19], s42 offen offset:1120
    buffer_load_ushort v198, v201, s[16:19], s42 offen offset:1184
    buffer_load_ushort v199, v201, s[16:19], s42 offen offset:1248
    v_and_b32 v201, 15, v200
    v_lshrrev_b32 v202, 4, v200
    v_lshrrev_b32 v203, 1, v201
    v_xor_b32 v203, v203, v202
    v_lshlrev_b32 v203, 4, v203
    s_lshl_b32 s42, s33, 6
    v_add_u32 v204, s42, v201
    v_lshlrev_b32 v204, 7, v204
    v_add_u32 v212, v204, v203
    v_xor_b32 v213, 64, v212
    v_bfe_u32 v201, v200, 2, 2
    v_lshrrev_b32 v203, 1, v201
    v_and_b32 v204, 1, v202
    v_lshlrev_b32 v204, 1, v204
    v_or_b32 v203, v203, v204
    s_lshl_b32 s42, s34, 1
    v_xor_b32 v203, s42, v203
    v_lshlrev_b32 v203, 5, v203
    v_lshlrev_b32 v204, 3, v202
    v_add_u32 v204, v204, v201
    v_lshlrev_b32 v204, 7, v204
    v_add_u32 v203, v203, v204
    v_and_b32 v204, 3, v200
    v_lshlrev_b32 v204, 3, v204
    v_add_u32 v203, v203, v204
    v_add_u32 v214, 49152, v203
    v_xor_b32 v215, 32, v214
    v_add_u32 v216, 49152, v214
    v_add_u32 v217, 49152, v215
    s_mov_b32 s4, s60
    s_and_b32 s5, s61, 0xffff
    s_mov_b32 s6, 4194304
    s_mov_b32 s7, 0x00020000
    s_mov_b32 s8, s62
    s_and_b32 s9, s63, 0xffff
    s_mov_b32 s10, 6291456
    s_mov_b32 s11, 0x00020000
    v_lshlrev_b32 v218, 7, v210
    v_min_u32 v219, 191, v210
    v_lshlrev_b32 v219, 7, v219
    s_lshr_b32 s47, s2, 4
    s_load_dwordx2 s[56:57], s[0:1], 32
    s_load_dwordx2 s[58:59], s[0:1], 72
    s_load_dwordx2 s[74:75], s[0:1], 0
    s_cmp_ge_u32 s32, 2
    s_cbranch_scc1 K1_SWX
    s_and_b32 s42, s2, 1
    s_lshl_b32 s42, s42, 21
    s_lshr_b32 s43, s2, 1
    s_lshl_b32 s43, s43, 14
    s_add_u32 s42, s42, s43
    buffer_load_dword v220, v218, s[4:7], s42 offen
K1_SWX:
    s_mul_i32 s48, s2, 24576
    s_cmp_gt_u32 s47, 3
    s_cbranch_scc1 K1_SW0
    s_cmp_ge_u32 s32, 3
    s_cbranch_scc1 K1_SW0
    buffer_load_dword v220, v219, s[8:11], s48 offen
K1_SW0:
    v_mov_b32 v201, 122880
    v_mov_b32 v202, 0
    v_mov_b32 v203, 0
    ds_write_b64 v201, v[202:203]
    s_waitcnt lgkmcnt(0)
    s_barrier
    ds_read_b128 v[96:99], v212 offset:0
    ds_read_b128 v[100:103], v212 offset:2048
    ds_read_b128 v[104:107], v212 offset:4096
    ds_read_b128 v[108:111], v212 offset:6144
    ds_read_b64_tr_b16 v[112:113], v214 offset:0
    ds_read_b64_tr_b16 v[114:115], v214 offset:512
    ds_read_b64_tr_b16 v[116:117], v215 offset:0
    ds_read_b64_tr_b16 v[118:119], v215 offset:512
    ds_read_b64_tr_b16 v[120:121], v214 offset:8192
    ds_read_b64_tr_b16 v[122:123], v214 offset:8704
    ds_read_b64_tr_b16 v[124:125], v215 offset:8192
    ds_read_b64_tr_b16 v[126:127], v215 offset:8704
    ds_read_b64_tr_b16 v[128:129], v214 offset:16384
    ds_read_b64_tr_b16 v[130:131], v214 offset:16896
    ds_read_b64_tr_b16 v[132:133], v215 offset:16384
    ds_read_b64_tr_b16 v[134:135], v215 offset:16896
    s_waitcnt lgkmcnt(0)
    s_cmp_lg_u32 s47, 4
    s_cbranch_scc1 K1_SW1
    s_cmp_ge_u32 s32, 3
    s_cbranch_scc1 K1_SW1
    buffer_load_dword v220, v219, s[8:11], s48 offen
K1_SW1:
    v_mfma_f32_16x16x32_bf16 v[0:3], v[112:115], v[96:99], 0
    ds_read_b128 v[136:139], v213 offset:0
    ds_read_b128 v[140:143], v213 offset:2048
    ds_read_b128 v[144:147], v213 offset:4096
    ds_read_b128 v[148:151], v213 offset:6144
    ds_read_b64_tr_b16 v[152:153], v214 offset:4096
    v_mfma_f32_16x16x32_bf16 v[4:7], v[116:119], v[96:99], 0
    ds_read_b64_tr_b16 v[154:155], v214 offset:4608
    v_mfma_f32_16x16x32_bf16 v[8:11], v[120:123], v[96:99], 0
    v_mfma_f32_16x16x32_bf16 v[12:15], v[124:127], v[96:99], 0
    ds_read_b64_tr_b16 v[156:157], v215 offset:4096
    v_mfma_f32_16x16x32_bf16 v[16:19], v[96:99], v[128:131], 0
    ds_read_b64_tr_b16 v[158:159], v215 offset:4608
    v_mfma_f32_16x16x32_bf16 v[20:23], v[96:99], v[132:135], 0
    v_mfma_f32_16x16x32_bf16 v[24:27], v[112:115], v[100:103], 0
    ds_read_b64_tr_b16 v[160:161], v214 offset:12288
    v_mfma_f32_16x16x32_bf16 v[28:31], v[116:119], v[100:103], 0
    ds_read_b64_tr_b16 v[162:163], v214 offset:12800
    v_mfma_f32_16x16x32_bf16 v[32:35], v[120:123], v[100:103], 0
    v_mfma_f32_16x16x32_bf16 v[36:39], v[124:127], v[100:103], 0
    ds_read_b64_tr_b16 v[164:165], v215 offset:12288
    v_mfma_f32_16x16x32_bf16 v[40:43], v[100:103], v[128:131], 0
    ds_read_b64_tr_b16 v[166:167], v215 offset:12800
    v_mfma_f32_16x16x32_bf16 v[44:47], v[100:103], v[132:135], 0
    v_mfma_f32_16x16x32_bf16 v[48:51], v[112:115], v[104:107], 0
    ds_read_b64_tr_b16 v[168:169], v214 offset:20480
    v_mfma_f32_16x16x32_bf16 v[52:55], v[116:119], v[104:107], 0
    ds_read_b64_tr_b16 v[170:171], v214 offset:20992
    v_mfma_f32_16x16x32_bf16 v[56:59], v[120:123], v[104:107], 0
    v_mfma_f32_16x16x32_bf16 v[60:63], v[124:127], v[104:107], 0
    ds_read_b64_tr_b16 v[172:173], v215 offset:20480
    v_mfma_f32_16x16x32_bf16 v[64:67], v[104:107], v[128:131], 0
    ds_read_b64_tr_b16 v[174:175], v215 offset:20992
    v_mfma_f32_16x16x32_bf16 v[68:71], v[104:107], v[132:135], 0
    v_mfma_f32_16x16x32_bf16 v[72:75], v[112:115], v[108:111], 0
    v_mfma_f32_16x16x32_bf16 v[76:79], v[116:119], v[108:111], 0
    v_mfma_f32_16x16x32_bf16 v[80:83], v[120:123], v[108:111], 0
    v_mfma_f32_16x16x32_bf16 v[84:87], v[124:127], v[108:111], 0
    v_mfma_f32_16x16x32_bf16 v[88:91], v[108:111], v[128:131], 0
    v_mfma_f32_16x16x32_bf16 v[92:95], v[108:111], v[132:135], 0
    s_waitcnt lgkmcnt(0)
    s_barrier
    v_mfma_f32_16x16x32_bf16 v[0:3], v[152:155], v[136:139], v[0:3]
    ds_read_b128 v[96:99], v212 offset:16384
    ds_read_b128 v[100:103], v212 offset:18432
    ds_read_b128 v[104:107], v212 offset:20480
    ds_read_b128 v[108:111], v212 offset:22528
    ds_read_b64_tr_b16 v[112:113], v214 offset:24576
    v_mfma_f32_16x16x32_bf16 v[4:7], v[156:159], v[136:139], v[4:7]
    ds_read_b64_tr_b16 v[114:115], v214 offset:25088
    v_mfma_f32_16x16x32_bf16 v[8:11], v[160:163], v[136:139], v[8:11]
    v_mfma_f32_16x16x32_bf16 v[12:15], v[164:167], v[136:139], v[12:15]
    ds_read_b64_tr_b16 v[116:117], v215 offset:24576
    v_mfma_f32_16x16x32_bf16 v[16:19], v[136:139], v[168:171], v[16:19]
    ds_read_b64_tr_b16 v[118:119], v215 offset:25088
    v_mfma_f32_16x16x32_bf16 v[20:23], v[136:139], v[172:175], v[20:23]
    v_mfma_f32_16x16x32_bf16 v[24:27], v[152:155], v[140:143], v[24:27]
    ds_read_b64_tr_b16 v[120:121], v214 offset:32768
    v_mfma_f32_16x16x32_bf16 v[28:31], v[156:159], v[140:143], v[28:31]
    ds_read_b64_tr_b16 v[122:123], v214 offset:33280
    v_mfma_f32_16x16x32_bf16 v[32:35], v[160:163], v[140:143], v[32:35]
    v_mfma_f32_16x16x32_bf16 v[36:39], v[164:167], v[140:143], v[36:39]
    ds_read_b64_tr_b16 v[124:125], v215 offset:32768
    v_mfma_f32_16x16x32_bf16 v[40:43], v[140:143], v[168:171], v[40:43]
    ds_read_b64_tr_b16 v[126:127], v215 offset:33280
    v_mfma_f32_16x16x32_bf16 v[44:47], v[140:143], v[172:175], v[44:47]
    v_mfma_f32_16x16x32_bf16 v[48:51], v[152:155], v[144:147], v[48:51]
    ds_read_b64_tr_b16 v[128:129], v214 offset:40960
    v_mfma_f32_16x16x32_bf16 v[52:55], v[156:159], v[144:147], v[52:55]
    ds_read_b64_tr_b16 v[130:131], v214 offset:41472
    v_mfma_f32_16x16x32_bf16 v[56:59], v[160:163], v[144:147], v[56:59]
    v_mfma_f32_16x16x32_bf16 v[60:63], v[164:167], v[144:147], v[60:63]
    ds_read_b64_tr_b16 v[132:133], v215 offset:40960
    v_mfma_f32_16x16x32_bf16 v[64:67], v[144:147], v[168:171], v[64:67]
    ds_read_b64_tr_b16 v[134:135], v215 offset:41472
    v_mfma_f32_16x16x32_bf16 v[68:71], v[144:147], v[172:175], v[68:71]
    v_mfma_f32_16x16x32_bf16 v[72:75], v[152:155], v[148:151], v[72:75]
    v_mfma_f32_16x16x32_bf16 v[76:79], v[156:159], v[148:151], v[76:79]
    v_mfma_f32_16x16x32_bf16 v[80:83], v[160:163], v[148:151], v[80:83]
    v_mfma_f32_16x16x32_bf16 v[84:87], v[164:167], v[148:151], v[84:87]
    v_mfma_f32_16x16x32_bf16 v[88:91], v[148:151], v[168:171], v[88:91]
    v_mfma_f32_16x16x32_bf16 v[92:95], v[148:151], v[172:175], v[92:95]
    s_waitcnt lgkmcnt(0)
    s_cmp_lg_u32 s47, 5
    s_cbranch_scc1 K1_SW2
    s_cmp_ge_u32 s32, 3
    s_cbranch_scc1 K1_SW2
    buffer_load_dword v220, v219, s[8:11], s48 offen
K1_SW2:
    v_mfma_f32_16x16x32_bf16 v[0:3], v[112:115], v[96:99], v[0:3]
    ds_read_b128 v[136:139], v213 offset:16384
    ds_read_b128 v[140:143], v213 offset:18432
    ds_read_b128 v[144:147], v213 offset:20480
    ds_read_b128 v[148:151], v213 offset:22528
    ds_read_b64_tr_b16 v[152:153], v214 offset:28672
    v_mfma_f32_16x16x32_bf16 v[4:7], v[116:119], v[96:99], v[4:7]
    ds_read_b64_tr_b16 v[154:155], v214 offset:29184
    v_mfma_f32_16x16x32_bf16 v[8:11], v[120:123], v[96:99], v[8:11]
    v_mfma_f32_16x16x32_bf16 v[12:15], v[124:127], v[96:99], v[12:15]
    ds_read_b64_tr_b16 v[156:157], v215 offset:28672
    v_mfma_f32_16x16x32_bf16 v[16:19], v[96:99], v[128:131], v[16:19]
    ds_read_b64_tr_b16 v[158:159], v215 offset:29184
    v_mfma_f32_16x16x32_bf16 v[20:23], v[96:99], v[132:135], v[20:23]
    v_mfma_f32_16x16x32_bf16 v[24:27], v[112:115], v[100:103], v[24:27]
    ds_read_b64_tr_b16 v[160:161], v214 offset:36864
    v_mfma_f32_16x16x32_bf16 v[28:31], v[116:119], v[100:103], v[28:31]
    ds_read_b64_tr_b16 v[162:163], v214 offset:37376
    v_mfma_f32_16x16x32_bf16 v[32:35], v[120:123], v[100:103], v[32:35]
    v_mfma_f32_16x16x32_bf16 v[36:39], v[124:127], v[100:103], v[36:39]
    ds_read_b64_tr_b16 v[164:165], v215 offset:36864
    v_mfma_f32_16x16x32_bf16 v[40:43], v[100:103], v[128:131], v[40:43]
    ds_read_b64_tr_b16 v[166:167], v215 offset:37376
    v_mfma_f32_16x16x32_bf16 v[44:47], v[100:103], v[132:135], v[44:47]
    v_mfma_f32_16x16x32_bf16 v[48:51], v[112:115], v[104:107], v[48:51]
    ds_read_b64_tr_b16 v[168:169], v214 offset:45056
    v_mfma_f32_16x16x32_bf16 v[52:55], v[116:119], v[104:107], v[52:55]
    ds_read_b64_tr_b16 v[170:171], v214 offset:45568
    v_mfma_f32_16x16x32_bf16 v[56:59], v[120:123], v[104:107], v[56:59]
    v_mfma_f32_16x16x32_bf16 v[60:63], v[124:127], v[104:107], v[60:63]
    ds_read_b64_tr_b16 v[172:173], v215 offset:45056
    v_mfma_f32_16x16x32_bf16 v[64:67], v[104:107], v[128:131], v[64:67]
    ds_read_b64_tr_b16 v[174:175], v215 offset:45568
    v_mfma_f32_16x16x32_bf16 v[68:71], v[104:107], v[132:135], v[68:71]
    v_mfma_f32_16x16x32_bf16 v[72:75], v[112:115], v[108:111], v[72:75]
    v_mfma_f32_16x16x32_bf16 v[76:79], v[116:119], v[108:111], v[76:79]
    v_mfma_f32_16x16x32_bf16 v[80:83], v[120:123], v[108:111], v[80:83]
    v_mfma_f32_16x16x32_bf16 v[84:87], v[124:127], v[108:111], v[84:87]
    v_mfma_f32_16x16x32_bf16 v[88:91], v[108:111], v[128:131], v[88:91]
    v_mfma_f32_16x16x32_bf16 v[92:95], v[108:111], v[132:135], v[92:95]
    s_waitcnt lgkmcnt(0)
    s_barrier
    v_mfma_f32_16x16x32_bf16 v[0:3], v[152:155], v[136:139], v[0:3]
    ds_read_b128 v[96:99], v212 offset:32768
    ds_read_b128 v[100:103], v212 offset:34816
    ds_read_b128 v[104:107], v212 offset:36864
    ds_read_b128 v[108:111], v212 offset:38912
    ds_read_b64_tr_b16 v[112:113], v216 offset:0
    v_mfma_f32_16x16x32_bf16 v[4:7], v[156:159], v[136:139], v[4:7]
    ds_read_b64_tr_b16 v[114:115], v216 offset:512
    v_mfma_f32_16x16x32_bf16 v[8:11], v[160:163], v[136:139], v[8:11]
    v_mfma_f32_16x16x32_bf16 v[12:15], v[164:167], v[136:139], v[12:15]
    ds_read_b64_tr_b16 v[116:117], v217 offset:0
    v_mfma_f32_16x16x32_bf16 v[16:19], v[136:139], v[168:171], v[16:19]
    ds_read_b64_tr_b16 v[118:119], v217 offset:512
    v_mfma_f32_16x16x32_bf16 v[20:23], v[136:139], v[172:175], v[20:23]
    v_mfma_f32_16x16x32_bf16 v[24:27], v[152:155], v[140:143], v[24:27]
    ds_read_b64_tr_b16 v[120:121], v216 offset:8192
    v_mfma_f32_16x16x32_bf16 v[28:31], v[156:159], v[140:143], v[28:31]
    ds_read_b64_tr_b16 v[122:123], v216 offset:8704
    v_mfma_f32_16x16x32_bf16 v[32:35], v[160:163], v[140:143], v[32:35]
    v_mfma_f32_16x16x32_bf16 v[36:39], v[164:167], v[140:143], v[36:39]
    ds_read_b64_tr_b16 v[124:125], v217 offset:8192
    v_mfma_f32_16x16x32_bf16 v[40:43], v[140:143], v[168:171], v[40:43]
    ds_read_b64_tr_b16 v[126:127], v217 offset:8704
    v_mfma_f32_16x16x32_bf16 v[44:47], v[140:143], v[172:175], v[44:47]
    v_mfma_f32_16x16x32_bf16 v[48:51], v[152:155], v[144:147], v[48:51]
    ds_read_b64_tr_b16 v[128:129], v216 offset:16384
    v_mfma_f32_16x16x32_bf16 v[52:55], v[156:159], v[144:147], v[52:55]
    ds_read_b64_tr_b16 v[130:131], v216 offset:16896
    v_mfma_f32_16x16x32_bf16 v[56:59], v[160:163], v[144:147], v[56:59]
    v_mfma_f32_16x16x32_bf16 v[60:63], v[164:167], v[144:147], v[60:63]
    ds_read_b64_tr_b16 v[132:133], v217 offset:16384
    v_mfma_f32_16x16x32_bf16 v[64:67], v[144:147], v[168:171], v[64:67]
    ds_read_b64_tr_b16 v[134:135], v217 offset:16896
    v_mfma_f32_16x16x32_bf16 v[68:71], v[144:147], v[172:175], v[68:71]
    v_mfma_f32_16x16x32_bf16 v[72:75], v[152:155], v[148:151], v[72:75]
    v_mfma_f32_16x16x32_bf16 v[76:79], v[156:159], v[148:151], v[76:79]
    v_mfma_f32_16x16x32_bf16 v[80:83], v[160:163], v[148:151], v[80:83]
    v_mfma_f32_16x16x32_bf16 v[84:87], v[164:167], v[148:151], v[84:87]
    v_mfma_f32_16x16x32_bf16 v[88:91], v[148:151], v[168:171], v[88:91]
    v_mfma_f32_16x16x32_bf16 v[92:95], v[148:151], v[172:175], v[92:95]
    s_waitcnt lgkmcnt(0)
    s_cmp_lg_u32 s47, 6
    s_cbranch_scc1 K1_SW3
    s_cmp_ge_u32 s32, 3
    s_cbranch_scc1 K1_SW3
    buffer_load_dword v220, v219, s[8:11], s48 offen
K1_SW3:
    v_mfma_f32_16x16x32_bf16 v[0:3], v[112:115], v[96:99], v[0:3]
    ds_read_b128 v[136:139], v213 offset:32768
    ds_read_b128 v[140:143], v213 offset:34816
    ds_read_b128 v[144:147], v213 offset:36864
    ds_read_b128 v[148:151], v213 offset:38912
    ds_read_b64_tr_b16 v[152:153], v216 offset:4096
    v_mfma_f32_16x16x32_bf16 v[4:7], v[116:119], v[96:99], v[4:7]
    ds_read_b64_tr_b16 v[154:155], v216 offset:4608
    v_mfma_f32_16x16x32_bf16 v[8:11], v[120:123], v[96:99], v[8:11]
    v_mfma_f32_16x16x32_bf16 v[12:15], v[124:127], v[96:99], v[12:15]
    ds_read_b64_tr_b16 v[156:157], v217 offset:4096
    v_mfma_f32_16x16x32_bf16 v[16:19], v[96:99], v[128:131], v[16:19]
    ds_read_b64_tr_b16 v[158:159], v217 offset:4608
    v_mfma_f32_16x16x32_bf16 v[20:23], v[96:99], v[132:135], v[20:23]
    v_mfma_f32_16x16x32_bf16 v[24:27], v[112:115], v[100:103], v[24:27]
    ds_read_b64_tr_b16 v[160:161], v216 offset:12288
    v_mfma_f32_16x16x32_bf16 v[28:31], v[116:119], v[100:103], v[28:31]
    ds_read_b64_tr_b16 v[162:163], v216 offset:12800
    v_mfma_f32_16x16x32_bf16 v[32:35], v[120:123], v[100:103], v[32:35]
    v_mfma_f32_16x16x32_bf16 v[36:39], v[124:127], v[100:103], v[36:39]
    ds_read_b64_tr_b16 v[164:165], v217 offset:12288
    v_mfma_f32_16x16x32_bf16 v[40:43], v[100:103], v[128:131], v[40:43]
    ds_read_b64_tr_b16 v[166:167], v217 offset:12800
    v_mfma_f32_16x16x32_bf16 v[44:47], v[100:103], v[132:135], v[44:47]
    v_mfma_f32_16x16x32_bf16 v[48:51], v[112:115], v[104:107], v[48:51]
    ds_read_b64_tr_b16 v[168:169], v216 offset:20480
    v_mfma_f32_16x16x32_bf16 v[52:55], v[116:119], v[104:107], v[52:55]
    ds_read_b64_tr_b16 v[170:171], v216 offset:20992
    v_mfma_f32_16x16x32_bf16 v[56:59], v[120:123], v[104:107], v[56:59]
    v_mfma_f32_16x16x32_bf16 v[60:63], v[124:127], v[104:107], v[60:63]
    ds_read_b64_tr_b16 v[172:173], v217 offset:20480
    v_mfma_f32_16x16x32_bf16 v[64:67], v[104:107], v[128:131], v[64:67]
    ds_read_b64_tr_b16 v[174:175], v217 offset:20992
    v_mfma_f32_16x16x32_bf16 v[68:71], v[104:107], v[132:135], v[68:71]
    v_mfma_f32_16x16x32_bf16 v[72:75], v[112:115], v[108:111], v[72:75]
    v_mfma_f32_16x16x32_bf16 v[76:79], v[116:119], v[108:111], v[76:79]
    v_mfma_f32_16x16x32_bf16 v[80:83], v[120:123], v[108:111], v[80:83]
    v_mfma_f32_16x16x32_bf16 v[84:87], v[124:127], v[108:111], v[84:87]
    v_mfma_f32_16x16x32_bf16 v[88:91], v[108:111], v[128:131], v[88:91]
    v_mfma_f32_16x16x32_bf16 v[92:95], v[108:111], v[132:135], v[92:95]
    s_waitcnt lgkmcnt(0)
    s_barrier
    v_mfma_f32_16x16x32_bf16 v[0:3], v[152:155], v[136:139], v[0:3]
    ds_read_b128 v[96:99], v212 offset:0
    ds_read_b128 v[100:103], v212 offset:2048
    ds_read_b128 v[104:107], v212 offset:4096
    ds_read_b128 v[108:111], v212 offset:6144
    ds_read_b64_tr_b16 v[112:113], v214 offset:0
    v_mfma_f32_16x16x32_bf16 v[4:7], v[156:159], v[136:139], v[4:7]
    ds_read_b64_tr_b16 v[114:115], v214 offset:512
    v_mfma_f32_16x16x32_bf16 v[8:11], v[160:163], v[136:139], v[8:11]
    v_mfma_f32_16x16x32_bf16 v[12:15], v[164:167], v[136:139], v[12:15]
    ds_read_b64_tr_b16 v[116:117], v215 offset:0
    v_mfma_f32_16x16x32_bf16 v[16:19], v[136:139], v[168:171], v[16:19]
    ds_read_b64_tr_b16 v[118:119], v215 offset:512
    v_mfma_f32_16x16x32_bf16 v[20:23], v[136:139], v[172:175], v[20:23]
    v_mfma_f32_16x16x32_bf16 v[24:27], v[152:155], v[140:143], v[24:27]
    ds_read_b64_tr_b16 v[120:121], v214 offset:8192
    v_mfma_f32_16x16x32_bf16 v[28:31], v[156:159], v[140:143], v[28:31]
    ds_read_b64_tr_b16 v[122:123], v214 offset:8704
    v_mfma_f32_16x16x32_bf16 v[32:35], v[160:163], v[140:143], v[32:35]
    v_mfma_f32_16x16x32_bf16 v[36:39], v[164:167], v[140:143], v[36:39]
    ds_read_b64_tr_b16 v[124:125], v215 offset:8192
    v_mfma_f32_16x16x32_bf16 v[40:43], v[140:143], v[168:171], v[40:43]
    ds_read_b64_tr_b16 v[126:127], v215 offset:8704
    v_mfma_f32_16x16x32_bf16 v[44:47], v[140:143], v[172:175], v[44:47]
    v_mfma_f32_16x16x32_bf16 v[48:51], v[152:155], v[144:147], v[48:51]
    ds_read_b64_tr_b16 v[128:129], v214 offset:16384
    v_mfma_f32_16x16x32_bf16 v[52:55], v[156:159], v[144:147], v[52:55]
    ds_read_b64_tr_b16 v[130:131], v214 offset:16896
    v_mfma_f32_16x16x32_bf16 v[56:59], v[160:163], v[144:147], v[56:59]
    v_mfma_f32_16x16x32_bf16 v[60:63], v[164:167], v[144:147], v[60:63]
    ds_read_b64_tr_b16 v[132:133], v215 offset:16384
    v_mfma_f32_16x16x32_bf16 v[64:67], v[144:147], v[168:171], v[64:67]
    ds_read_b64_tr_b16 v[134:135], v215 offset:16896
    v_mfma_f32_16x16x32_bf16 v[68:71], v[144:147], v[172:175], v[68:71]
    v_mfma_f32_16x16x32_bf16 v[72:75], v[152:155], v[148:151], v[72:75]
    v_mfma_f32_16x16x32_bf16 v[76:79], v[156:159], v[148:151], v[76:79]
    v_mfma_f32_16x16x32_bf16 v[80:83], v[160:163], v[148:151], v[80:83]
    v_mfma_f32_16x16x32_bf16 v[84:87], v[164:167], v[148:151], v[84:87]
    v_mfma_f32_16x16x32_bf16 v[88:91], v[148:151], v[168:171], v[88:91]
    v_mfma_f32_16x16x32_bf16 v[92:95], v[148:151], v[172:175], v[92:95]
    s_waitcnt lgkmcnt(0)
    s_waitcnt vmcnt(0)
    v_lshl_or_b32 v176, v185, 16, v184
    v_lshl_or_b32 v177, v187, 16, v186
    v_lshl_or_b32 v178, v189, 16, v188
    v_lshl_or_b32 v179, v191, 16, v190
    v_lshl_or_b32 v180, v193, 16, v192
    v_lshl_or_b32 v181, v195, 16, v194
    v_lshl_or_b32 v182, v197, 16, v196
    v_lshl_or_b32 v183, v199, 16, v198
    s_cmp_lg_u32 s47, 7
    s_cbranch_scc1 K1_SW4
    s_cmp_ge_u32 s32, 3
    s_cbranch_scc1 K1_SW4
    buffer_load_dword v220, v219, s[8:11], s48 offen
K1_SW4:
    v_mfma_f32_16x16x32_bf16 v[0:3], v[112:115], v[96:99], v[0:3]
    ds_read_b128 v[136:139], v213 offset:0
    ds_read_b128 v[140:143], v213 offset:2048
    ds_read_b128 v[144:147], v213 offset:4096
    ds_read_b128 v[148:151], v213 offset:6144
    ds_read_b64_tr_b16 v[152:153], v214 offset:4096
    v_mfma_f32_16x16x32_bf16 v[4:7], v[116:119], v[96:99], v[4:7]
    ds_read_b64_tr_b16 v[154:155], v214 offset:4608
    v_mfma_f32_16x16x32_bf16 v[8:11], v[120:123], v[96:99], v[8:11]
    v_mfma_f32_16x16x32_bf16 v[12:15], v[124:127], v[96:99], v[12:15]
    ds_read_b64_tr_b16 v[156:157], v215 offset:4096
    v_mfma_f32_16x16x32_bf16 v[16:19], v[96:99], v[128:131], v[16:19]
    ds_read_b64_tr_b16 v[158:159], v215 offset:4608
    v_mfma_f32_16x16x32_bf16 v[20:23], v[96:99], v[132:135], v[20:23]
    v_mfma_f32_16x16x32_bf16 v[24:27], v[112:115], v[100:103], v[24:27]
    ds_read_b64_tr_b16 v[160:161], v214 offset:12288
    v_mfma_f32_16x16x32_bf16 v[28:31], v[116:119], v[100:103], v[28:31]
    ds_read_b64_tr_b16 v[162:163], v214 offset:12800
    v_mfma_f32_16x16x32_bf16 v[32:35], v[120:123], v[100:103], v[32:35]
    v_mfma_f32_16x16x32_bf16 v[36:39], v[124:127], v[100:103], v[36:39]
    ds_read_b64_tr_b16 v[164:165], v215 offset:12288
    v_mfma_f32_16x16x32_bf16 v[40:43], v[100:103], v[128:131], v[40:43]
    ds_read_b64_tr_b16 v[166:167], v215 offset:12800
    v_mfma_f32_16x16x32_bf16 v[44:47], v[100:103], v[132:135], v[44:47]
    v_mfma_f32_16x16x32_bf16 v[48:51], v[112:115], v[104:107], v[48:51]
    ds_read_b64_tr_b16 v[168:169], v214 offset:20480
    v_mfma_f32_16x16x32_bf16 v[52:55], v[116:119], v[104:107], v[52:55]
    ds_read_b64_tr_b16 v[170:171], v214 offset:20992
    v_mfma_f32_16x16x32_bf16 v[56:59], v[120:123], v[104:107], v[56:59]
    v_mfma_f32_16x16x32_bf16 v[60:63], v[124:127], v[104:107], v[60:63]
    ds_read_b64_tr_b16 v[172:173], v215 offset:20480
    v_mfma_f32_16x16x32_bf16 v[64:67], v[104:107], v[128:131], v[64:67]
    ds_read_b64_tr_b16 v[174:175], v215 offset:20992
    v_mfma_f32_16x16x32_bf16 v[68:71], v[104:107], v[132:135], v[68:71]
    v_mfma_f32_16x16x32_bf16 v[72:75], v[112:115], v[108:111], v[72:75]
    v_mfma_f32_16x16x32_bf16 v[76:79], v[116:119], v[108:111], v[76:79]
    v_mfma_f32_16x16x32_bf16 v[80:83], v[120:123], v[108:111], v[80:83]
    v_mfma_f32_16x16x32_bf16 v[84:87], v[124:127], v[108:111], v[84:87]
    v_mfma_f32_16x16x32_bf16 v[88:91], v[108:111], v[128:131], v[88:91]
    v_mfma_f32_16x16x32_bf16 v[92:95], v[108:111], v[132:135], v[92:95]
    s_waitcnt lgkmcnt(0)
    s_barrier
    v_mfma_f32_16x16x32_bf16 v[0:3], v[152:155], v[136:139], v[0:3]
    ds_read_b128 v[96:99], v212 offset:16384
    ds_read_b128 v[100:103], v212 offset:18432
    ds_read_b128 v[104:107], v212 offset:20480
    ds_read_b128 v[108:111], v212 offset:22528
    ds_read_b64_tr_b16 v[112:113], v214 offset:24576
    v_mfma_f32_16x16x32_bf16 v[4:7], v[156:159], v[136:139], v[4:7]
    ds_read_b64_tr_b16 v[114:115], v214 offset:25088
    v_mfma_f32_16x16x32_bf16 v[8:11], v[160:163], v[136:139], v[8:11]
    v_mfma_f32_16x16x32_bf16 v[12:15], v[164:167], v[136:139], v[12:15]
    ds_read_b64_tr_b16 v[116:117], v215 offset:24576
    v_mfma_f32_16x16x32_bf16 v[16:19], v[136:139], v[168:171], v[16:19]
    ds_read_b64_tr_b16 v[118:119], v215 offset:25088
    v_mfma_f32_16x16x32_bf16 v[20:23], v[136:139], v[172:175], v[20:23]
    v_mfma_f32_16x16x32_bf16 v[24:27], v[152:155], v[140:143], v[24:27]
    ds_read_b64_tr_b16 v[120:121], v214 offset:32768
    v_mfma_f32_16x16x32_bf16 v[28:31], v[156:159], v[140:143], v[28:31]
    ds_read_b64_tr_b16 v[122:123], v214 offset:33280
    v_mfma_f32_16x16x32_bf16 v[32:35], v[160:163], v[140:143], v[32:35]
    v_mfma_f32_16x16x32_bf16 v[36:39], v[164:167], v[140:143], v[36:39]
    ds_read_b64_tr_b16 v[124:125], v215 offset:32768
    v_mfma_f32_16x16x32_bf16 v[40:43], v[140:143], v[168:171], v[40:43]
    ds_read_b64_tr_b16 v[126:127], v215 offset:33280
    v_mfma_f32_16x16x32_bf16 v[44:47], v[140:143], v[172:175], v[44:47]
    v_mfma_f32_16x16x32_bf16 v[48:51], v[152:155], v[144:147], v[48:51]
    ds_read_b64_tr_b16 v[128:129], v214 offset:40960
    v_mfma_f32_16x16x32_bf16 v[52:55], v[156:159], v[144:147], v[52:55]
    ds_read_b64_tr_b16 v[130:131], v214 offset:41472
    v_mfma_f32_16x16x32_bf16 v[56:59], v[160:163], v[144:147], v[56:59]
    v_mfma_f32_16x16x32_bf16 v[60:63], v[164:167], v[144:147], v[60:63]
    ds_read_b64_tr_b16 v[132:133], v215 offset:40960
    v_mfma_f32_16x16x32_bf16 v[64:67], v[144:147], v[168:171], v[64:67]
    ds_read_b64_tr_b16 v[134:135], v215 offset:41472
    v_mfma_f32_16x16x32_bf16 v[68:71], v[144:147], v[172:175], v[68:71]
    v_mfma_f32_16x16x32_bf16 v[72:75], v[152:155], v[148:151], v[72:75]
    v_mfma_f32_16x16x32_bf16 v[76:79], v[156:159], v[148:151], v[76:79]
    v_mfma_f32_16x16x32_bf16 v[80:83], v[160:163], v[148:151], v[80:83]
    v_mfma_f32_16x16x32_bf16 v[84:87], v[164:167], v[148:151], v[84:87]
    v_mfma_f32_16x16x32_bf16 v[88:91], v[148:151], v[168:171], v[88:91]
    v_mfma_f32_16x16x32_bf16 v[92:95], v[148:151], v[172:175], v[92:95]
    s_waitcnt lgkmcnt(0)
    s_cmp_lg_u32 s47, 8
    s_cbranch_scc1 K1_SW5
    s_cmp_ge_u32 s32, 3
    s_cbranch_scc1 K1_SW5
    buffer_load_dword v220, v219, s[8:11], s48 offen
K1_SW5:
    v_mfma_f32_16x16x32_bf16 v[0:3], v[112:115], v[96:99], v[0:3]
    ds_read_b128 v[136:139], v213 offset:16384
    ds_read_b128 v[140:143], v213 offset:18432
    ds_read_b128 v[144:147], v213 offset:20480
    ds_read_b128 v[148:151], v213 offset:22528
    ds_read_b64_tr_b16 v[152:153], v214 offset:28672
    v_mfma_f32_16x16x32_bf16 v[4:7], v[116:119], v[96:99], v[4:7]
    ds_read_b64_tr_b16 v[154:155], v214 offset:29184
    v_mfma_f32_16x16x32_bf16 v[8:11], v[120:123], v[96:99], v[8:11]
    v_mfma_f32_16x16x32_bf16 v[12:15], v[124:127], v[96:99], v[12:15]
    ds_read_b64_tr_b16 v[156:157], v215 offset:28672
    v_mfma_f32_16x16x32_bf16 v[16:19], v[96:99], v[128:131], v[16:19]
    ds_read_b64_tr_b16 v[158:159], v215 offset:29184
    v_mfma_f32_16x16x32_bf16 v[20:23], v[96:99], v[132:135], v[20:23]
    v_mfma_f32_16x16x32_bf16 v[24:27], v[112:115], v[100:103], v[24:27]
    ds_read_b64_tr_b16 v[160:161], v214 offset:36864
    v_mfma_f32_16x16x32_bf16 v[28:31], v[116:119], v[100:103], v[28:31]
    ds_read_b64_tr_b16 v[162:163], v214 offset:37376
    v_mfma_f32_16x16x32_bf16 v[32:35], v[120:123], v[100:103], v[32:35]
    v_mfma_f32_16x16x32_bf16 v[36:39], v[124:127], v[100:103], v[36:39]
    ds_read_b64_tr_b16 v[164:165], v215 offset:36864
    v_mfma_f32_16x16x32_bf16 v[40:43], v[100:103], v[128:131], v[40:43]
    ds_read_b64_tr_b16 v[166:167], v215 offset:37376
    v_mfma_f32_16x16x32_bf16 v[44:47], v[100:103], v[132:135], v[44:47]
    v_mfma_f32_16x16x32_bf16 v[48:51], v[112:115], v[104:107], v[48:51]
    ds_read_b64_tr_b16 v[168:169], v214 offset:45056
    v_mfma_f32_16x16x32_bf16 v[52:55], v[116:119], v[104:107], v[52:55]
    ds_read_b64_tr_b16 v[170:171], v214 offset:45568
    v_mfma_f32_16x16x32_bf16 v[56:59], v[120:123], v[104:107], v[56:59]
    v_mfma_f32_16x16x32_bf16 v[60:63], v[124:127], v[104:107], v[60:63]
    ds_read_b64_tr_b16 v[172:173], v215 offset:45056
    v_mfma_f32_16x16x32_bf16 v[64:67], v[104:107], v[128:131], v[64:67]
    ds_read_b64_tr_b16 v[174:175], v215 offset:45568
    v_mfma_f32_16x16x32_bf16 v[68:71], v[104:107], v[132:135], v[68:71]
    v_mfma_f32_16x16x32_bf16 v[72:75], v[112:115], v[108:111], v[72:75]
    v_mfma_f32_16x16x32_bf16 v[76:79], v[116:119], v[108:111], v[76:79]
    v_mfma_f32_16x16x32_bf16 v[80:83], v[120:123], v[108:111], v[80:83]
    v_mfma_f32_16x16x32_bf16 v[84:87], v[124:127], v[108:111], v[84:87]
    v_mfma_f32_16x16x32_bf16 v[88:91], v[108:111], v[128:131], v[88:91]
    v_mfma_f32_16x16x32_bf16 v[92:95], v[108:111], v[132:135], v[92:95]
    s_waitcnt lgkmcnt(0)
    s_barrier
    v_mfma_f32_16x16x32_bf16 v[0:3], v[152:155], v[136:139], v[0:3]
    ds_read_b128 v[96:99], v212 offset:32768
    ds_read_b128 v[100:103], v212 offset:34816
    ds_read_b128 v[104:107], v212 offset:36864
    ds_read_b128 v[108:111], v212 offset:38912
    ds_read_b64_tr_b16 v[112:113], v216 offset:0
    v_mfma_f32_16x16x32_bf16 v[4:7], v[156:159], v[136:139], v[4:7]
    ds_read_b64_tr_b16 v[114:115], v216 offset:512
    v_mfma_f32_16x16x32_bf16 v[8:11], v[160:163], v[136:139], v[8:11]
    v_mfma_f32_16x16x32_bf16 v[12:15], v[164:167], v[136:139], v[12:15]
    ds_read_b64_tr_b16 v[116:117], v217 offset:0
    v_mfma_f32_16x16x32_bf16 v[16:19], v[136:139], v[168:171], v[16:19]
    ds_read_b64_tr_b16 v[118:119], v217 offset:512
    v_mfma_f32_16x16x32_bf16 v[20:23], v[136:139], v[172:175], v[20:23]
    v_mfma_f32_16x16x32_bf16 v[24:27], v[152:155], v[140:143], v[24:27]
    ds_read_b64_tr_b16 v[120:121], v216 offset:8192
    v_mfma_f32_16x16x32_bf16 v[28:31], v[156:159], v[140:143], v[28:31]
    ds_read_b64_tr_b16 v[122:123], v216 offset:8704
    v_mfma_f32_16x16x32_bf16 v[32:35], v[160:163], v[140:143], v[32:35]
    v_mfma_f32_16x16x32_bf16 v[36:39], v[164:167], v[140:143], v[36:39]
    ds_read_b64_tr_b16 v[124:125], v217 offset:8192
    v_mfma_f32_16x16x32_bf16 v[40:43], v[140:143], v[168:171], v[40:43]
    ds_read_b64_tr_b16 v[126:127], v217 offset:8704
    v_mfma_f32_16x16x32_bf16 v[44:47], v[140:143], v[172:175], v[44:47]
    v_mfma_f32_16x16x32_bf16 v[48:51], v[152:155], v[144:147], v[48:51]
    ds_read_b64_tr_b16 v[128:129], v216 offset:16384
    v_mfma_f32_16x16x32_bf16 v[52:55], v[156:159], v[144:147], v[52:55]
    ds_read_b64_tr_b16 v[130:131], v216 offset:16896
    v_mfma_f32_16x16x32_bf16 v[56:59], v[160:163], v[144:147], v[56:59]
    v_mfma_f32_16x16x32_bf16 v[60:63], v[164:167], v[144:147], v[60:63]
    ds_read_b64_tr_b16 v[132:133], v217 offset:16384
    v_mfma_f32_16x16x32_bf16 v[64:67], v[144:147], v[168:171], v[64:67]
    ds_read_b64_tr_b16 v[134:135], v217 offset:16896
    v_mfma_f32_16x16x32_bf16 v[68:71], v[144:147], v[172:175], v[68:71]
    v_mfma_f32_16x16x32_bf16 v[72:75], v[152:155], v[148:151], v[72:75]
    v_mfma_f32_16x16x32_bf16 v[76:79], v[156:159], v[148:151], v[76:79]
    v_mfma_f32_16x16x32_bf16 v[80:83], v[160:163], v[148:151], v[80:83]
    v_mfma_f32_16x16x32_bf16 v[84:87], v[164:167], v[148:151], v[84:87]
    v_mfma_f32_16x16x32_bf16 v[88:91], v[148:151], v[168:171], v[88:91]
    v_mfma_f32_16x16x32_bf16 v[92:95], v[148:151], v[172:175], v[92:95]
    s_waitcnt lgkmcnt(0)
    s_cmp_lg_u32 s47, 9
    s_cbranch_scc1 K1_SW6
    s_cmp_ge_u32 s32, 3
    s_cbranch_scc1 K1_SW6
    buffer_load_dword v220, v219, s[8:11], s48 offen
K1_SW6:
    v_mfma_f32_16x16x32_bf16 v[0:3], v[112:115], v[96:99], v[0:3]
    ds_read_b128 v[136:139], v213 offset:32768
    ds_read_b128 v[140:143], v213 offset:34816
    ds_read_b128 v[144:147], v213 offset:36864
    ds_read_b128 v[148:151], v213 offset:38912
    ds_read_b64_tr_b16 v[152:153], v216 offset:4096
    v_mfma_f32_16x16x32_bf16 v[4:7], v[116:119], v[96:99], v[4:7]
    ds_read_b64_tr_b16 v[154:155], v216 offset:4608
    v_mfma_f32_16x16x32_bf16 v[8:11], v[120:123], v[96:99], v[8:11]
    v_mfma_f32_16x16x32_bf16 v[12:15], v[124:127], v[96:99], v[12:15]
    ds_read_b64_tr_b16 v[156:157], v217 offset:4096
    v_mfma_f32_16x16x32_bf16 v[16:19], v[96:99], v[128:131], v[16:19]
    ds_read_b64_tr_b16 v[158:159], v217 offset:4608
    v_mfma_f32_16x16x32_bf16 v[20:23], v[96:99], v[132:135], v[20:23]
    v_mfma_f32_16x16x32_bf16 v[24:27], v[112:115], v[100:103], v[24:27]
    ds_read_b64_tr_b16 v[160:161], v216 offset:12288
    v_mfma_f32_16x16x32_bf16 v[28:31], v[116:119], v[100:103], v[28:31]
    ds_read_b64_tr_b16 v[162:163], v216 offset:12800
    v_mfma_f32_16x16x32_bf16 v[32:35], v[120:123], v[100:103], v[32:35]
    v_mfma_f32_16x16x32_bf16 v[36:39], v[124:127], v[100:103], v[36:39]
    ds_read_b64_tr_b16 v[164:165], v217 offset:12288
    v_mfma_f32_16x16x32_bf16 v[40:43], v[100:103], v[128:131], v[40:43]
    ds_read_b64_tr_b16 v[166:167], v217 offset:12800
    v_mfma_f32_16x16x32_bf16 v[44:47], v[100:103], v[132:135], v[44:47]
    v_mfma_f32_16x16x32_bf16 v[48:51], v[112:115], v[104:107], v[48:51]
    ds_read_b64_tr_b16 v[168:169], v216 offset:20480
    v_mfma_f32_16x16x32_bf16 v[52:55], v[116:119], v[104:107], v[52:55]
    ds_read_b64_tr_b16 v[170:171], v216 offset:20992
    v_mfma_f32_16x16x32_bf16 v[56:59], v[120:123], v[104:107], v[56:59]
    v_mfma_f32_16x16x32_bf16 v[60:63], v[124:127], v[104:107], v[60:63]
    ds_read_b64_tr_b16 v[172:173], v217 offset:20480
    v_mfma_f32_16x16x32_bf16 v[64:67], v[104:107], v[128:131], v[64:67]
    ds_read_b64_tr_b16 v[174:175], v217 offset:20992
    v_mfma_f32_16x16x32_bf16 v[68:71], v[104:107], v[132:135], v[68:71]
    v_mfma_f32_16x16x32_bf16 v[72:75], v[112:115], v[108:111], v[72:75]
    v_mfma_f32_16x16x32_bf16 v[76:79], v[116:119], v[108:111], v[76:79]
    v_mfma_f32_16x16x32_bf16 v[80:83], v[120:123], v[108:111], v[80:83]
    v_mfma_f32_16x16x32_bf16 v[84:87], v[124:127], v[108:111], v[84:87]
    v_mfma_f32_16x16x32_bf16 v[88:91], v[108:111], v[128:131], v[88:91]
    v_mfma_f32_16x16x32_bf16 v[92:95], v[108:111], v[132:135], v[92:95]
    s_waitcnt lgkmcnt(0)
    s_barrier
    v_mfma_f32_16x16x32_bf16 v[0:3], v[152:155], v[136:139], v[0:3]
    ds_read_b128 v[96:99], v212 offset:0
    ds_read_b128 v[100:103], v212 offset:2048
    ds_read_b128 v[104:107], v212 offset:4096
    ds_read_b128 v[108:111], v212 offset:6144
    ds_read_b64_tr_b16 v[112:113], v214 offset:0
    v_mfma_f32_16x16x32_bf16 v[4:7], v[156:159], v[136:139], v[4:7]
    ds_read_b64_tr_b16 v[114:115], v214 offset:512
    v_mfma_f32_16x16x32_bf16 v[8:11], v[160:163], v[136:139], v[8:11]
    v_mfma_f32_16x16x32_bf16 v[12:15], v[164:167], v[136:139], v[12:15]
    ds_read_b64_tr_b16 v[116:117], v215 offset:0
    v_mfma_f32_16x16x32_bf16 v[16:19], v[136:139], v[168:171], v[16:19]
    ds_read_b64_tr_b16 v[118:119], v215 offset:512
    v_mfma_f32_16x16x32_bf16 v[20:23], v[136:139], v[172:175], v[20:23]
    v_mfma_f32_16x16x32_bf16 v[24:27], v[152:155], v[140:143], v[24:27]
    ds_read_b64_tr_b16 v[120:121], v214 offset:8192
    v_mfma_f32_16x16x32_bf16 v[28:31], v[156:159], v[140:143], v[28:31]
    ds_read_b64_tr_b16 v[122:123], v214 offset:8704
    v_mfma_f32_16x16x32_bf16 v[32:35], v[160:163], v[140:143], v[32:35]
    v_mfma_f32_16x16x32_bf16 v[36:39], v[164:167], v[140:143], v[36:39]
    ds_read_b64_tr_b16 v[124:125], v215 offset:8192
    v_mfma_f32_16x16x32_bf16 v[40:43], v[140:143], v[168:171], v[40:43]
    ds_read_b64_tr_b16 v[126:127], v215 offset:8704
    v_mfma_f32_16x16x32_bf16 v[44:47], v[140:143], v[172:175], v[44:47]
    v_mfma_f32_16x16x32_bf16 v[48:51], v[152:155], v[144:147], v[48:51]
    ds_read_b64_tr_b16 v[128:129], v214 offset:16384
    v_mfma_f32_16x16x32_bf16 v[52:55], v[156:159], v[144:147], v[52:55]
    ds_read_b64_tr_b16 v[130:131], v214 offset:16896
    v_mfma_f32_16x16x32_bf16 v[56:59], v[160:163], v[144:147], v[56:59]
    v_mfma_f32_16x16x32_bf16 v[60:63], v[164:167], v[144:147], v[60:63]
    ds_read_b64_tr_b16 v[132:133], v215 offset:16384
    v_mfma_f32_16x16x32_bf16 v[64:67], v[144:147], v[168:171], v[64:67]
    ds_read_b64_tr_b16 v[134:135], v215 offset:16896
    v_mfma_f32_16x16x32_bf16 v[68:71], v[144:147], v[172:175], v[68:71]
    v_mfma_f32_16x16x32_bf16 v[72:75], v[152:155], v[148:151], v[72:75]
    v_mfma_f32_16x16x32_bf16 v[76:79], v[156:159], v[148:151], v[76:79]
    v_mfma_f32_16x16x32_bf16 v[80:83], v[160:163], v[148:151], v[80:83]
    v_mfma_f32_16x16x32_bf16 v[84:87], v[164:167], v[148:151], v[84:87]
    v_mfma_f32_16x16x32_bf16 v[88:91], v[148:151], v[168:171], v[88:91]
    v_mfma_f32_16x16x32_bf16 v[92:95], v[148:151], v[172:175], v[92:95]
    s_waitcnt lgkmcnt(0)
    s_cmp_lg_u32 s47, 10
    s_cbranch_scc1 K1_SW7
    s_cmp_ge_u32 s32, 3
    s_cbranch_scc1 K1_SW7
    buffer_load_dword v220, v219, s[8:11], s48 offen
K1_SW7:
    v_mfma_f32_16x16x32_bf16 v[0:3], v[112:115], v[96:99], v[0:3]
    ds_read_b128 v[136:139], v213 offset:0
    ds_read_b128 v[140:143], v213 offset:2048
    ds_read_b128 v[144:147], v213 offset:4096
    ds_read_b128 v[148:151], v213 offset:6144
    ds_read_b64_tr_b16 v[152:153], v214 offset:4096
    v_mfma_f32_16x16x32_bf16 v[4:7], v[116:119], v[96:99], v[4:7]
    ds_read_b64_tr_b16 v[154:155], v214 offset:4608
    v_mfma_f32_16x16x32_bf16 v[8:11], v[120:123], v[96:99], v[8:11]
    v_mfma_f32_16x16x32_bf16 v[12:15], v[124:127], v[96:99], v[12:15]
    ds_read_b64_tr_b16 v[156:157], v215 offset:4096
    v_mfma_f32_16x16x32_bf16 v[16:19], v[96:99], v[128:131], v[16:19]
    ds_read_b64_tr_b16 v[158:159], v215 offset:4608
    v_mfma_f32_16x16x32_bf16 v[20:23], v[96:99], v[132:135], v[20:23]
    v_mfma_f32_16x16x32_bf16 v[24:27], v[112:115], v[100:103], v[24:27]
    ds_read_b64_tr_b16 v[160:161], v214 offset:12288
    v_mfma_f32_16x16x32_bf16 v[28:31], v[116:119], v[100:103], v[28:31]
    ds_read_b64_tr_b16 v[162:163], v214 offset:12800
    v_mfma_f32_16x16x32_bf16 v[32:35], v[120:123], v[100:103], v[32:35]
    v_mfma_f32_16x16x32_bf16 v[36:39], v[124:127], v[100:103], v[36:39]
    ds_read_b64_tr_b16 v[164:165], v215 offset:12288
    v_mfma_f32_16x16x32_bf16 v[40:43], v[100:103], v[128:131], v[40:43]
    ds_read_b64_tr_b16 v[166:167], v215 offset:12800
    v_mfma_f32_16x16x32_bf16 v[44:47], v[100:103], v[132:135], v[44:47]
    v_mfma_f32_16x16x32_bf16 v[48:51], v[112:115], v[104:107], v[48:51]
    ds_read_b64_tr_b16 v[168:169], v214 offset:20480
    v_mfma_f32_16x16x32_bf16 v[52:55], v[116:119], v[104:107], v[52:55]
    ds_read_b64_tr_b16 v[170:171], v214 offset:20992
    v_mfma_f32_16x16x32_bf16 v[56:59], v[120:123], v[104:107], v[56:59]
    v_mfma_f32_16x16x32_bf16 v[60:63], v[124:127], v[104:107], v[60:63]
    ds_read_b64_tr_b16 v[172:173], v215 offset:20480
    v_mfma_f32_16x16x32_bf16 v[64:67], v[104:107], v[128:131], v[64:67]
    ds_read_b64_tr_b16 v[174:175], v215 offset:20992
    v_mfma_f32_16x16x32_bf16 v[68:71], v[104:107], v[132:135], v[68:71]
    v_mfma_f32_16x16x32_bf16 v[72:75], v[112:115], v[108:111], v[72:75]
    v_mfma_f32_16x16x32_bf16 v[76:79], v[116:119], v[108:111], v[76:79]
    v_mfma_f32_16x16x32_bf16 v[80:83], v[120:123], v[108:111], v[80:83]
    v_mfma_f32_16x16x32_bf16 v[84:87], v[124:127], v[108:111], v[84:87]
    v_mfma_f32_16x16x32_bf16 v[88:91], v[108:111], v[128:131], v[88:91]
    v_mfma_f32_16x16x32_bf16 v[92:95], v[108:111], v[132:135], v[92:95]
    s_waitcnt lgkmcnt(0)
    s_barrier
    v_mfma_f32_16x16x32_bf16 v[0:3], v[152:155], v[136:139], v[0:3]
    ds_read_b128 v[96:99], v212 offset:16384
    ds_read_b128 v[100:103], v212 offset:18432
    ds_read_b128 v[104:107], v212 offset:20480
    ds_read_b128 v[108:111], v212 offset:22528
    ds_read_b64_tr_b16 v[112:113], v214 offset:24576
    v_mfma_f32_16x16x32_bf16 v[4:7], v[156:159], v[136:139], v[4:7]
    ds_read_b64_tr_b16 v[114:115], v214 offset:25088
    v_mfma_f32_16x16x32_bf16 v[8:11], v[160:163], v[136:139], v[8:11]
    v_mfma_f32_16x16x32_bf16 v[12:15], v[164:167], v[136:139], v[12:15]
    ds_read_b64_tr_b16 v[116:117], v215 offset:24576
    v_mfma_f32_16x16x32_bf16 v[16:19], v[136:139], v[168:171], v[16:19]
    ds_read_b64_tr_b16 v[118:119], v215 offset:25088
    v_mfma_f32_16x16x32_bf16 v[20:23], v[136:139], v[172:175], v[20:23]
    v_mfma_f32_16x16x32_bf16 v[24:27], v[152:155], v[140:143], v[24:27]
    ds_read_b64_tr_b16 v[120:121], v214 offset:32768
    v_mfma_f32_16x16x32_bf16 v[28:31], v[156:159], v[140:143], v[28:31]
    ds_read_b64_tr_b16 v[122:123], v214 offset:33280
    v_mfma_f32_16x16x32_bf16 v[32:35], v[160:163], v[140:143], v[32:35]
    v_mfma_f32_16x16x32_bf16 v[36:39], v[164:167], v[140:143], v[36:39]
    ds_read_b64_tr_b16 v[124:125], v215 offset:32768
    v_mfma_f32_16x16x32_bf16 v[40:43], v[140:143], v[168:171], v[40:43]
    ds_read_b64_tr_b16 v[126:127], v215 offset:33280
    v_mfma_f32_16x16x32_bf16 v[44:47], v[140:143], v[172:175], v[44:47]
    v_mfma_f32_16x16x32_bf16 v[48:51], v[152:155], v[144:147], v[48:51]
    ds_read_b64_tr_b16 v[128:129], v214 offset:40960
    v_mfma_f32_16x16x32_bf16 v[52:55], v[156:159], v[144:147], v[52:55]
    ds_read_b64_tr_b16 v[130:131], v214 offset:41472
    v_mfma_f32_16x16x32_bf16 v[56:59], v[160:163], v[144:147], v[56:59]
    v_mfma_f32_16x16x32_bf16 v[60:63], v[164:167], v[144:147], v[60:63]
    ds_read_b64_tr_b16 v[132:133], v215 offset:40960
    v_mfma_f32_16x16x32_bf16 v[64:67], v[144:147], v[168:171], v[64:67]
    ds_read_b64_tr_b16 v[134:135], v215 offset:41472
    v_mfma_f32_16x16x32_bf16 v[68:71], v[144:147], v[172:175], v[68:71]
    v_mfma_f32_16x16x32_bf16 v[72:75], v[152:155], v[148:151], v[72:75]
    v_mfma_f32_16x16x32_bf16 v[76:79], v[156:159], v[148:151], v[76:79]
    v_mfma_f32_16x16x32_bf16 v[80:83], v[160:163], v[148:151], v[80:83]
    v_mfma_f32_16x16x32_bf16 v[84:87], v[164:167], v[148:151], v[84:87]
    v_mfma_f32_16x16x32_bf16 v[88:91], v[148:151], v[168:171], v[88:91]
    v_mfma_f32_16x16x32_bf16 v[92:95], v[148:151], v[172:175], v[92:95]
    s_waitcnt lgkmcnt(0)
    s_cmp_lg_u32 s47, 11
    s_cbranch_scc1 K1_SW8
    s_cmp_ge_u32 s32, 3
    s_cbranch_scc1 K1_SW8
    buffer_load_dword v220, v219, s[8:11], s48 offen
K1_SW8:
    v_mfma_f32_16x16x32_bf16 v[0:3], v[112:115], v[96:99], v[0:3]
    ds_read_b128 v[136:139], v213 offset:16384
    ds_read_b128 v[140:143], v213 offset:18432
    ds_read_b128 v[144:147], v213 offset:20480
    ds_read_b128 v[148:151], v213 offset:22528
    ds_read_b64_tr_b16 v[152:153], v214 offset:28672
    v_mfma_f32_16x16x32_bf16 v[4:7], v[116:119], v[96:99], v[4:7]
    ds_read_b64_tr_b16 v[154:155], v214 offset:29184
    v_mfma_f32_16x16x32_bf16 v[8:11], v[120:123], v[96:99], v[8:11]
    v_mfma_f32_16x16x32_bf16 v[12:15], v[124:127], v[96:99], v[12:15]
    ds_read_b64_tr_b16 v[156:157], v215 offset:28672
    v_mfma_f32_16x16x32_bf16 v[16:19], v[96:99], v[128:131], v[16:19]
    ds_read_b64_tr_b16 v[158:159], v215 offset:29184
    v_mfma_f32_16x16x32_bf16 v[20:23], v[96:99], v[132:135], v[20:23]
    v_mfma_f32_16x16x32_bf16 v[24:27], v[112:115], v[100:103], v[24:27]
    ds_read_b64_tr_b16 v[160:161], v214 offset:36864
    v_mfma_f32_16x16x32_bf16 v[28:31], v[116:119], v[100:103], v[28:31]
    ds_read_b64_tr_b16 v[162:163], v214 offset:37376
    v_mfma_f32_16x16x32_bf16 v[32:35], v[120:123], v[100:103], v[32:35]
    v_mfma_f32_16x16x32_bf16 v[36:39], v[124:127], v[100:103], v[36:39]
    ds_read_b64_tr_b16 v[164:165], v215 offset:36864
    v_mfma_f32_16x16x32_bf16 v[40:43], v[100:103], v[128:131], v[40:43]
    ds_read_b64_tr_b16 v[166:167], v215 offset:37376
    v_mfma_f32_16x16x32_bf16 v[44:47], v[100:103], v[132:135], v[44:47]
    v_mfma_f32_16x16x32_bf16 v[48:51], v[112:115], v[104:107], v[48:51]
    ds_read_b64_tr_b16 v[168:169], v214 offset:45056
    v_mfma_f32_16x16x32_bf16 v[52:55], v[116:119], v[104:107], v[52:55]
    ds_read_b64_tr_b16 v[170:171], v214 offset:45568
    v_mfma_f32_16x16x32_bf16 v[56:59], v[120:123], v[104:107], v[56:59]
    v_mfma_f32_16x16x32_bf16 v[60:63], v[124:127], v[104:107], v[60:63]
    ds_read_b64_tr_b16 v[172:173], v215 offset:45056
    v_mfma_f32_16x16x32_bf16 v[64:67], v[104:107], v[128:131], v[64:67]
    ds_read_b64_tr_b16 v[174:175], v215 offset:45568
    v_mfma_f32_16x16x32_bf16 v[68:71], v[104:107], v[132:135], v[68:71]
    v_mfma_f32_16x16x32_bf16 v[72:75], v[112:115], v[108:111], v[72:75]
    v_mfma_f32_16x16x32_bf16 v[76:79], v[116:119], v[108:111], v[76:79]
    v_mfma_f32_16x16x32_bf16 v[80:83], v[120:123], v[108:111], v[80:83]
    v_mfma_f32_16x16x32_bf16 v[84:87], v[124:127], v[108:111], v[84:87]
    v_mfma_f32_16x16x32_bf16 v[88:91], v[108:111], v[128:131], v[88:91]
    v_mfma_f32_16x16x32_bf16 v[92:95], v[108:111], v[132:135], v[92:95]
    s_waitcnt lgkmcnt(0)
    s_barrier
    v_mfma_f32_16x16x32_bf16 v[0:3], v[152:155], v[136:139], v[0:3]
    ds_read_b128 v[96:99], v212 offset:32768
    ds_read_b128 v[100:103], v212 offset:34816
    ds_read_b128 v[104:107], v212 offset:36864
    ds_read_b128 v[108:111], v212 offset:38912
    ds_read_b64_tr_b16 v[112:113], v216 offset:0
    v_mfma_f32_16x16x32_bf16 v[4:7], v[156:159], v[136:139], v[4:7]
    ds_read_b64_tr_b16 v[114:115], v216 offset:512
    v_mfma_f32_16x16x32_bf16 v[8:11], v[160:163], v[136:139], v[8:11]
    v_mfma_f32_16x16x32_bf16 v[12:15], v[164:167], v[136:139], v[12:15]
    ds_read_b64_tr_b16 v[116:117], v217 offset:0
    v_mfma_f32_16x16x32_bf16 v[16:19], v[136:139], v[168:171], v[16:19]
    ds_read_b64_tr_b16 v[118:119], v217 offset:512
    v_mfma_f32_16x16x32_bf16 v[20:23], v[136:139], v[172:175], v[20:23]
    v_mfma_f32_16x16x32_bf16 v[24:27], v[152:155], v[140:143], v[24:27]
    ds_read_b64_tr_b16 v[120:121], v216 offset:8192
    v_mfma_f32_16x16x32_bf16 v[28:31], v[156:159], v[140:143], v[28:31]
    ds_read_b64_tr_b16 v[122:123], v216 offset:8704
    v_mfma_f32_16x16x32_bf16 v[32:35], v[160:163], v[140:143], v[32:35]
    v_mfma_f32_16x16x32_bf16 v[36:39], v[164:167], v[140:143], v[36:39]
    ds_read_b64_tr_b16 v[124:125], v217 offset:8192
    v_mfma_f32_16x16x32_bf16 v[40:43], v[140:143], v[168:171], v[40:43]
    ds_read_b64_tr_b16 v[126:127], v217 offset:8704
    v_mfma_f32_16x16x32_bf16 v[44:47], v[140:143], v[172:175], v[44:47]
    v_mfma_f32_16x16x32_bf16 v[48:51], v[152:155], v[144:147], v[48:51]
    ds_read_b64_tr_b16 v[128:129], v216 offset:16384
    v_mfma_f32_16x16x32_bf16 v[52:55], v[156:159], v[144:147], v[52:55]
    ds_read_b64_tr_b16 v[130:131], v216 offset:16896
    v_mfma_f32_16x16x32_bf16 v[56:59], v[160:163], v[144:147], v[56:59]
    v_mfma_f32_16x16x32_bf16 v[60:63], v[164:167], v[144:147], v[60:63]
    ds_read_b64_tr_b16 v[132:133], v217 offset:16384
    v_mfma_f32_16x16x32_bf16 v[64:67], v[144:147], v[168:171], v[64:67]
    ds_read_b64_tr_b16 v[134:135], v217 offset:16896
    v_mfma_f32_16x16x32_bf16 v[68:71], v[144:147], v[172:175], v[68:71]
    v_mfma_f32_16x16x32_bf16 v[72:75], v[152:155], v[148:151], v[72:75]
    v_mfma_f32_16x16x32_bf16 v[76:79], v[156:159], v[148:151], v[76:79]
    v_mfma_f32_16x16x32_bf16 v[80:83], v[160:163], v[148:151], v[80:83]
    v_mfma_f32_16x16x32_bf16 v[84:87], v[164:167], v[148:151], v[84:87]
    v_mfma_f32_16x16x32_bf16 v[88:91], v[148:151], v[168:171], v[88:91]
    v_mfma_f32_16x16x32_bf16 v[92:95], v[148:151], v[172:175], v[92:95]
    s_waitcnt lgkmcnt(0)
    s_cmp_lg_u32 s47, 12
    s_cbranch_scc1 K1_SW9
    s_cmp_ge_u32 s32, 3
    s_cbranch_scc1 K1_SW9
    buffer_load_dword v220, v219, s[8:11], s48 offen
K1_SW9:
    v_mfma_f32_16x16x32_bf16 v[0:3], v[112:115], v[96:99], v[0:3]
    ds_read_b128 v[136:139], v213 offset:32768
    ds_read_b128 v[140:143], v213 offset:34816
    ds_read_b128 v[144:147], v213 offset:36864
    ds_read_b128 v[148:151], v213 offset:38912
    ds_read_b64_tr_b16 v[152:153], v216 offset:4096
    v_mfma_f32_16x16x32_bf16 v[4:7], v[116:119], v[96:99], v[4:7]
    ds_read_b64_tr_b16 v[154:155], v216 offset:4608
    v_mfma_f32_16x16x32_bf16 v[8:11], v[120:123], v[96:99], v[8:11]
    v_mfma_f32_16x16x32_bf16 v[12:15], v[124:127], v[96:99], v[12:15]
    ds_read_b64_tr_b16 v[156:157], v217 offset:4096
    v_mfma_f32_16x16x32_bf16 v[16:19], v[96:99], v[128:131], v[16:19]
    ds_read_b64_tr_b16 v[158:159], v217 offset:4608
    v_mfma_f32_16x16x32_bf16 v[20:23], v[96:99], v[132:135], v[20:23]
    v_mfma_f32_16x16x32_bf16 v[24:27], v[112:115], v[100:103], v[24:27]
    ds_read_b64_tr_b16 v[160:161], v216 offset:12288
    v_mfma_f32_16x16x32_bf16 v[28:31], v[116:119], v[100:103], v[28:31]
    ds_read_b64_tr_b16 v[162:163], v216 offset:12800
    v_mfma_f32_16x16x32_bf16 v[32:35], v[120:123], v[100:103], v[32:35]
    v_mfma_f32_16x16x32_bf16 v[36:39], v[124:127], v[100:103], v[36:39]
    ds_read_b64_tr_b16 v[164:165], v217 offset:12288
    v_mfma_f32_16x16x32_bf16 v[40:43], v[100:103], v[128:131], v[40:43]
    ds_read_b64_tr_b16 v[166:167], v217 offset:12800
    v_mfma_f32_16x16x32_bf16 v[44:47], v[100:103], v[132:135], v[44:47]
    v_mfma_f32_16x16x32_bf16 v[48:51], v[112:115], v[104:107], v[48:51]
    ds_read_b64_tr_b16 v[168:169], v216 offset:20480
    v_mfma_f32_16x16x32_bf16 v[52:55], v[116:119], v[104:107], v[52:55]
    ds_read_b64_tr_b16 v[170:171], v216 offset:20992
    v_mfma_f32_16x16x32_bf16 v[56:59], v[120:123], v[104:107], v[56:59]
    v_mfma_f32_16x16x32_bf16 v[60:63], v[124:127], v[104:107], v[60:63]
    ds_read_b64_tr_b16 v[172:173], v217 offset:20480
    v_mfma_f32_16x16x32_bf16 v[64:67], v[104:107], v[128:131], v[64:67]
    ds_read_b64_tr_b16 v[174:175], v217 offset:20992
    v_mfma_f32_16x16x32_bf16 v[68:71], v[104:107], v[132:135], v[68:71]
    v_mfma_f32_16x16x32_bf16 v[72:75], v[112:115], v[108:111], v[72:75]
    v_mfma_f32_16x16x32_bf16 v[76:79], v[116:119], v[108:111], v[76:79]
    v_mfma_f32_16x16x32_bf16 v[80:83], v[120:123], v[108:111], v[80:83]
    v_mfma_f32_16x16x32_bf16 v[84:87], v[124:127], v[108:111], v[84:87]
    v_mfma_f32_16x16x32_bf16 v[88:91], v[108:111], v[128:131], v[88:91]
    v_mfma_f32_16x16x32_bf16 v[92:95], v[108:111], v[132:135], v[92:95]
    s_waitcnt lgkmcnt(0)
    s_barrier
    v_mfma_f32_16x16x32_bf16 v[0:3], v[152:155], v[136:139], v[0:3]
    ds_read_b128 v[96:99], v212 offset:0
    ds_read_b128 v[100:103], v212 offset:2048
    ds_read_b128 v[104:107], v212 offset:4096
    ds_read_b128 v[108:111], v212 offset:6144
    ds_read_b64_tr_b16 v[112:113], v214 offset:0
    v_mfma_f32_16x16x32_bf16 v[4:7], v[156:159], v[136:139], v[4:7]
    ds_read_b64_tr_b16 v[114:115], v214 offset:512
    v_mfma_f32_16x16x32_bf16 v[8:11], v[160:163], v[136:139], v[8:11]
    v_mfma_f32_16x16x32_bf16 v[12:15], v[164:167], v[136:139], v[12:15]
    ds_read_b64_tr_b16 v[116:117], v215 offset:0
    v_mfma_f32_16x16x32_bf16 v[16:19], v[136:139], v[168:171], v[16:19]
    ds_read_b64_tr_b16 v[118:119], v215 offset:512
    v_mfma_f32_16x16x32_bf16 v[20:23], v[136:139], v[172:175], v[20:23]
    v_mfma_f32_16x16x32_bf16 v[24:27], v[152:155], v[140:143], v[24:27]
    ds_read_b64_tr_b16 v[120:121], v214 offset:8192
    v_mfma_f32_16x16x32_bf16 v[28:31], v[156:159], v[140:143], v[28:31]
    ds_read_b64_tr_b16 v[122:123], v214 offset:8704
    v_mfma_f32_16x16x32_bf16 v[32:35], v[160:163], v[140:143], v[32:35]
    v_mfma_f32_16x16x32_bf16 v[36:39], v[164:167], v[140:143], v[36:39]
    ds_read_b64_tr_b16 v[124:125], v215 offset:8192
    v_mfma_f32_16x16x32_bf16 v[40:43], v[140:143], v[168:171], v[40:43]
    ds_read_b64_tr_b16 v[126:127], v215 offset:8704
    v_mfma_f32_16x16x32_bf16 v[44:47], v[140:143], v[172:175], v[44:47]
    v_mfma_f32_16x16x32_bf16 v[48:51], v[152:155], v[144:147], v[48:51]
    ds_read_b64_tr_b16 v[128:129], v214 offset:16384
    v_mfma_f32_16x16x32_bf16 v[52:55], v[156:159], v[144:147], v[52:55]
    ds_read_b64_tr_b16 v[130:131], v214 offset:16896
    v_mfma_f32_16x16x32_bf16 v[56:59], v[160:163], v[144:147], v[56:59]
    v_mfma_f32_16x16x32_bf16 v[60:63], v[164:167], v[144:147], v[60:63]
    ds_read_b64_tr_b16 v[132:133], v215 offset:16384
    v_mfma_f32_16x16x32_bf16 v[64:67], v[144:147], v[168:171], v[64:67]
    ds_read_b64_tr_b16 v[134:135], v215 offset:16896
    v_mfma_f32_16x16x32_bf16 v[68:71], v[144:147], v[172:175], v[68:71]
    v_mfma_f32_16x16x32_bf16 v[72:75], v[152:155], v[148:151], v[72:75]
    v_mfma_f32_16x16x32_bf16 v[76:79], v[156:159], v[148:151], v[76:79]
    v_mfma_f32_16x16x32_bf16 v[80:83], v[160:163], v[148:151], v[80:83]
    v_mfma_f32_16x16x32_bf16 v[84:87], v[164:167], v[148:151], v[84:87]
    v_mfma_f32_16x16x32_bf16 v[88:91], v[148:151], v[168:171], v[88:91]
    v_mfma_f32_16x16x32_bf16 v[92:95], v[148:151], v[172:175], v[92:95]
    s_waitcnt lgkmcnt(0)
    s_cmp_lg_u32 s47, 13
    s_cbranch_scc1 K1_SW10
    s_cmp_ge_u32 s32, 3
    s_cbranch_scc1 K1_SW10
    buffer_load_dword v220, v219, s[8:11], s48 offen
K1_SW10:
    v_mfma_f32_16x16x32_bf16 v[0:3], v[112:115], v[96:99], v[0:3]
    ds_read_b128 v[136:139], v213 offset:0
    ds_read_b128 v[140:143], v213 offset:2048
    ds_read_b128 v[144:147], v213 offset:4096
    ds_read_b128 v[148:151], v213 offset:6144
    ds_read_b64_tr_b16 v[152:153], v214 offset:4096
    v_mfma_f32_16x16x32_bf16 v[4:7], v[116:119], v[96:99], v[4:7]
    ds_read_b64_tr_b16 v[154:155], v214 offset:4608
    v_mfma_f32_16x16x32_bf16 v[8:11], v[120:123], v[96:99], v[8:11]
    v_mfma_f32_16x16x32_bf16 v[12:15], v[124:127], v[96:99], v[12:15]
    ds_read_b64_tr_b16 v[156:157], v215 offset:4096
    v_mfma_f32_16x16x32_bf16 v[16:19], v[96:99], v[128:131], v[16:19]
    ds_read_b64_tr_b16 v[158:159], v215 offset:4608
    v_mfma_f32_16x16x32_bf16 v[20:23], v[96:99], v[132:135], v[20:23]
    v_mfma_f32_16x16x32_bf16 v[24:27], v[112:115], v[100:103], v[24:27]
    ds_read_b64_tr_b16 v[160:161], v214 offset:12288
    v_mfma_f32_16x16x32_bf16 v[28:31], v[116:119], v[100:103], v[28:31]
    ds_read_b64_tr_b16 v[162:163], v214 offset:12800
    v_mfma_f32_16x16x32_bf16 v[32:35], v[120:123], v[100:103], v[32:35]
    v_mfma_f32_16x16x32_bf16 v[36:39], v[124:127], v[100:103], v[36:39]
    ds_read_b64_tr_b16 v[164:165], v215 offset:12288
    v_mfma_f32_16x16x32_bf16 v[40:43], v[100:103], v[128:131], v[40:43]
    ds_read_b64_tr_b16 v[166:167], v215 offset:12800
    v_mfma_f32_16x16x32_bf16 v[44:47], v[100:103], v[132:135], v[44:47]
    v_mfma_f32_16x16x32_bf16 v[48:51], v[112:115], v[104:107], v[48:51]
    ds_read_b64_tr_b16 v[168:169], v214 offset:20480
    v_mfma_f32_16x16x32_bf16 v[52:55], v[116:119], v[104:107], v[52:55]
    ds_read_b64_tr_b16 v[170:171], v214 offset:20992
    v_mfma_f32_16x16x32_bf16 v[56:59], v[120:123], v[104:107], v[56:59]
    v_mfma_f32_16x16x32_bf16 v[60:63], v[124:127], v[104:107], v[60:63]
    ds_read_b64_tr_b16 v[172:173], v215 offset:20480
    v_mfma_f32_16x16x32_bf16 v[64:67], v[104:107], v[128:131], v[64:67]
    ds_read_b64_tr_b16 v[174:175], v215 offset:20992
    v_mfma_f32_16x16x32_bf16 v[68:71], v[104:107], v[132:135], v[68:71]
    v_mfma_f32_16x16x32_bf16 v[72:75], v[112:115], v[108:111], v[72:75]
    v_mfma_f32_16x16x32_bf16 v[76:79], v[116:119], v[108:111], v[76:79]
    v_mfma_f32_16x16x32_bf16 v[80:83], v[120:123], v[108:111], v[80:83]
    v_mfma_f32_16x16x32_bf16 v[84:87], v[124:127], v[108:111], v[84:87]
    v_mfma_f32_16x16x32_bf16 v[88:91], v[108:111], v[128:131], v[88:91]
    v_mfma_f32_16x16x32_bf16 v[92:95], v[108:111], v[132:135], v[92:95]
    s_waitcnt lgkmcnt(0)
    s_barrier
    v_mfma_f32_16x16x32_bf16 v[0:3], v[152:155], v[136:139], v[0:3]
    ds_read_b128 v[96:99], v212 offset:16384
    ds_read_b128 v[100:103], v212 offset:18432
    ds_read_b128 v[104:107], v212 offset:20480
    ds_read_b128 v[108:111], v212 offset:22528
    ds_read_b64_tr_b16 v[112:113], v214 offset:24576
    v_mfma_f32_16x16x32_bf16 v[4:7], v[156:159], v[136:139], v[4:7]
    ds_read_b64_tr_b16 v[114:115], v214 offset:25088
    v_mfma_f32_16x16x32_bf16 v[8:11], v[160:163], v[136:139], v[8:11]
    v_mfma_f32_16x16x32_bf16 v[12:15], v[164:167], v[136:139], v[12:15]
    ds_read_b64_tr_b16 v[116:117], v215 offset:24576
    v_mfma_f32_16x16x32_bf16 v[16:19], v[136:139], v[168:171], v[16:19]
    ds_read_b64_tr_b16 v[118:119], v215 offset:25088
    v_mfma_f32_16x16x32_bf16 v[20:23], v[136:139], v[172:175], v[20:23]
    v_mfma_f32_16x16x32_bf16 v[24:27], v[152:155], v[140:143], v[24:27]
    ds_read_b64_tr_b16 v[120:121], v214 offset:32768
    v_mfma_f32_16x16x32_bf16 v[28:31], v[156:159], v[140:143], v[28:31]
    ds_read_b64_tr_b16 v[122:123], v214 offset:33280
    v_mfma_f32_16x16x32_bf16 v[32:35], v[160:163], v[140:143], v[32:35]
    v_mfma_f32_16x16x32_bf16 v[36:39], v[164:167], v[140:143], v[36:39]
    ds_read_b64_tr_b16 v[124:125], v215 offset:32768
    v_mfma_f32_16x16x32_bf16 v[40:43], v[140:143], v[168:171], v[40:43]
    ds_read_b64_tr_b16 v[126:127], v215 offset:33280
    v_mfma_f32_16x16x32_bf16 v[44:47], v[140:143], v[172:175], v[44:47]
    v_mfma_f32_16x16x32_bf16 v[48:51], v[152:155], v[144:147], v[48:51]
    ds_read_b64_tr_b16 v[128:129], v214 offset:40960
    v_mfma_f32_16x16x32_bf16 v[52:55], v[156:159], v[144:147], v[52:55]
    ds_read_b64_tr_b16 v[130:131], v214 offset:41472
    v_mfma_f32_16x16x32_bf16 v[56:59], v[160:163], v[144:147], v[56:59]
    v_mfma_f32_16x16x32_bf16 v[60:63], v[164:167], v[144:147], v[60:63]
    ds_read_b64_tr_b16 v[132:133], v215 offset:40960
    v_mfma_f32_16x16x32_bf16 v[64:67], v[144:147], v[168:171], v[64:67]
    ds_read_b64_tr_b16 v[134:135], v215 offset:41472
    v_mfma_f32_16x16x32_bf16 v[68:71], v[144:147], v[172:175], v[68:71]
    v_mfma_f32_16x16x32_bf16 v[72:75], v[152:155], v[148:151], v[72:75]
    v_mfma_f32_16x16x32_bf16 v[76:79], v[156:159], v[148:151], v[76:79]
    v_mfma_f32_16x16x32_bf16 v[80:83], v[160:163], v[148:151], v[80:83]
    v_mfma_f32_16x16x32_bf16 v[84:87], v[164:167], v[148:151], v[84:87]
    v_mfma_f32_16x16x32_bf16 v[88:91], v[148:151], v[168:171], v[88:91]
    v_mfma_f32_16x16x32_bf16 v[92:95], v[148:151], v[172:175], v[92:95]
    s_waitcnt lgkmcnt(0)
    s_cmp_lg_u32 s47, 14
    s_cbranch_scc1 K1_SW11
    s_cmp_ge_u32 s32, 3
    s_cbranch_scc1 K1_SW11
    buffer_load_dword v220, v219, s[8:11], s48 offen
K1_SW11:
    v_mfma_f32_16x16x32_bf16 v[0:3], v[112:115], v[96:99], v[0:3]
    ds_read_b128 v[136:139], v213 offset:16384
    ds_read_b128 v[140:143], v213 offset:18432
    ds_read_b128 v[144:147], v213 offset:20480
    ds_read_b128 v[148:151], v213 offset:22528
    ds_read_b64_tr_b16 v[152:153], v214 offset:28672
    v_mfma_f32_16x16x32_bf16 v[4:7], v[116:119], v[96:99], v[4:7]
    ds_read_b64_tr_b16 v[154:155], v214 offset:29184
    v_mfma_f32_16x16x32_bf16 v[8:11], v[120:123], v[96:99], v[8:11]
    v_mfma_f32_16x16x32_bf16 v[12:15], v[124:127], v[96:99], v[12:15]
    ds_read_b64_tr_b16 v[156:157], v215 offset:28672
    v_mfma_f32_16x16x32_bf16 v[16:19], v[96:99], v[128:131], v[16:19]
    ds_read_b64_tr_b16 v[158:159], v215 offset:29184
    v_mfma_f32_16x16x32_bf16 v[20:23], v[96:99], v[132:135], v[20:23]
    v_mfma_f32_16x16x32_bf16 v[24:27], v[112:115], v[100:103], v[24:27]
    ds_read_b64_tr_b16 v[160:161], v214 offset:36864
    v_mfma_f32_16x16x32_bf16 v[28:31], v[116:119], v[100:103], v[28:31]
    ds_read_b64_tr_b16 v[162:163], v214 offset:37376
    v_mfma_f32_16x16x32_bf16 v[32:35], v[120:123], v[100:103], v[32:35]
    v_mfma_f32_16x16x32_bf16 v[36:39], v[124:127], v[100:103], v[36:39]
    ds_read_b64_tr_b16 v[164:165], v215 offset:36864
    v_mfma_f32_16x16x32_bf16 v[40:43], v[100:103], v[128:131], v[40:43]
    ds_read_b64_tr_b16 v[166:167], v215 offset:37376
    v_mfma_f32_16x16x32_bf16 v[44:47], v[100:103], v[132:135], v[44:47]
    v_mfma_f32_16x16x32_bf16 v[48:51], v[112:115], v[104:107], v[48:51]
    ds_read_b64_tr_b16 v[168:169], v214 offset:45056
    v_mfma_f32_16x16x32_bf16 v[52:55], v[116:119], v[104:107], v[52:55]
    ds_read_b64_tr_b16 v[170:171], v214 offset:45568
    v_mfma_f32_16x16x32_bf16 v[56:59], v[120:123], v[104:107], v[56:59]
    v_mfma_f32_16x16x32_bf16 v[60:63], v[124:127], v[104:107], v[60:63]
    ds_read_b64_tr_b16 v[172:173], v215 offset:45056
    v_mfma_f32_16x16x32_bf16 v[64:67], v[104:107], v[128:131], v[64:67]
    ds_read_b64_tr_b16 v[174:175], v215 offset:45568
    v_mfma_f32_16x16x32_bf16 v[68:71], v[104:107], v[132:135], v[68:71]
    v_mfma_f32_16x16x32_bf16 v[72:75], v[112:115], v[108:111], v[72:75]
    v_mfma_f32_16x16x32_bf16 v[76:79], v[116:119], v[108:111], v[76:79]
    v_mfma_f32_16x16x32_bf16 v[80:83], v[120:123], v[108:111], v[80:83]
    v_mfma_f32_16x16x32_bf16 v[84:87], v[124:127], v[108:111], v[84:87]
    v_mfma_f32_16x16x32_bf16 v[88:91], v[108:111], v[128:131], v[88:91]
    v_mfma_f32_16x16x32_bf16 v[92:95], v[108:111], v[132:135], v[92:95]
    s_waitcnt lgkmcnt(0)
    s_barrier
    v_mfma_f32_16x16x32_bf16 v[0:3], v[152:155], v[136:139], v[0:3]
    ds_read_b128 v[96:99], v212 offset:32768
    ds_read_b128 v[100:103], v212 offset:34816
    ds_read_b128 v[104:107], v212 offset:36864
    ds_read_b128 v[108:111], v212 offset:38912
    ds_read_b64_tr_b16 v[112:113], v216 offset:0
    v_mfma_f32_16x16x32_bf16 v[4:7], v[156:159], v[136:139], v[4:7]
    ds_read_b64_tr_b16 v[114:115], v216 offset:512
    v_mfma_f32_16x16x32_bf16 v[8:11], v[160:163], v[136:139], v[8:11]
    v_mfma_f32_16x16x32_bf16 v[12:15], v[164:167], v[136:139], v[12:15]
    ds_read_b64_tr_b16 v[116:117], v217 offset:0
    v_mfma_f32_16x16x32_bf16 v[16:19], v[136:139], v[168:171], v[16:19]
    ds_read_b64_tr_b16 v[118:119], v217 offset:512
    v_mfma_f32_16x16x32_bf16 v[20:23], v[136:139], v[172:175], v[20:23]
    v_mfma_f32_16x16x32_bf16 v[24:27], v[152:155], v[140:143], v[24:27]
    ds_read_b64_tr_b16 v[120:121], v216 offset:8192
    v_mfma_f32_16x16x32_bf16 v[28:31], v[156:159], v[140:143], v[28:31]
    ds_read_b64_tr_b16 v[122:123], v216 offset:8704
    v_mfma_f32_16x16x32_bf16 v[32:35], v[160:163], v[140:143], v[32:35]
    v_mfma_f32_16x16x32_bf16 v[36:39], v[164:167], v[140:143], v[36:39]
    ds_read_b64_tr_b16 v[124:125], v217 offset:8192
    v_mfma_f32_16x16x32_bf16 v[40:43], v[140:143], v[168:171], v[40:43]
    ds_read_b64_tr_b16 v[126:127], v217 offset:8704
    v_mfma_f32_16x16x32_bf16 v[44:47], v[140:143], v[172:175], v[44:47]
    v_mfma_f32_16x16x32_bf16 v[48:51], v[152:155], v[144:147], v[48:51]
    ds_read_b64_tr_b16 v[128:129], v216 offset:16384
    v_mfma_f32_16x16x32_bf16 v[52:55], v[156:159], v[144:147], v[52:55]
    ds_read_b64_tr_b16 v[130:131], v216 offset:16896
    v_mfma_f32_16x16x32_bf16 v[56:59], v[160:163], v[144:147], v[56:59]
    v_mfma_f32_16x16x32_bf16 v[60:63], v[164:167], v[144:147], v[60:63]
    ds_read_b64_tr_b16 v[132:133], v217 offset:16384
    v_mfma_f32_16x16x32_bf16 v[64:67], v[144:147], v[168:171], v[64:67]
    ds_read_b64_tr_b16 v[134:135], v217 offset:16896
    v_mfma_f32_16x16x32_bf16 v[68:71], v[144:147], v[172:175], v[68:71]
    v_mfma_f32_16x16x32_bf16 v[72:75], v[152:155], v[148:151], v[72:75]
    v_mfma_f32_16x16x32_bf16 v[76:79], v[156:159], v[148:151], v[76:79]
    v_mfma_f32_16x16x32_bf16 v[80:83], v[160:163], v[148:151], v[80:83]
    v_mfma_f32_16x16x32_bf16 v[84:87], v[164:167], v[148:151], v[84:87]
    v_mfma_f32_16x16x32_bf16 v[88:91], v[148:151], v[168:171], v[88:91]
    v_mfma_f32_16x16x32_bf16 v[92:95], v[148:151], v[172:175], v[92:95]
    s_waitcnt lgkmcnt(0)
    s_cmp_lg_u32 s47, 15
    s_cbranch_scc1 K1_SW12
    s_cmp_ge_u32 s32, 3
    s_cbranch_scc1 K1_SW12
    buffer_load_dword v220, v219, s[8:11], s48 offen
K1_SW12:
    v_mfma_f32_16x16x32_bf16 v[0:3], v[112:115], v[96:99], v[0:3]
    ds_read_b128 v[136:139], v213 offset:32768
    ds_read_b128 v[140:143], v213 offset:34816
    ds_read_b128 v[144:147], v213 offset:36864
    ds_read_b128 v[148:151], v213 offset:38912
    ds_read_b64_tr_b16 v[152:153], v216 offset:4096
    v_mfma_f32_16x16x32_bf16 v[4:7], v[116:119], v[96:99], v[4:7]
    ds_read_b64_tr_b16 v[154:155], v216 offset:4608
    v_mfma_f32_16x16x32_bf16 v[8:11], v[120:123], v[96:99], v[8:11]
    v_mfma_f32_16x16x32_bf16 v[12:15], v[124:127], v[96:99], v[12:15]
    ds_read_b64_tr_b16 v[156:157], v217 offset:4096
    v_mfma_f32_16x16x32_bf16 v[16:19], v[96:99], v[128:131], v[16:19]
    ds_read_b64_tr_b16 v[158:159], v217 offset:4608
    v_mfma_f32_16x16x32_bf16 v[20:23], v[96:99], v[132:135], v[20:23]
    v_mfma_f32_16x16x32_bf16 v[24:27], v[112:115], v[100:103], v[24:27]
    ds_read_b64_tr_b16 v[160:161], v216 offset:12288
    v_mfma_f32_16x16x32_bf16 v[28:31], v[116:119], v[100:103], v[28:31]
    ds_read_b64_tr_b16 v[162:163], v216 offset:12800
    v_mfma_f32_16x16x32_bf16 v[32:35], v[120:123], v[100:103], v[32:35]
    v_mfma_f32_16x16x32_bf16 v[36:39], v[124:127], v[100:103], v[36:39]
    ds_read_b64_tr_b16 v[164:165], v217 offset:12288
    v_mfma_f32_16x16x32_bf16 v[40:43], v[100:103], v[128:131], v[40:43]
    ds_read_b64_tr_b16 v[166:167], v217 offset:12800
    v_mfma_f32_16x16x32_bf16 v[44:47], v[100:103], v[132:135], v[44:47]
    v_mfma_f32_16x16x32_bf16 v[48:51], v[112:115], v[104:107], v[48:51]
    ds_read_b64_tr_b16 v[168:169], v216 offset:20480
    v_mfma_f32_16x16x32_bf16 v[52:55], v[116:119], v[104:107], v[52:55]
    ds_read_b64_tr_b16 v[170:171], v216 offset:20992
    v_mfma_f32_16x16x32_bf16 v[56:59], v[120:123], v[104:107], v[56:59]
    v_mfma_f32_16x16x32_bf16 v[60:63], v[124:127], v[104:107], v[60:63]
    ds_read_b64_tr_b16 v[172:173], v217 offset:20480
    v_mfma_f32_16x16x32_bf16 v[64:67], v[104:107], v[128:131], v[64:67]
    ds_read_b64_tr_b16 v[174:175], v217 offset:20992
    v_mfma_f32_16x16x32_bf16 v[68:71], v[104:107], v[132:135], v[68:71]
    v_mfma_f32_16x16x32_bf16 v[72:75], v[112:115], v[108:111], v[72:75]
    v_mfma_f32_16x16x32_bf16 v[76:79], v[116:119], v[108:111], v[76:79]
    v_mfma_f32_16x16x32_bf16 v[80:83], v[120:123], v[108:111], v[80:83]
    v_mfma_f32_16x16x32_bf16 v[84:87], v[124:127], v[108:111], v[84:87]
    v_mfma_f32_16x16x32_bf16 v[88:91], v[108:111], v[128:131], v[88:91]
    v_mfma_f32_16x16x32_bf16 v[92:95], v[108:111], v[132:135], v[92:95]
    s_waitcnt lgkmcnt(0)
    s_barrier
    v_mfma_f32_16x16x32_bf16 v[0:3], v[152:155], v[136:139], v[0:3]
    ds_read_b128 v[96:99], v212 offset:0
    ds_read_b128 v[100:103], v212 offset:2048
    ds_read_b128 v[104:107], v212 offset:4096
    ds_read_b128 v[108:111], v212 offset:6144
    ds_read_b64_tr_b16 v[112:113], v214 offset:0
    v_mfma_f32_16x16x32_bf16 v[4:7], v[156:159], v[136:139], v[4:7]
    ds_read_b64_tr_b16 v[114:115], v214 offset:512
    v_mfma_f32_16x16x32_bf16 v[8:11], v[160:163], v[136:139], v[8:11]
    v_mfma_f32_16x16x32_bf16 v[12:15], v[164:167], v[136:139], v[12:15]
    ds_read_b64_tr_b16 v[116:117], v215 offset:0
    v_mfma_f32_16x16x32_bf16 v[16:19], v[136:139], v[168:171], v[16:19]
    ds_read_b64_tr_b16 v[118:119], v215 offset:512
    v_mfma_f32_16x16x32_bf16 v[20:23], v[136:139], v[172:175], v[20:23]
    v_mfma_f32_16x16x32_bf16 v[24:27], v[152:155], v[140:143], v[24:27]
    ds_read_b64_tr_b16 v[120:121], v214 offset:8192
    v_mfma_f32_16x16x32_bf16 v[28:31], v[156:159], v[140:143], v[28:31]
    ds_read_b64_tr_b16 v[122:123], v214 offset:8704
    v_mfma_f32_16x16x32_bf16 v[32:35], v[160:163], v[140:143], v[32:35]
    v_mfma_f32_16x16x32_bf16 v[36:39], v[164:167], v[140:143], v[36:39]
    ds_read_b64_tr_b16 v[124:125], v215 offset:8192
    v_mfma_f32_16x16x32_bf16 v[40:43], v[140:143], v[168:171], v[40:43]
    ds_read_b64_tr_b16 v[126:127], v215 offset:8704
    v_mfma_f32_16x16x32_bf16 v[44:47], v[140:143], v[172:175], v[44:47]
    v_mfma_f32_16x16x32_bf16 v[48:51], v[152:155], v[144:147], v[48:51]
    ds_read_b64_tr_b16 v[128:129], v214 offset:16384
    v_mfma_f32_16x16x32_bf16 v[52:55], v[156:159], v[144:147], v[52:55]
    ds_read_b64_tr_b16 v[130:131], v214 offset:16896
    v_mfma_f32_16x16x32_bf16 v[56:59], v[160:163], v[144:147], v[56:59]
    v_mfma_f32_16x16x32_bf16 v[60:63], v[164:167], v[144:147], v[60:63]
    ds_read_b64_tr_b16 v[132:133], v215 offset:16384
    v_mfma_f32_16x16x32_bf16 v[64:67], v[144:147], v[168:171], v[64:67]
    ds_read_b64_tr_b16 v[134:135], v215 offset:16896
    v_mfma_f32_16x16x32_bf16 v[68:71], v[144:147], v[172:175], v[68:71]
    v_mfma_f32_16x16x32_bf16 v[72:75], v[152:155], v[148:151], v[72:75]
    v_mfma_f32_16x16x32_bf16 v[76:79], v[156:159], v[148:151], v[76:79]
    v_mfma_f32_16x16x32_bf16 v[80:83], v[160:163], v[148:151], v[80:83]
    v_mfma_f32_16x16x32_bf16 v[84:87], v[164:167], v[148:151], v[84:87]
    v_mfma_f32_16x16x32_bf16 v[88:91], v[148:151], v[168:171], v[88:91]
    v_mfma_f32_16x16x32_bf16 v[92:95], v[148:151], v[172:175], v[92:95]
    s_waitcnt lgkmcnt(0)
    v_mfma_f32_16x16x32_bf16 v[0:3], v[112:115], v[96:99], v[0:3]
    ds_read_b128 v[136:139], v213 offset:0
    ds_read_b128 v[140:143], v213 offset:2048
    ds_read_b128 v[144:147], v213 offset:4096
    ds_read_b128 v[148:151], v213 offset:6144
    ds_read_b64_tr_b16 v[152:153], v214 offset:4096
    v_mfma_f32_16x16x32_bf16 v[4:7], v[116:119], v[96:99], v[4:7]
    ds_read_b64_tr_b16 v[154:155], v214 offset:4608
    v_mfma_f32_16x16x32_bf16 v[8:11], v[120:123], v[96:99], v[8:11]
    v_mfma_f32_16x16x32_bf16 v[12:15], v[124:127], v[96:99], v[12:15]
    ds_read_b64_tr_b16 v[156:157], v215 offset:4096
    v_mfma_f32_16x16x32_bf16 v[16:19], v[96:99], v[128:131], v[16:19]
    ds_read_b64_tr_b16 v[158:159], v215 offset:4608
    v_mfma_f32_16x16x32_bf16 v[20:23], v[96:99], v[132:135], v[20:23]
    v_mfma_f32_16x16x32_bf16 v[24:27], v[112:115], v[100:103], v[24:27]
    ds_read_b64_tr_b16 v[160:161], v214 offset:12288
    v_mfma_f32_16x16x32_bf16 v[28:31], v[116:119], v[100:103], v[28:31]
    ds_read_b64_tr_b16 v[162:163], v214 offset:12800
    v_mfma_f32_16x16x32_bf16 v[32:35], v[120:123], v[100:103], v[32:35]
    v_mfma_f32_16x16x32_bf16 v[36:39], v[124:127], v[100:103], v[36:39]
    ds_read_b64_tr_b16 v[164:165], v215 offset:12288
    v_mfma_f32_16x16x32_bf16 v[40:43], v[100:103], v[128:131], v[40:43]
    ds_read_b64_tr_b16 v[166:167], v215 offset:12800
    v_mfma_f32_16x16x32_bf16 v[44:47], v[100:103], v[132:135], v[44:47]
    v_mfma_f32_16x16x32_bf16 v[48:51], v[112:115], v[104:107], v[48:51]
    ds_read_b64_tr_b16 v[168:169], v214 offset:20480
    v_mfma_f32_16x16x32_bf16 v[52:55], v[116:119], v[104:107], v[52:55]
    ds_read_b64_tr_b16 v[170:171], v214 offset:20992
    v_mfma_f32_16x16x32_bf16 v[56:59], v[120:123], v[104:107], v[56:59]
    v_mfma_f32_16x16x32_bf16 v[60:63], v[124:127], v[104:107], v[60:63]
    ds_read_b64_tr_b16 v[172:173], v215 offset:20480
    v_mfma_f32_16x16x32_bf16 v[64:67], v[104:107], v[128:131], v[64:67]
    ds_read_b64_tr_b16 v[174:175], v215 offset:20992
    v_mfma_f32_16x16x32_bf16 v[68:71], v[104:107], v[132:135], v[68:71]
    v_mfma_f32_16x16x32_bf16 v[72:75], v[112:115], v[108:111], v[72:75]
    v_mfma_f32_16x16x32_bf16 v[76:79], v[116:119], v[108:111], v[76:79]
    v_mfma_f32_16x16x32_bf16 v[80:83], v[120:123], v[108:111], v[80:83]
    v_mfma_f32_16x16x32_bf16 v[84:87], v[124:127], v[108:111], v[84:87]
    v_mfma_f32_16x16x32_bf16 v[88:91], v[108:111], v[128:131], v[88:91]
    v_mfma_f32_16x16x32_bf16 v[92:95], v[108:111], v[132:135], v[92:95]
    s_waitcnt lgkmcnt(0)
    s_barrier
    v_mfma_f32_16x16x32_bf16 v[0:3], v[152:155], v[136:139], v[0:3]
    ds_read_b128 v[96:99], v212 offset:16384
    ds_read_b128 v[100:103], v212 offset:18432
    ds_read_b128 v[104:107], v212 offset:20480
    ds_read_b128 v[108:111], v212 offset:22528
    ds_read_b64_tr_b16 v[112:113], v214 offset:24576
    v_mfma_f32_16x16x32_bf16 v[4:7], v[156:159], v[136:139], v[4:7]
    ds_read_b64_tr_b16 v[114:115], v214 offset:25088
    v_mfma_f32_16x16x32_bf16 v[8:11], v[160:163], v[136:139], v[8:11]
    v_mfma_f32_16x16x32_bf16 v[12:15], v[164:167], v[136:139], v[12:15]
    ds_read_b64_tr_b16 v[116:117], v215 offset:24576
    v_mfma_f32_16x16x32_bf16 v[16:19], v[136:139], v[168:171], v[16:19]
    ds_read_b64_tr_b16 v[118:119], v215 offset:25088
    v_mfma_f32_16x16x32_bf16 v[20:23], v[136:139], v[172:175], v[20:23]
    v_mfma_f32_16x16x32_bf16 v[24:27], v[152:155], v[140:143], v[24:27]
    ds_read_b64_tr_b16 v[120:121], v214 offset:32768
    v_mfma_f32_16x16x32_bf16 v[28:31], v[156:159], v[140:143], v[28:31]
    ds_read_b64_tr_b16 v[122:123], v214 offset:33280
    v_mfma_f32_16x16x32_bf16 v[32:35], v[160:163], v[140:143], v[32:35]
    v_mfma_f32_16x16x32_bf16 v[36:39], v[164:167], v[140:143], v[36:39]
    ds_read_b64_tr_b16 v[124:125], v215 offset:32768
    v_mfma_f32_16x16x32_bf16 v[40:43], v[140:143], v[168:171], v[40:43]
    ds_read_b64_tr_b16 v[126:127], v215 offset:33280
    v_mfma_f32_16x16x32_bf16 v[44:47], v[140:143], v[172:175], v[44:47]
    v_mfma_f32_16x16x32_bf16 v[48:51], v[152:155], v[144:147], v[48:51]
    ds_read_b64_tr_b16 v[128:129], v214 offset:40960
    v_mfma_f32_16x16x32_bf16 v[52:55], v[156:159], v[144:147], v[52:55]
    ds_read_b64_tr_b16 v[130:131], v214 offset:41472
    v_mfma_f32_16x16x32_bf16 v[56:59], v[160:163], v[144:147], v[56:59]
    v_mfma_f32_16x16x32_bf16 v[60:63], v[164:167], v[144:147], v[60:63]
    ds_read_b64_tr_b16 v[132:133], v215 offset:40960
    v_mfma_f32_16x16x32_bf16 v[64:67], v[144:147], v[168:171], v[64:67]
    ds_read_b64_tr_b16 v[134:135], v215 offset:41472
    v_mfma_f32_16x16x32_bf16 v[68:71], v[144:147], v[172:175], v[68:71]
    v_mfma_f32_16x16x32_bf16 v[72:75], v[152:155], v[148:151], v[72:75]
    v_mfma_f32_16x16x32_bf16 v[76:79], v[156:159], v[148:151], v[76:79]
    v_mfma_f32_16x16x32_bf16 v[80:83], v[160:163], v[148:151], v[80:83]
    v_mfma_f32_16x16x32_bf16 v[84:87], v[164:167], v[148:151], v[84:87]
    v_mfma_f32_16x16x32_bf16 v[88:91], v[148:151], v[168:171], v[88:91]
    v_mfma_f32_16x16x32_bf16 v[92:95], v[148:151], v[172:175], v[92:95]
    s_waitcnt lgkmcnt(0)
    s_mov_b32 s52, s58
    s_and_b32 s53, s59, 0xffff
    s_mov_b32 s54, 2097152
    s_mov_b32 s55, 0x00020000
    s_cmp_ge_u32 s32, 1
    s_cbranch_scc1 K1_SW13
    s_lshl_b32 s42, s2, 13
    buffer_load_dword v220, v218, s[52:55], s42 offen
K1_SW13:
    v_mfma_f32_16x16x32_bf16 v[0:3], v[112:115], v[96:99], v[0:3]
    ds_read_b128 v[136:139], v213 offset:16384
    ds_read_b128 v[140:143], v213 offset:18432
    ds_read_b128 v[144:147], v213 offset:20480
    ds_read_b128 v[148:151], v213 offset:22528
    ds_read_b64_tr_b16 v[152:153], v214 offset:28672
    v_mfma_f32_16x16x32_bf16 v[4:7], v[116:119], v[96:99], v[4:7]
    ds_read_b64_tr_b16 v[154:155], v214 offset:29184
    v_mfma_f32_16x16x32_bf16 v[8:11], v[120:123], v[96:99], v[8:11]
    v_mfma_f32_16x16x32_bf16 v[12:15], v[124:127], v[96:99], v[12:15]
    ds_read_b64_tr_b16 v[156:157], v215 offset:28672
    v_mfma_f32_16x16x32_bf16 v[16:19], v[96:99], v[128:131], v[16:19]
    ds_read_b64_tr_b16 v[158:159], v215 offset:29184
    v_mfma_f32_16x16x32_bf16 v[20:23], v[96:99], v[132:135], v[20:23]
    v_mfma_f32_16x16x32_bf16 v[24:27], v[112:115], v[100:103], v[24:27]
    ds_read_b64_tr_b16 v[160:161], v214 offset:36864
    v_mfma_f32_16x16x32_bf16 v[28:31], v[116:119], v[100:103], v[28:31]
    ds_read_b64_tr_b16 v[162:163], v214 offset:37376
    v_mfma_f32_16x16x32_bf16 v[32:35], v[120:123], v[100:103], v[32:35]
    v_mfma_f32_16x16x32_bf16 v[36:39], v[124:127], v[100:103], v[36:39]
    ds_read_b64_tr_b16 v[164:165], v215 offset:36864
    v_mfma_f32_16x16x32_bf16 v[40:43], v[100:103], v[128:131], v[40:43]
    ds_read_b64_tr_b16 v[166:167], v215 offset:37376
    v_mfma_f32_16x16x32_bf16 v[44:47], v[100:103], v[132:135], v[44:47]
    v_mfma_f32_16x16x32_bf16 v[48:51], v[112:115], v[104:107], v[48:51]
    ds_read_b64_tr_b16 v[168:169], v214 offset:45056
    v_mfma_f32_16x16x32_bf16 v[52:55], v[116:119], v[104:107], v[52:55]
    ds_read_b64_tr_b16 v[170:171], v214 offset:45568
    v_mfma_f32_16x16x32_bf16 v[56:59], v[120:123], v[104:107], v[56:59]
    v_mfma_f32_16x16x32_bf16 v[60:63], v[124:127], v[104:107], v[60:63]
    ds_read_b64_tr_b16 v[172:173], v215 offset:45056
    v_mfma_f32_16x16x32_bf16 v[64:67], v[104:107], v[128:131], v[64:67]
    ds_read_b64_tr_b16 v[174:175], v215 offset:45568
    v_mfma_f32_16x16x32_bf16 v[68:71], v[104:107], v[132:135], v[68:71]
    v_mfma_f32_16x16x32_bf16 v[72:75], v[112:115], v[108:111], v[72:75]
    v_mfma_f32_16x16x32_bf16 v[76:79], v[116:119], v[108:111], v[76:79]
    v_mfma_f32_16x16x32_bf16 v[80:83], v[120:123], v[108:111], v[80:83]
    v_mfma_f32_16x16x32_bf16 v[84:87], v[124:127], v[108:111], v[84:87]
    v_mfma_f32_16x16x32_bf16 v[88:91], v[108:111], v[128:131], v[88:91]
    v_mfma_f32_16x16x32_bf16 v[92:95], v[108:111], v[132:135], v[92:95]
    s_waitcnt lgkmcnt(0)
    s_barrier
    v_mfma_f32_16x16x32_bf16 v[0:3], v[152:155], v[136:139], v[0:3]
    ds_read_b128 v[96:99], v212 offset:32768
    ds_read_b128 v[100:103], v212 offset:34816
    ds_read_b128 v[104:107], v212 offset:36864
    ds_read_b128 v[108:111], v212 offset:38912
    ds_read_b64_tr_b16 v[112:113], v216 offset:0
    v_mfma_f32_16x16x32_bf16 v[4:7], v[156:159], v[136:139], v[4:7]
    ds_read_b64_tr_b16 v[114:115], v216 offset:512
    v_mfma_f32_16x16x32_bf16 v[8:11], v[160:163], v[136:139], v[8:11]
    v_mfma_f32_16x16x32_bf16 v[12:15], v[164:167], v[136:139], v[12:15]
    ds_read_b64_tr_b16 v[116:117], v217 offset:0
    v_mfma_f32_16x16x32_bf16 v[16:19], v[136:139], v[168:171], v[16:19]
    ds_read_b64_tr_b16 v[118:119], v217 offset:512
    v_mfma_f32_16x16x32_bf16 v[20:23], v[136:139], v[172:175], v[20:23]
    v_mfma_f32_16x16x32_bf16 v[24:27], v[152:155], v[140:143], v[24:27]
    ds_read_b64_tr_b16 v[120:121], v216 offset:8192
    v_mfma_f32_16x16x32_bf16 v[28:31], v[156:159], v[140:143], v[28:31]
    ds_read_b64_tr_b16 v[122:123], v216 offset:8704
    v_mfma_f32_16x16x32_bf16 v[32:35], v[160:163], v[140:143], v[32:35]
    v_mfma_f32_16x16x32_bf16 v[36:39], v[164:167], v[140:143], v[36:39]
    ds_read_b64_tr_b16 v[124:125], v217 offset:8192
    v_mfma_f32_16x16x32_bf16 v[40:43], v[140:143], v[168:171], v[40:43]
    ds_read_b64_tr_b16 v[126:127], v217 offset:8704
    v_mfma_f32_16x16x32_bf16 v[44:47], v[140:143], v[172:175], v[44:47]
    v_mfma_f32_16x16x32_bf16 v[48:51], v[152:155], v[144:147], v[48:51]
    ds_read_b64_tr_b16 v[128:129], v216 offset:16384
    v_mfma_f32_16x16x32_bf16 v[52:55], v[156:159], v[144:147], v[52:55]
    ds_read_b64_tr_b16 v[130:131], v216 offset:16896
    v_mfma_f32_16x16x32_bf16 v[56:59], v[160:163], v[144:147], v[56:59]
    v_mfma_f32_16x16x32_bf16 v[60:63], v[164:167], v[144:147], v[60:63]
    ds_read_b64_tr_b16 v[132:133], v217 offset:16384
    v_mfma_f32_16x16x32_bf16 v[64:67], v[144:147], v[168:171], v[64:67]
    ds_read_b64_tr_b16 v[134:135], v217 offset:16896
    v_mfma_f32_16x16x32_bf16 v[68:71], v[144:147], v[172:175], v[68:71]
    v_mfma_f32_16x16x32_bf16 v[72:75], v[152:155], v[148:151], v[72:75]
    v_mfma_f32_16x16x32_bf16 v[76:79], v[156:159], v[148:151], v[76:79]
    v_mfma_f32_16x16x32_bf16 v[80:83], v[160:163], v[148:151], v[80:83]
    v_mfma_f32_16x16x32_bf16 v[84:87], v[164:167], v[148:151], v[84:87]
    v_mfma_f32_16x16x32_bf16 v[88:91], v[148:151], v[168:171], v[88:91]
    v_mfma_f32_16x16x32_bf16 v[92:95], v[148:151], v[172:175], v[92:95]
    s_waitcnt lgkmcnt(0)
    v_mfma_f32_16x16x32_bf16 v[0:3], v[112:115], v[96:99], v[0:3]
    ds_read_b128 v[136:139], v213 offset:32768
    ds_read_b128 v[140:143], v213 offset:34816
    ds_read_b128 v[144:147], v213 offset:36864
    ds_read_b128 v[148:151], v213 offset:38912
    ds_read_b64_tr_b16 v[152:153], v216 offset:4096
    v_mfma_f32_16x16x32_bf16 v[4:7], v[116:119], v[96:99], v[4:7]
    ds_read_b64_tr_b16 v[154:155], v216 offset:4608
    v_mfma_f32_16x16x32_bf16 v[8:11], v[120:123], v[96:99], v[8:11]
    v_mfma_f32_16x16x32_bf16 v[12:15], v[124:127], v[96:99], v[12:15]
    ds_read_b64_tr_b16 v[156:157], v217 offset:4096
    v_mfma_f32_16x16x32_bf16 v[16:19], v[96:99], v[128:131], v[16:19]
    ds_read_b64_tr_b16 v[158:159], v217 offset:4608
    v_mfma_f32_16x16x32_bf16 v[20:23], v[96:99], v[132:135], v[20:23]
    v_mfma_f32_16x16x32_bf16 v[24:27], v[112:115], v[100:103], v[24:27]
    ds_read_b64_tr_b16 v[160:161], v216 offset:12288
    v_mfma_f32_16x16x32_bf16 v[28:31], v[116:119], v[100:103], v[28:31]
    ds_read_b64_tr_b16 v[162:163], v216 offset:12800
    v_mfma_f32_16x16x32_bf16 v[32:35], v[120:123], v[100:103], v[32:35]
    v_mfma_f32_16x16x32_bf16 v[36:39], v[124:127], v[100:103], v[36:39]
    ds_read_b64_tr_b16 v[164:165], v217 offset:12288
    v_mfma_f32_16x16x32_bf16 v[40:43], v[100:103], v[128:131], v[40:43]
    ds_read_b64_tr_b16 v[166:167], v217 offset:12800
    v_mfma_f32_16x16x32_bf16 v[44:47], v[100:103], v[132:135], v[44:47]
    v_mfma_f32_16x16x32_bf16 v[48:51], v[112:115], v[104:107], v[48:51]
    ds_read_b64_tr_b16 v[168:169], v216 offset:20480
    v_mfma_f32_16x16x32_bf16 v[52:55], v[116:119], v[104:107], v[52:55]
    ds_read_b64_tr_b16 v[170:171], v216 offset:20992
    v_mfma_f32_16x16x32_bf16 v[56:59], v[120:123], v[104:107], v[56:59]
    v_mfma_f32_16x16x32_bf16 v[60:63], v[124:127], v[104:107], v[60:63]
    ds_read_b64_tr_b16 v[172:173], v217 offset:20480
    v_mfma_f32_16x16x32_bf16 v[64:67], v[104:107], v[128:131], v[64:67]
    ds_read_b64_tr_b16 v[174:175], v217 offset:20992
    v_mfma_f32_16x16x32_bf16 v[68:71], v[104:107], v[132:135], v[68:71]
    v_mfma_f32_16x16x32_bf16 v[72:75], v[112:115], v[108:111], v[72:75]
    v_mfma_f32_16x16x32_bf16 v[76:79], v[116:119], v[108:111], v[76:79]
    v_mfma_f32_16x16x32_bf16 v[80:83], v[120:123], v[108:111], v[80:83]
    v_mfma_f32_16x16x32_bf16 v[84:87], v[124:127], v[108:111], v[84:87]
    v_mfma_f32_16x16x32_bf16 v[88:91], v[108:111], v[128:131], v[88:91]
    v_mfma_f32_16x16x32_bf16 v[92:95], v[108:111], v[132:135], v[92:95]
    s_waitcnt lgkmcnt(0)
    s_barrier
    v_mfma_f32_16x16x32_bf16 v[0:3], v[152:155], v[136:139], v[0:3]
    ds_read_b128 v[96:99], v212 offset:0
    ds_read_b128 v[100:103], v212 offset:2048
    ds_read_b128 v[104:107], v212 offset:4096
    ds_read_b128 v[108:111], v212 offset:6144
    ds_read_b64_tr_b16 v[112:113], v214 offset:0
    v_mfma_f32_16x16x32_bf16 v[4:7], v[156:159], v[136:139], v[4:7]
    ds_read_b64_tr_b16 v[114:115], v214 offset:512
    v_mfma_f32_16x16x32_bf16 v[8:11], v[160:163], v[136:139], v[8:11]
    v_mfma_f32_16x16x32_bf16 v[12:15], v[164:167], v[136:139], v[12:15]
    ds_read_b64_tr_b16 v[116:117], v215 offset:0
    v_mfma_f32_16x16x32_bf16 v[16:19], v[136:139], v[168:171], v[16:19]
    ds_read_b64_tr_b16 v[118:119], v215 offset:512
    v_mfma_f32_16x16x32_bf16 v[20:23], v[136:139], v[172:175], v[20:23]
    v_mfma_f32_16x16x32_bf16 v[24:27], v[152:155], v[140:143], v[24:27]
    ds_read_b64_tr_b16 v[120:121], v214 offset:8192
    v_mfma_f32_16x16x32_bf16 v[28:31], v[156:159], v[140:143], v[28:31]
    ds_read_b64_tr_b16 v[122:123], v214 offset:8704
    v_mfma_f32_16x16x32_bf16 v[32:35], v[160:163], v[140:143], v[32:35]
    v_mfma_f32_16x16x32_bf16 v[36:39], v[164:167], v[140:143], v[36:39]
    ds_read_b64_tr_b16 v[124:125], v215 offset:8192
    v_mfma_f32_16x16x32_bf16 v[40:43], v[140:143], v[168:171], v[40:43]
    ds_read_b64_tr_b16 v[126:127], v215 offset:8704
    v_mfma_f32_16x16x32_bf16 v[44:47], v[140:143], v[172:175], v[44:47]
    v_mfma_f32_16x16x32_bf16 v[48:51], v[152:155], v[144:147], v[48:51]
    ds_read_b64_tr_b16 v[128:129], v214 offset:16384
    v_mfma_f32_16x16x32_bf16 v[52:55], v[156:159], v[144:147], v[52:55]
    ds_read_b64_tr_b16 v[130:131], v214 offset:16896
    v_mfma_f32_16x16x32_bf16 v[56:59], v[160:163], v[144:147], v[56:59]
    v_mfma_f32_16x16x32_bf16 v[60:63], v[164:167], v[144:147], v[60:63]
    ds_read_b64_tr_b16 v[132:133], v215 offset:16384
    v_mfma_f32_16x16x32_bf16 v[64:67], v[144:147], v[168:171], v[64:67]
    ds_read_b64_tr_b16 v[134:135], v215 offset:16896
    v_mfma_f32_16x16x32_bf16 v[68:71], v[144:147], v[172:175], v[68:71]
    v_mfma_f32_16x16x32_bf16 v[72:75], v[152:155], v[148:151], v[72:75]
    v_mfma_f32_16x16x32_bf16 v[76:79], v[156:159], v[148:151], v[76:79]
    v_mfma_f32_16x16x32_bf16 v[80:83], v[160:163], v[148:151], v[80:83]
    v_mfma_f32_16x16x32_bf16 v[84:87], v[164:167], v[148:151], v[84:87]
    v_mfma_f32_16x16x32_bf16 v[88:91], v[148:151], v[168:171], v[88:91]
    v_mfma_f32_16x16x32_bf16 v[92:95], v[148:151], v[172:175], v[92:95]
    s_waitcnt lgkmcnt(0)
    v_mfma_f32_16x16x32_bf16 v[0:3], v[112:115], v[96:99], v[0:3]
    ds_read_b128 v[136:139], v213 offset:0
    ds_read_b128 v[140:143], v213 offset:2048
    ds_read_b128 v[144:147], v213 offset:4096
    ds_read_b128 v[148:151], v213 offset:6144
    ds_read_b64_tr_b16 v[152:153], v214 offset:4096
    v_mfma_f32_16x16x32_bf16 v[4:7], v[116:119], v[96:99], v[4:7]
    ds_read_b64_tr_b16 v[154:155], v214 offset:4608
    v_mfma_f32_16x16x32_bf16 v[8:11], v[120:123], v[96:99], v[8:11]
    v_mfma_f32_16x16x32_bf16 v[12:15], v[124:127], v[96:99], v[12:15]
    ds_read_b64_tr_b16 v[156:157], v215 offset:4096
    v_mfma_f32_16x16x32_bf16 v[16:19], v[96:99], v[128:131], v[16:19]
    ds_read_b64_tr_b16 v[158:159], v215 offset:4608
    v_mfma_f32_16x16x32_bf16 v[20:23], v[96:99], v[132:135], v[20:23]
    v_mfma_f32_16x16x32_bf16 v[24:27], v[112:115], v[100:103], v[24:27]
    ds_read_b64_tr_b16 v[160:161], v214 offset:12288
    v_mfma_f32_16x16x32_bf16 v[28:31], v[116:119], v[100:103], v[28:31]
    ds_read_b64_tr_b16 v[162:163], v214 offset:12800
    v_mfma_f32_16x16x32_bf16 v[32:35], v[120:123], v[100:103], v[32:35]
    v_mfma_f32_16x16x32_bf16 v[36:39], v[124:127], v[100:103], v[36:39]
    ds_read_b64_tr_b16 v[164:165], v215 offset:12288
    v_mfma_f32_16x16x32_bf16 v[40:43], v[100:103], v[128:131], v[40:43]
    ds_read_b64_tr_b16 v[166:167], v215 offset:12800
    v_mfma_f32_16x16x32_bf16 v[44:47], v[100:103], v[132:135], v[44:47]
    v_mfma_f32_16x16x32_bf16 v[48:51], v[112:115], v[104:107], v[48:51]
    ds_read_b64_tr_b16 v[168:169], v214 offset:20480
    v_mfma_f32_16x16x32_bf16 v[52:55], v[116:119], v[104:107], v[52:55]
    ds_read_b64_tr_b16 v[170:171], v214 offset:20992
    v_mfma_f32_16x16x32_bf16 v[56:59], v[120:123], v[104:107], v[56:59]
    v_mfma_f32_16x16x32_bf16 v[60:63], v[124:127], v[104:107], v[60:63]
    ds_read_b64_tr_b16 v[172:173], v215 offset:20480
    v_mfma_f32_16x16x32_bf16 v[64:67], v[104:107], v[128:131], v[64:67]
    ds_read_b64_tr_b16 v[174:175], v215 offset:20992
    v_mfma_f32_16x16x32_bf16 v[68:71], v[104:107], v[132:135], v[68:71]
    v_mfma_f32_16x16x32_bf16 v[72:75], v[112:115], v[108:111], v[72:75]
    v_mfma_f32_16x16x32_bf16 v[76:79], v[116:119], v[108:111], v[76:79]
    v_mfma_f32_16x16x32_bf16 v[80:83], v[120:123], v[108:111], v[80:83]
    v_mfma_f32_16x16x32_bf16 v[84:87], v[124:127], v[108:111], v[84:87]
    v_mfma_f32_16x16x32_bf16 v[88:91], v[108:111], v[128:131], v[88:91]
    v_mfma_f32_16x16x32_bf16 v[92:95], v[108:111], v[132:135], v[92:95]
    s_waitcnt lgkmcnt(0)
    v_mfma_f32_16x16x32_bf16 v[0:3], v[152:155], v[136:139], v[0:3]
    v_mfma_f32_16x16x32_bf16 v[4:7], v[156:159], v[136:139], v[4:7]
    v_mfma_f32_16x16x32_bf16 v[8:11], v[160:163], v[136:139], v[8:11]
    v_mfma_f32_16x16x32_bf16 v[12:15], v[164:167], v[136:139], v[12:15]
    v_mfma_f32_16x16x32_bf16 v[16:19], v[136:139], v[168:171], v[16:19]
    v_mfma_f32_16x16x32_bf16 v[20:23], v[136:139], v[172:175], v[20:23]
    v_mfma_f32_16x16x32_bf16 v[24:27], v[152:155], v[140:143], v[24:27]
    v_mfma_f32_16x16x32_bf16 v[28:31], v[156:159], v[140:143], v[28:31]
    v_mfma_f32_16x16x32_bf16 v[32:35], v[160:163], v[140:143], v[32:35]
    v_mfma_f32_16x16x32_bf16 v[36:39], v[164:167], v[140:143], v[36:39]
    v_mfma_f32_16x16x32_bf16 v[40:43], v[140:143], v[168:171], v[40:43]
    v_mfma_f32_16x16x32_bf16 v[44:47], v[140:143], v[172:175], v[44:47]
    v_mfma_f32_16x16x32_bf16 v[48:51], v[152:155], v[144:147], v[48:51]
    v_mfma_f32_16x16x32_bf16 v[52:55], v[156:159], v[144:147], v[52:55]
    v_mfma_f32_16x16x32_bf16 v[56:59], v[160:163], v[144:147], v[56:59]
    v_mfma_f32_16x16x32_bf16 v[60:63], v[164:167], v[144:147], v[60:63]
    v_mfma_f32_16x16x32_bf16 v[64:67], v[144:147], v[168:171], v[64:67]
    v_mfma_f32_16x16x32_bf16 v[68:71], v[144:147], v[172:175], v[68:71]
    v_mfma_f32_16x16x32_bf16 v[72:75], v[152:155], v[148:151], v[72:75]
    v_mfma_f32_16x16x32_bf16 v[76:79], v[156:159], v[148:151], v[76:79]
    v_mfma_f32_16x16x32_bf16 v[80:83], v[160:163], v[148:151], v[80:83]
    v_mfma_f32_16x16x32_bf16 v[84:87], v[164:167], v[148:151], v[84:87]
    v_mfma_f32_16x16x32_bf16 v[88:91], v[148:151], v[168:171], v[88:91]
    v_mfma_f32_16x16x32_bf16 v[92:95], v[148:151], v[172:175], v[92:95]
    s_waitcnt lgkmcnt(0)
    s_barrier
    s_nop 3
    s_lshl_b32 s42, s44, 7
    s_lshl_b32 s43, s35, 3
    s_add_u32 s42, s42, s43
    s_lshl_b32 s43, s33, 2
    s_add_u32 s42, s42, s43
    s_lshl_b32 s42, s42, 10
    s_add_u32 s42, s42, 8388608
    v_lshlrev_b32 v201, 4, v200
    v_add_u32 v201, s42, v201
    v_cvt_pk_bf16_f32 v136, v0, v1
    v_cvt_pk_bf16_f32 v137, v2, v3
    v_cvt_pk_bf16_f32 v138, v4, v5
    v_cvt_pk_bf16_f32 v139, v6, v7
    buffer_store_dwordx4 v[136:139], v201, s[12:15], 0 offen offset:0
    v_cvt_pk_bf16_f32 v140, v24, v25
    v_cvt_pk_bf16_f32 v141, v26, v27
    v_cvt_pk_bf16_f32 v142, v28, v29
    v_cvt_pk_bf16_f32 v143, v30, v31
    buffer_store_dwordx4 v[140:143], v201, s[12:15], 0 offen offset:1024
    v_cvt_pk_bf16_f32 v144, v48, v49
    v_cvt_pk_bf16_f32 v145, v50, v51
    v_cvt_pk_bf16_f32 v146, v52, v53
    v_cvt_pk_bf16_f32 v147, v54, v55
    buffer_store_dwordx4 v[144:147], v201, s[12:15], 0 offen offset:2048
    v_cvt_pk_bf16_f32 v148, v72, v73
    v_cvt_pk_bf16_f32 v149, v74, v75
    v_cvt_pk_bf16_f32 v150, v76, v77
    v_cvt_pk_bf16_f32 v151, v78, v79
    buffer_store_dwordx4 v[148:151], v201, s[12:15], 0 offen offset:3072
    v_cvt_pk_bf16_f32 v96, v16, v17
    v_cvt_pk_bf16_f32 v97, v18, v19
    v_cvt_pk_bf16_f32 v98, v40, v41
    v_cvt_pk_bf16_f32 v99, v42, v43
    v_cvt_pk_bf16_f32 v100, v20, v21
    v_cvt_pk_bf16_f32 v101, v22, v23
    v_cvt_pk_bf16_f32 v102, v44, v45
    v_cvt_pk_bf16_f32 v103, v46, v47
    v_cvt_pk_bf16_f32 v104, v64, v65
    v_cvt_pk_bf16_f32 v105, v66, v67
    v_cvt_pk_bf16_f32 v106, v88, v89
    v_cvt_pk_bf16_f32 v107, v90, v91
    v_cvt_pk_bf16_f32 v108, v68, v69
    v_cvt_pk_bf16_f32 v109, v70, v71
    v_cvt_pk_bf16_f32 v110, v92, v93
    v_cvt_pk_bf16_f32 v111, v94, v95
    v_mov_b32 v168, 0x3f803f80
    v_mov_b32 v169, 0x3f803f80
    v_mov_b32 v170, 0x3f803f80
    v_mov_b32 v171, 0x3f803f80
    s_mul_i32 s42, s32, 10240
    v_and_b32 v204, 15, v200
    s_movk_i32 s43, 160
    v_mul_lo_u32 v202, v204, s43
    v_lshrrev_b32 v204, 4, v200
    v_lshlrev_b32 v205, 3, v204
    v_add_u32 v202, v202, v205
    v_add_u32 v202, s42, v202
    v_lshrrev_b32 v204, 2, v200
    v_mul_lo_u32 v203, v204, s43
    v_and_b32 v204, 3, v200
    v_lshlrev_b32 v204, 3, v204
    v_add_u32 v203, v203, v204
    v_add_u32 v203, s42, v203
    v_cvt_pk_bf16_f32 v112, v8, v9
    v_cvt_pk_bf16_f32 v113, v10, v11
    v_cvt_pk_bf16_f32 v114, v12, v13
    v_cvt_pk_bf16_f32 v115, v14, v15
    s_nop 1
    v_mfma_f32_16x16x32_bf16 v[116:119], v[176:179], v[112:115], 0
    v_mfma_f32_16x16x32_bf16 v[120:123], v[180:183], v[112:115], 0
    s_nop 8
    v_cvt_pk_bf16_f32 v136, 0, v116
    v_cvt_pk_bf16_f32 v137, 0, v117
    v_cvt_pk_bf16_f32 v138, 0, v118
    v_cvt_pk_bf16_f32 v139, 0, v119
    v_cvt_pk_bf16_f32 v140, 0, v120
    v_cvt_pk_bf16_f32 v141, 0, v121
    v_cvt_pk_bf16_f32 v142, 0, v122
    v_cvt_pk_bf16_f32 v143, 0, v123
    v_max3_f32 v160, v136, v137, v138
    v_min3_f32 v161, v136, v137, v138
    v_max3_f32 v160, v160, v139, v140
    v_min3_f32 v161, v161, v139, v140
    v_max3_f32 v160, v160, v141, v142
    v_min3_f32 v161, v161, v141, v142
    v_max_f32 v160, v160, v143
    v_min_f32 v161, v161, v143
    v_sub_f32 v161, 0, v161
    s_nop 1
    v_permlane16_swap_b32 v160, v161
    v_max_f32 v162, v160, v161
    v_mov_b32 v163, v162
    s_nop 1
    v_permlane32_swap_b32 v162, v163
    v_max_f32 v160, v162, v163
    v_mov_b32 v161, v160
    s_nop 1
    v_permlane16_swap_b32 v160, v161
    v_mul_f32 v160, s41, v160
    v_mul_f32 v161, s41, v161
    v_fma_f32 v144, v136, s41, -v160
    v_fma_f32 v152, -v136, s41, -v161
    v_fma_f32 v145, v137, s41, -v160
    v_fma_f32 v153, -v137, s41, -v161
    v_fma_f32 v146, v138, s41, -v160
    v_fma_f32 v154, -v138, s41, -v161
    v_fma_f32 v147, v139, s41, -v160
    v_fma_f32 v155, -v139, s41, -v161
    v_fma_f32 v148, v140, s41, -v160
    v_fma_f32 v156, -v140, s41, -v161
    v_fma_f32 v149, v141, s41, -v160
    v_fma_f32 v157, -v141, s41, -v161
    v_fma_f32 v150, v142, s41, -v160
    v_fma_f32 v158, -v142, s41, -v161
    v_fma_f32 v151, v143, s41, -v160
    v_fma_f32 v159, -v143, s41, -v161
    v_exp_f32 v144, v144
    v_exp_f32 v152, v152
    v_exp_f32 v145, v145
    v_exp_f32 v153, v153
    v_exp_f32 v146, v146
    v_exp_f32 v154, v154
    v_exp_f32 v147, v147
    v_exp_f32 v155, v155
    v_exp_f32 v148, v148
    v_exp_f32 v156, v156
    v_exp_f32 v149, v149
    v_exp_f32 v157, v157
    v_exp_f32 v150, v150
    v_exp_f32 v158, v158
    v_exp_f32 v151, v151
    v_exp_f32 v159, v159
    s_nop 0
    v_add_f32 v164, v144, v145
    v_add_f32 v165, v152, v153
    v_add_f32 v164, v164, v146
    v_add_f32 v165, v165, v154
    v_add_f32 v164, v164, v147
    v_add_f32 v165, v165, v155
    v_add_f32 v164, v164, v148
    v_add_f32 v165, v165, v156
    v_add_f32 v164, v164, v149
    v_add_f32 v165, v165, v157
    v_add_f32 v164, v164, v150
    v_add_f32 v165, v165, v158
    v_add_f32 v164, v164, v151
    v_add_f32 v165, v165, v159
    s_nop 1
    v_permlane16_swap_b32 v164, v165
    v_add_f32 v162, v164, v165
    v_mov_b32 v163, v162
    s_nop 1
    v_permlane32_swap_b32 v162, v163
    v_add_f32 v164, v162, v163
    v_mov_b32 v165, v164
    s_nop 1
    v_permlane16_swap_b32 v164, v165
    v_rcp_f32 v164, v164
    v_rcp_f32 v165, v165
    s_nop 0
    v_mul_f32 v144, v144, v164
    v_mul_f32 v152, v152, v165
    v_mul_f32 v145, v145, v164
    v_mul_f32 v153, v153, v165
    v_mul_f32 v146, v146, v164
    v_mul_f32 v154, v154, v165
    v_mul_f32 v147, v147, v164
    v_mul_f32 v155, v155, v165
    v_mul_f32 v148, v148, v164
    v_mul_f32 v156, v156, v165
    v_mul_f32 v149, v149, v164
    v_mul_f32 v157, v157, v165
    v_mul_f32 v150, v150, v164
    v_mul_f32 v158, v158, v165
    v_mul_f32 v151, v151, v164
    v_mul_f32 v159, v159, v165
    v_cvt_pk_bf16_f32 v124, v144, v145
    v_cvt_pk_bf16_f32 v128, v152, v153
    v_cvt_pk_bf16_f32 v125, v146, v147
    v_cvt_pk_bf16_f32 v129, v154, v155
    v_cvt_pk_bf16_f32 v126, v148, v149
    v_cvt_pk_bf16_f32 v130, v156, v157
    v_cvt_pk_bf16_f32 v127, v150, v151
    v_cvt_pk_bf16_f32 v131, v158, v159
    ds_write_b64 v202, v[124:125] offset:0
    ds_write_b64 v202, v[126:127] offset:32
    ds_write_b64 v202, v[128:129] offset:64
    ds_write_b64 v202, v[130:131] offset:96
    s_nop 1
    v_cvt_pk_bf16_f32 v112, v32, v33
    v_cvt_pk_bf16_f32 v113, v34, v35
    v_cvt_pk_bf16_f32 v114, v36, v37
    v_cvt_pk_bf16_f32 v115, v38, v39
    s_nop 1
    v_mfma_f32_16x16x32_bf16 v[116:119], v[176:179], v[112:115], 0
    v_mfma_f32_16x16x32_bf16 v[120:123], v[180:183], v[112:115], 0
    s_nop 8
    v_cvt_pk_bf16_f32 v136, 0, v116
    v_cvt_pk_bf16_f32 v137, 0, v117
    v_cvt_pk_bf16_f32 v138, 0, v118
    v_cvt_pk_bf16_f32 v139, 0, v119
    v_cvt_pk_bf16_f32 v140, 0, v120
    v_cvt_pk_bf16_f32 v141, 0, v121
    v_cvt_pk_bf16_f32 v142, 0, v122
    v_cvt_pk_bf16_f32 v143, 0, v123
    v_max3_f32 v160, v136, v137, v138
    v_min3_f32 v161, v136, v137, v138
    v_max3_f32 v160, v160, v139, v140
    v_min3_f32 v161, v161, v139, v140
    v_max3_f32 v160, v160, v141, v142
    v_min3_f32 v161, v161, v141, v142
    v_max_f32 v160, v160, v143
    v_min_f32 v161, v161, v143
    v_sub_f32 v161, 0, v161
    s_nop 1
    v_permlane16_swap_b32 v160, v161
    v_max_f32 v162, v160, v161
    v_mov_b32 v163, v162
    s_nop 1
    v_permlane32_swap_b32 v162, v163
    v_max_f32 v160, v162, v163
    v_mov_b32 v161, v160
    s_nop 1
    v_permlane16_swap_b32 v160, v161
    v_mul_f32 v160, s41, v160
    v_mul_f32 v161, s41, v161
    v_fma_f32 v144, v136, s41, -v160
    v_fma_f32 v152, -v136, s41, -v161
    v_fma_f32 v145, v137, s41, -v160
    v_fma_f32 v153, -v137, s41, -v161
    v_fma_f32 v146, v138, s41, -v160
    v_fma_f32 v154, -v138, s41, -v161
    v_fma_f32 v147, v139, s41, -v160
    v_fma_f32 v155, -v139, s41, -v161
    v_fma_f32 v148, v140, s41, -v160
    v_fma_f32 v156, -v140, s41, -v161
    v_fma_f32 v149, v141, s41, -v160
    v_fma_f32 v157, -v141, s41, -v161
    v_fma_f32 v150, v142, s41, -v160
    v_fma_f32 v158, -v142, s41, -v161
    v_fma_f32 v151, v143, s41, -v160
    v_fma_f32 v159, -v143, s41, -v161
    v_exp_f32 v144, v144
    v_exp_f32 v152, v152
    v_exp_f32 v145, v145
    v_exp_f32 v153, v153
    v_exp_f32 v146, v146
    v_exp_f32 v154, v154
    v_exp_f32 v147, v147
    v_exp_f32 v155, v155
    v_exp_f32 v148, v148
    v_exp_f32 v156, v156
    v_exp_f32 v149, v149
    v_exp_f32 v157, v157
    v_exp_f32 v150, v150
    v_exp_f32 v158, v158
    v_exp_f32 v151, v151
    v_exp_f32 v159, v159
    s_nop 0
    v_add_f32 v164, v144, v145
    v_add_f32 v165, v152, v153
    v_add_f32 v164, v164, v146
    v_add_f32 v165, v165, v154
    v_add_f32 v164, v164, v147
    v_add_f32 v165, v165, v155
    v_add_f32 v164, v164, v148
    v_add_f32 v165, v165, v156
    v_add_f32 v164, v164, v149
    v_add_f32 v165, v165, v157
    v_add_f32 v164, v164, v150
    v_add_f32 v165, v165, v158
    v_add_f32 v164, v164, v151
    v_add_f32 v165, v165, v159
    s_nop 1
    v_permlane16_swap_b32 v164, v165
    v_add_f32 v162, v164, v165
    v_mov_b32 v163, v162
    s_nop 1
    v_permlane32_swap_b32 v162, v163
    v_add_f32 v164, v162, v163
    v_mov_b32 v165, v164
    s_nop 1
    v_permlane16_swap_b32 v164, v165
    v_rcp_f32 v164, v164
    v_rcp_f32 v165, v165
    s_nop 0
    v_mul_f32 v144, v144, v164
    v_mul_f32 v152, v152, v165
    v_mul_f32 v145, v145, v164
    v_mul_f32 v153, v153, v165
    v_mul_f32 v146, v146, v164
    v_mul_f32 v154, v154, v165
    v_mul_f32 v147, v147, v164
    v_mul_f32 v155, v155, v165
    v_mul_f32 v148, v148, v164
    v_mul_f32 v156, v156, v165
    v_mul_f32 v149, v149, v164
    v_mul_f32 v157, v157, v165
    v_mul_f32 v150, v150, v164
    v_mul_f32 v158, v158, v165
    v_mul_f32 v151, v151, v164
    v_mul_f32 v159, v159, v165
    v_cvt_pk_bf16_f32 v124, v144, v145
    v_cvt_pk_bf16_f32 v128, v152, v153
    v_cvt_pk_bf16_f32 v125, v146, v147
    v_cvt_pk_bf16_f32 v129, v154, v155
    v_cvt_pk_bf16_f32 v126, v148, v149
    v_cvt_pk_bf16_f32 v130, v156, v157
    v_cvt_pk_bf16_f32 v127, v150, v151
    v_cvt_pk_bf16_f32 v131, v158, v159
    ds_write_b64 v202, v[124:125] offset:2560
    ds_write_b64 v202, v[126:127] offset:2592
    ds_write_b64 v202, v[128:129] offset:2624
    ds_write_b64 v202, v[130:131] offset:2656
    s_nop 1
    v_cvt_pk_bf16_f32 v112, v56, v57
    v_cvt_pk_bf16_f32 v113, v58, v59
    v_cvt_pk_bf16_f32 v114, v60, v61
    v_cvt_pk_bf16_f32 v115, v62, v63
    s_nop 1
    v_mfma_f32_16x16x32_bf16 v[116:119], v[176:179], v[112:115], 0
    v_mfma_f32_16x16x32_bf16 v[120:123], v[180:183], v[112:115], 0
    s_nop 8
    v_cvt_pk_bf16_f32 v136, 0, v116
    v_cvt_pk_bf16_f32 v137, 0, v117
    v_cvt_pk_bf16_f32 v138, 0, v118
    v_cvt_pk_bf16_f32 v139, 0, v119
    v_cvt_pk_bf16_f32 v140, 0, v120
    v_cvt_pk_bf16_f32 v141, 0, v121
    v_cvt_pk_bf16_f32 v142, 0, v122
    v_cvt_pk_bf16_f32 v143, 0, v123
    v_max3_f32 v160, v136, v137, v138
    v_min3_f32 v161, v136, v137, v138
    v_max3_f32 v160, v160, v139, v140
    v_min3_f32 v161, v161, v139, v140
    v_max3_f32 v160, v160, v141, v142
    v_min3_f32 v161, v161, v141, v142
    v_max_f32 v160, v160, v143
    v_min_f32 v161, v161, v143
    v_sub_f32 v161, 0, v161
    s_nop 1
    v_permlane16_swap_b32 v160, v161
    v_max_f32 v162, v160, v161
    v_mov_b32 v163, v162
    s_nop 1
    v_permlane32_swap_b32 v162, v163
    v_max_f32 v160, v162, v163
    v_mov_b32 v161, v160
    s_nop 1
    v_permlane16_swap_b32 v160, v161
    v_mul_f32 v160, s41, v160
    v_mul_f32 v161, s41, v161
    v_fma_f32 v144, v136, s41, -v160
    v_fma_f32 v152, -v136, s41, -v161
    v_fma_f32 v145, v137, s41, -v160
    v_fma_f32 v153, -v137, s41, -v161
    v_fma_f32 v146, v138, s41, -v160
    v_fma_f32 v154, -v138, s41, -v161
    v_fma_f32 v147, v139, s41, -v160
    v_fma_f32 v155, -v139, s41, -v161
    v_fma_f32 v148, v140, s41, -v160
    v_fma_f32 v156, -v140, s41, -v161
    v_fma_f32 v149, v141, s41, -v160
    v_fma_f32 v157, -v141, s41, -v161
    v_fma_f32 v150, v142, s41, -v160
    v_fma_f32 v158, -v142, s41, -v161
    v_fma_f32 v151, v143, s41, -v160
    v_fma_f32 v159, -v143, s41, -v161
    v_exp_f32 v144, v144
    v_exp_f32 v152, v152
    v_exp_f32 v145, v145
    v_exp_f32 v153, v153
    v_exp_f32 v146, v146
    v_exp_f32 v154, v154
    v_exp_f32 v147, v147
    v_exp_f32 v155, v155
    v_exp_f32 v148, v148
    v_exp_f32 v156, v156
    v_exp_f32 v149, v149
    v_exp_f32 v157, v157
    v_exp_f32 v150, v150
    v_exp_f32 v158, v158
    v_exp_f32 v151, v151
    v_exp_f32 v159, v159
    s_nop 0
    v_add_f32 v164, v144, v145
    v_add_f32 v165, v152, v153
    v_add_f32 v164, v164, v146
    v_add_f32 v165, v165, v154
    v_add_f32 v164, v164, v147
    v_add_f32 v165, v165, v155
    v_add_f32 v164, v164, v148
    v_add_f32 v165, v165, v156
    v_add_f32 v164, v164, v149
    v_add_f32 v165, v165, v157
    v_add_f32 v164, v164, v150
    v_add_f32 v165, v165, v158
    v_add_f32 v164, v164, v151
    v_add_f32 v165, v165, v159
    s_nop 1
    v_permlane16_swap_b32 v164, v165
    v_add_f32 v162, v164, v165
    v_mov_b32 v163, v162
    s_nop 1
    v_permlane32_swap_b32 v162, v163
    v_add_f32 v164, v162, v163
    v_mov_b32 v165, v164
    s_nop 1
    v_permlane16_swap_b32 v164, v165
    v_rcp_f32 v164, v164
    v_rcp_f32 v165, v165
    s_nop 0
    v_mul_f32 v144, v144, v164
    v_mul_f32 v152, v152, v165
    v_mul_f32 v145, v145, v164
    v_mul_f32 v153, v153, v165
    v_mul_f32 v146, v146, v164
    v_mul_f32 v154, v154, v165
    v_mul_f32 v147, v147, v164
    v_mul_f32 v155, v155, v165
    v_mul_f32 v148, v148, v164
    v_mul_f32 v156, v156, v165
    v_mul_f32 v149, v149, v164
    v_mul_f32 v157, v157, v165
    v_mul_f32 v150, v150, v164
    v_mul_f32 v158, v158, v165
    v_mul_f32 v151, v151, v164
    v_mul_f32 v159, v159, v165
    v_cvt_pk_bf16_f32 v124, v144, v145
    v_cvt_pk_bf16_f32 v128, v152, v153
    v_cvt_pk_bf16_f32 v125, v146, v147
    v_cvt_pk_bf16_f32 v129, v154, v155
    v_cvt_pk_bf16_f32 v126, v148, v149
    v_cvt_pk_bf16_f32 v130, v156, v157
    v_cvt_pk_bf16_f32 v127, v150, v151
    v_cvt_pk_bf16_f32 v131, v158, v159
    ds_write_b64 v202, v[124:125] offset:5120
    ds_write_b64 v202, v[126:127] offset:5152
    ds_write_b64 v202, v[128:129] offset:5184
    ds_write_b64 v202, v[130:131] offset:5216
    s_nop 1
    v_cvt_pk_bf16_f32 v112, v80, v81
    v_cvt_pk_bf16_f32 v113, v82, v83
    v_cvt_pk_bf16_f32 v114, v84, v85
    v_cvt_pk_bf16_f32 v115, v86, v87
    s_nop 1
    v_mfma_f32_16x16x32_bf16 v[116:119], v[176:179], v[112:115], 0
    v_mfma_f32_16x16x32_bf16 v[120:123], v[180:183], v[112:115], 0
    s_nop 8
    v_cvt_pk_bf16_f32 v136, 0, v116
    v_cvt_pk_bf16_f32 v137, 0, v117
    v_cvt_pk_bf16_f32 v138, 0, v118
    v_cvt_pk_bf16_f32 v139, 0, v119
    v_cvt_pk_bf16_f32 v140, 0, v120
    v_cvt_pk_bf16_f32 v141, 0, v121
    v_cvt_pk_bf16_f32 v142, 0, v122
    v_cvt_pk_bf16_f32 v143, 0, v123
    v_max3_f32 v160, v136, v137, v138
    v_min3_f32 v161, v136, v137, v138
    v_max3_f32 v160, v160, v139, v140
    v_min3_f32 v161, v161, v139, v140
    v_max3_f32 v160, v160, v141, v142
    v_min3_f32 v161, v161, v141, v142
    v_max_f32 v160, v160, v143
    v_min_f32 v161, v161, v143
    v_sub_f32 v161, 0, v161
    s_nop 1
    v_permlane16_swap_b32 v160, v161
    v_max_f32 v162, v160, v161
    v_mov_b32 v163, v162
    s_nop 1
    v_permlane32_swap_b32 v162, v163
    v_max_f32 v160, v162, v163
    v_mov_b32 v161, v160
    s_nop 1
    v_permlane16_swap_b32 v160, v161
    v_mul_f32 v160, s41, v160
    v_mul_f32 v161, s41, v161
    v_fma_f32 v144, v136, s41, -v160
    v_fma_f32 v152, -v136, s41, -v161
    v_fma_f32 v145, v137, s41, -v160
    v_fma_f32 v153, -v137, s41, -v161
    v_fma_f32 v146, v138, s41, -v160
    v_fma_f32 v154, -v138, s41, -v161
    v_fma_f32 v147, v139, s41, -v160
    v_fma_f32 v155, -v139, s41, -v161
    v_fma_f32 v148, v140, s41, -v160
    v_fma_f32 v156, -v140, s41, -v161
    v_fma_f32 v149, v141, s41, -v160
    v_fma_f32 v157, -v141, s41, -v161
    v_fma_f32 v150, v142, s41, -v160
    v_fma_f32 v158, -v142, s41, -v161
    v_fma_f32 v151, v143, s41, -v160
    v_fma_f32 v159, -v143, s41, -v161
    v_exp_f32 v144, v144
    v_exp_f32 v152, v152
    v_exp_f32 v145, v145
    v_exp_f32 v153, v153
    v_exp_f32 v146, v146
    v_exp_f32 v154, v154
    v_exp_f32 v147, v147
    v_exp_f32 v155, v155
    v_exp_f32 v148, v148
    v_exp_f32 v156, v156
    v_exp_f32 v149, v149
    v_exp_f32 v157, v157
    v_exp_f32 v150, v150
    v_exp_f32 v158, v158
    v_exp_f32 v151, v151
    v_exp_f32 v159, v159
    s_nop 0
    v_add_f32 v164, v144, v145
    v_add_f32 v165, v152, v153
    v_add_f32 v164, v164, v146
    v_add_f32 v165, v165, v154
    v_add_f32 v164, v164, v147
    v_add_f32 v165, v165, v155
    v_add_f32 v164, v164, v148
    v_add_f32 v165, v165, v156
    v_add_f32 v164, v164, v149
    v_add_f32 v165, v165, v157
    v_add_f32 v164, v164, v150
    v_add_f32 v165, v165, v158
    v_add_f32 v164, v164, v151
    v_add_f32 v165, v165, v159
    s_nop 1
    v_permlane16_swap_b32 v164, v165
    v_add_f32 v162, v164, v165
    v_mov_b32 v163, v162
    s_nop 1
    v_permlane32_swap_b32 v162, v163
    v_add_f32 v164, v162, v163
    v_mov_b32 v165, v164
    s_nop 1
    v_permlane16_swap_b32 v164, v165
    v_rcp_f32 v164, v164
    v_rcp_f32 v165, v165
    s_nop 0
    v_mul_f32 v144, v144, v164
    v_mul_f32 v152, v152, v165
    v_mul_f32 v145, v145, v164
    v_mul_f32 v153, v153, v165
    v_mul_f32 v146, v146, v164
    v_mul_f32 v154, v154, v165
    v_mul_f32 v147, v147, v164
    v_mul_f32 v155, v155, v165
    v_mul_f32 v148, v148, v164
    v_mul_f32 v156, v156, v165
    v_mul_f32 v149, v149, v164
    v_mul_f32 v157, v157, v165
    v_mul_f32 v150, v150, v164
    v_mul_f32 v158, v158, v165
    v_mul_f32 v151, v151, v164
    v_mul_f32 v159, v159, v165
    v_cvt_pk_bf16_f32 v124, v144, v145
    v_cvt_pk_bf16_f32 v128, v152, v153
    v_cvt_pk_bf16_f32 v125, v146, v147
    v_cvt_pk_bf16_f32 v129, v154, v155
    v_cvt_pk_bf16_f32 v126, v148, v149
    v_cvt_pk_bf16_f32 v130, v156, v157
    v_cvt_pk_bf16_f32 v127, v150, v151
    v_cvt_pk_bf16_f32 v131, v158, v159
    ds_write_b64 v202, v[124:125] offset:7680
    ds_write_b64 v202, v[126:127] offset:7712
    ds_write_b64 v202, v[128:129] offset:7744
    ds_write_b64 v202, v[130:131] offset:7776
    s_nop 1
    s_waitcnt lgkmcnt(0)
    ds_read_b64_tr_b16 v[136:137], v203 offset:0
    ds_read_b64_tr_b16 v[138:139], v203 offset:2560
    ds_read_b64_tr_b16 v[140:141], v203 offset:5120
    ds_read_b64_tr_b16 v[142:143], v203 offset:7680
    ds_read_b64_tr_b16 v[144:145], v203 offset:32
    ds_read_b64_tr_b16 v[146:147], v203 offset:2592
    ds_read_b64_tr_b16 v[148:149], v203 offset:5152
    ds_read_b64_tr_b16 v[150:151], v203 offset:7712
    ds_read_b64_tr_b16 v[152:153], v203 offset:64
    ds_read_b64_tr_b16 v[154:155], v203 offset:2624
    ds_read_b64_tr_b16 v[156:157], v203 offset:5184
    ds_read_b64_tr_b16 v[158:159], v203 offset:7744
    ds_read_b64_tr_b16 v[160:161], v203 offset:96
    ds_read_b64_tr_b16 v[162:163], v203 offset:2656
    ds_read_b64_tr_b16 v[164:165], v203 offset:5216
    ds_read_b64_tr_b16 v[166:167], v203 offset:7776
    s_waitcnt lgkmcnt(0)
    v_mfma_f32_16x16x32_bf16 v[0:3], v[136:139], v[96:99], 0
    v_mfma_f32_16x16x32_bf16 v[0:3], v[140:143], v[104:107], v[0:3]
    v_mfma_f32_16x16x32_bf16 v[4:7], v[136:139], v[100:103], 0
    v_mfma_f32_16x16x32_bf16 v[4:7], v[140:143], v[108:111], v[4:7]
    v_mfma_f32_16x16x32_bf16 v[8:11], v[136:139], v[168:171], 0
    v_mfma_f32_16x16x32_bf16 v[8:11], v[140:143], v[168:171], v[8:11]
    v_mfma_f32_16x16x32_bf16 v[12:15], v[144:147], v[96:99], 0
    v_mfma_f32_16x16x32_bf16 v[12:15], v[148:151], v[104:107], v[12:15]
    v_mfma_f32_16x16x32_bf16 v[16:19], v[144:147], v[100:103], 0
    v_mfma_f32_16x16x32_bf16 v[16:19], v[148:151], v[108:111], v[16:19]
    v_mfma_f32_16x16x32_bf16 v[20:23], v[144:147], v[168:171], 0
    v_mfma_f32_16x16x32_bf16 v[20:23], v[148:151], v[168:171], v[20:23]
    v_mfma_f32_16x16x32_bf16 v[24:27], v[152:155], v[96:99], 0
    v_mfma_f32_16x16x32_bf16 v[24:27], v[156:159], v[104:107], v[24:27]
    v_mfma_f32_16x16x32_bf16 v[28:31], v[152:155], v[100:103], 0
    v_mfma_f32_16x16x32_bf16 v[28:31], v[156:159], v[108:111], v[28:31]
    v_mfma_f32_16x16x32_bf16 v[32:35], v[152:155], v[168:171], 0
    v_mfma_f32_16x16x32_bf16 v[32:35], v[156:159], v[168:171], v[32:35]
    v_mfma_f32_16x16x32_bf16 v[36:39], v[160:163], v[96:99], 0
    v_mfma_f32_16x16x32_bf16 v[36:39], v[164:167], v[104:107], v[36:39]
    v_mfma_f32_16x16x32_bf16 v[40:43], v[160:163], v[100:103], 0
    v_mfma_f32_16x16x32_bf16 v[40:43], v[164:167], v[108:111], v[40:43]
    v_mfma_f32_16x16x32_bf16 v[44:47], v[160:163], v[168:171], 0
    v_mfma_f32_16x16x32_bf16 v[44:47], v[164:167], v[168:171], v[44:47]
    s_nop 8
    s_mul_i32 s42, s34, 12288
    s_add_u32 s42, s42, 49152
    v_lshlrev_b32 v204, 4, v200
    v_add_u32 v204, s42, v204
    s_cmp_eq_u32 s33, 0
    s_cbranch_scc1 K1_WM0
    ds_write_b128 v204, v[0:3] offset:0
    ds_write_b128 v204, v[4:7] offset:1024
    ds_write_b128 v204, v[8:11] offset:2048
    ds_write_b128 v204, v[12:15] offset:3072
    ds_write_b128 v204, v[16:19] offset:4096
    ds_write_b128 v204, v[20:23] offset:5120
    ds_write_b128 v204, v[24:27] offset:6144
    ds_write_b128 v204, v[28:31] offset:7168
    ds_write_b128 v204, v[32:35] offset:8192
    ds_write_b128 v204, v[36:39] offset:9216
    ds_write_b128 v204, v[40:43] offset:10240
    ds_write_b128 v204, v[44:47] offset:11264
    s_lshl_b32 s42, s34, 2
    s_add_u32 s42, s42, 122880
    v_mov_b32 v205, s42
    v_mov_b32 v206, 1
    ds_write_b32 v205, v206
    s_waitcnt lgkmcnt(0)
    s_branch K1_END
K1_WM0:
    s_lshl_b32 s42, s34, 2
    s_add_u32 s42, s42, 122880
    v_mov_b32 v205, s42
K1_POLL:
    ds_read_b32 v206, v205
    s_waitcnt lgkmcnt(0)
    v_readfirstlane_b32 s42, v206
    s_cmp_eq_u32 s42, 0
    s_cbranch_scc1 K1_POLL
    ds_read_b128 v[96:99], v204 offset:0
    ds_read_b128 v[100:103], v204 offset:1024
    ds_read_b128 v[104:107], v204 offset:2048
    ds_read_b128 v[108:111], v204 offset:3072
    ds_read_b128 v[112:115], v204 offset:4096
    ds_read_b128 v[116:119], v204 offset:5120
    ds_read_b128 v[120:123], v204 offset:6144
    ds_read_b128 v[124:127], v204 offset:7168
    ds_read_b128 v[128:131], v204 offset:8192
    ds_read_b128 v[132:135], v204 offset:9216
    ds_read_b128 v[136:139], v204 offset:10240
    ds_read_b128 v[140:143], v204 offset:11264
    s_waitcnt lgkmcnt(0)
    v_add_f32 v0, v0, v96
    v_add_f32 v1, v1, v97
    v_add_f32 v2, v2, v98
    v_add_f32 v3, v3, v99
    v_add_f32 v4, v4, v100
    v_add_f32 v5, v5, v101
    v_add_f32 v6, v6, v102
    v_add_f32 v7, v7, v103
    v_add_f32 v8, v8, v104
    v_add_f32 v9, v9, v105
    v_add_f32 v10, v10, v106
    v_add_f32 v11, v11, v107
    v_add_f32 v12, v12, v108
    v_add_f32 v13, v13, v109
    v_add_f32 v14, v14, v110
    v_add_f32 v15, v15, v111
    v_add_f32 v16, v16, v112
    v_add_f32 v17, v17, v113
    v_add_f32 v18, v18, v114
    v_add_f32 v19, v19, v115
    v_add_f32 v20, v20, v116
    v_add_f32 v21, v21, v117
    v_add_f32 v22, v22, v118
    v_add_f32 v23, v23, v119
    v_add_f32 v24, v24, v120
    v_add_f32 v25, v25, v121
    v_add_f32 v26, v26, v122
    v_add_f32 v27, v27, v123
    v_add_f32 v28, v28, v124
    v_add_f32 v29, v29, v125
    v_add_f32 v30, v30, v126
    v_add_f32 v31, v31, v127
    v_add_f32 v32, v32, v128
    v_add_f32 v33, v33, v129
    v_add_f32 v34, v34, v130
    v_add_f32 v35, v35, v131
    v_add_f32 v36, v36, v132
    v_add_f32 v37, v37, v133
    v_add_f32 v38, v38, v134
    v_add_f32 v39, v39, v135
    v_add_f32 v40, v40, v136
    v_add_f32 v41, v41, v137
    v_add_f32 v42, v42, v138
    v_add_f32 v43, v43, v139
    v_add_f32 v44, v44, v140
    v_add_f32 v45, v45, v141
    v_add_f32 v46, v46, v142
    v_add_f32 v47, v47, v143
    s_lshl_b32 s42, s44, 4
    s_add_u32 s42, s42, s35
    s_mul_i32 s42, s42, 8448
    s_add_u32 s42, s42, 16777216
    v_lshlrev_b32 v204, 4, v200
    v_add_u32 v204, s42, v204
    v_add_u32 v205, 4096, v204
    buffer_store_dwordx4 v[0:3], v204, s[12:15], 0 offen offset:0
    buffer_store_dwordx4 v[4:7], v204, s[12:15], 0 offen offset:1024
    buffer_store_dwordx4 v[12:15], v204, s[12:15], 0 offen offset:2048
    buffer_store_dwordx4 v[16:19], v204, s[12:15], 0 offen offset:3072
    buffer_store_dwordx4 v[24:27], v205, s[12:15], 0 offen offset:0
    buffer_store_dwordx4 v[28:31], v205, s[12:15], 0 offen offset:1024
    buffer_store_dwordx4 v[36:39], v205, s[12:15], 0 offen offset:2048
    buffer_store_dwordx4 v[40:43], v205, s[12:15], 0 offen offset:3072
    v_lshrrev_b32 v206, 4, v200
    v_lshlrev_b32 v206, 4, v206
    s_add_u32 s42, s42, 8192
    v_add_u32 v206, s42, v206
    v_and_b32 v207, 15, v200
    v_cmp_eq_u32 vcc, 0, v207
    s_and_saveexec_b64 s[50:51], vcc
    buffer_store_dwordx4 v[8:11], v206, s[12:15], 0 offen offset:0
    buffer_store_dwordx4 v[20:23], v206, s[12:15], 0 offen offset:64
    buffer_store_dwordx4 v[32:35], v206, s[12:15], 0 offen offset:128
    buffer_store_dwordx4 v[44:47], v206, s[12:15], 0 offen offset:192
    s_mov_b64 exec, s[50:51]
    s_branch K1_END
K1_AUX:
    s_cmp_ge_u32 s32, 6
    s_cbranch_scc1 K1_PREP
    s_mov_b32 s4, s60
    s_and_b32 s5, s61, 0xffff
    s_mov_b32 s6, 4194304
    s_mov_b32 s7, 0x00020000
    s_mov_b32 s8, s62
    s_and_b32 s9, s63, 0xffff
    s_mov_b32 s10, 6291456
    s_mov_b32 s11, 0x00020000
    s_lshl_b32 s37, s45, 13
    s_lshl_b32 s38, s45, 12
    s_add_u32 s38, s38, 49152
    s_lshl_b32 s42, s35, 7
    s_lshl_b32 s43, s45, 6
    s_add_u32 s42, s42, s43
    v_lshrrev_b32 v201, 3, v200
    v_add_u32 v201, s42, v201
    v_lshlrev_b32 v201, 11, v201
    v_lshrrev_b32 v202, 4, v200
    v_and_b32 v203, 7, v200
    v_add_u32 v204, 0, v202
    v_xor_b32 v204, v204, v203
    v_lshlrev_b32 v204, 4, v204
    v_add_u32 v204, v204, v201
    v_add_u32 v160, 0, v204
    v_add_u32 v204, 4, v202
    v_xor_b32 v204, v204, v203
    v_lshlrev_b32 v204, 4, v204
    v_add_u32 v204, v204, v201
    v_add_u32 v161, 16384, v204
    v_add_u32 v204, 0, v202
    v_xor_b32 v204, v204, v203
    v_lshlrev_b32 v204, 4, v204
    v_add_u32 v204, v204, v201
    v_add_u32 v162, 32768, v204
    v_add_u32 v204, 4, v202
    v_xor_b32 v204, v204, v203
    v_lshlrev_b32 v204, 4, v204
    v_add_u32 v204, v204, v201
    v_add_u32 v163, 49152, v204
    v_add_u32 v204, 0, v202
    v_xor_b32 v204, v204, v203
    v_lshlrev_b32 v204, 4, v204
    v_add_u32 v204, v204, v201
    v_add_u32 v164, 65536, v204
    v_add_u32 v204, 4, v202
    v_xor_b32 v204, v204, v203
    v_lshlrev_b32 v204, 4, v204
    v_add_u32 v204, v204, v201
    v_add_u32 v165, 81920, v204
    v_add_u32 v204, 0, v202
    v_xor_b32 v204, v204, v203
    v_lshlrev_b32 v204, 4, v204
    v_add_u32 v204, v204, v201
    v_add_u32 v166, 98304, v204
    v_add_u32 v204, 4, v202
    v_xor_b32 v204, v204, v203
    v_lshlrev_b32 v204, 4, v204
    v_add_u32 v204, v204, v201
    v_add_u32 v167, 114688, v204
    s_lshl_b32 s42, s45, 5
    v_lshrrev_b32 v201, 3, v200
    v_add_u32 v201, s42, v201
    s_movk_i32 s43, 6144
    v_mul_lo_u32 v201, v201, s43
    s_lshl_b32 s42, s36, 7
    v_add_u32 v201, s42, v201
    v_bfe_u32 v202, v200, 4, 1
    v_bfe_u32 v203, v200, 1, 2
    v_or_b32 v204, 0, v202
    v_xor_b32 v204, v204, v203
    v_lshlrev_b32 v204, 1, v204
    v_and_b32 v205, 1, v200
    v_or_b32 v204, v204, v205
    v_lshlrev_b32 v204, 4, v204
    v_add_u32 v204, v204, v201
    v_add_u32 v168, 0, v204
    v_add_u32 v169, 2048, v204
    v_add_u32 v170, 4096, v204
    v_or_b32 v204, 2, v202
    v_xor_b32 v204, v204, v203
    v_lshlrev_b32 v204, 1, v204
    v_and_b32 v205, 1, v200
    v_or_b32 v204, v204, v205
    v_lshlrev_b32 v204, 4, v204
    v_add_u32 v204, v204, v201
    v_add_u32 v171, 49152, v204
    v_add_u32 v172, 51200, v204
    v_add_u32 v173, 53248, v204
    v_or_b32 v204, 0, v202
    v_xor_b32 v204, v204, v203
    v_lshlrev_b32 v204, 1, v204
    v_and_b32 v205, 1, v200
    v_or_b32 v204, v204, v205
    v_lshlrev_b32 v204, 4, v204
    v_add_u32 v204, v204, v201
    v_add_u32 v174, 98304, v204
    v_add_u32 v175, 100352, v204
    v_add_u32 v176, 102400, v204
    v_or_b32 v204, 2, v202
    v_xor_b32 v204, v204, v203
    v_lshlrev_b32 v204, 1, v204
    v_and_b32 v205, 1, v200
    v_or_b32 v204, v204, v205
    v_lshlrev_b32 v204, 4, v204
    v_add_u32 v204, v204, v201
    v_add_u32 v177, 147456, v204
    v_add_u32 v178, 149504, v204
    v_add_u32 v179, 151552, v204
    s_mov_b32 s39, 0
    s_mov_b32 s40, 0
    s_add_u32 m0, s37, 0
    s_nop 0
    buffer_load_dwordx4 v160, s[4:7], s39 offen lds
    s_add_u32 m0, s37, 1024
    s_nop 0
    buffer_load_dwordx4 v161, s[4:7], s39 offen lds
    s_add_u32 m0, s37, 2048
    s_nop 0
    buffer_load_dwordx4 v162, s[4:7], s39 offen lds
    s_add_u32 m0, s37, 3072
    s_nop 0
    buffer_load_dwordx4 v163, s[4:7], s39 offen lds
    s_add_u32 m0, s37, 4096
    s_nop 0
    buffer_load_dwordx4 v164, s[4:7], s39 offen lds
    s_add_u32 m0, s37, 5120
    s_nop 0
    buffer_load_dwordx4 v165, s[4:7], s39 offen lds
    s_add_u32 m0, s37, 6144
    s_nop 0
    buffer_load_dwordx4 v166, s[4:7], s39 offen lds
    s_add_u32 m0, s37, 7168
    s_nop 0
    buffer_load_dwordx4 v167, s[4:7], s39 offen lds
    s_add_u32 m0, s38, 0
    s_nop 0
    buffer_load_dwordx4 v168, s[8:11], s40 offen lds
    s_add_u32 m0, s38, 8192
    s_nop 0
    buffer_load_dwordx4 v169, s[8:11], s40 offen lds
    s_add_u32 m0, s38, 16384
    s_nop 0
    buffer_load_dwordx4 v170, s[8:11], s40 offen lds
    s_add_u32 m0, s38, 1024
    s_nop 0
    buffer_load_dwordx4 v171, s[8:11], s40 offen lds
    s_add_u32 m0, s38, 9216
    s_nop 0
    buffer_load_dwordx4 v172, s[8:11], s40 offen lds
    s_add_u32 m0, s38, 17408
    s_nop 0
    buffer_load_dwordx4 v173, s[8:11], s40 offen lds
    s_add_u32 m0, s38, 2048
    s_nop 0
    buffer_load_dwordx4 v174, s[8:11], s40 offen lds
    s_add_u32 m0, s38, 10240
    s_nop 0
    buffer_load_dwordx4 v175, s[8:11], s40 offen lds
    s_add_u32 m0, s38, 18432
    s_nop 0
    buffer_load_dwordx4 v176, s[8:11], s40 offen lds
    s_add_u32 m0, s38, 3072
    s_nop 0
    buffer_load_dwordx4 v177, s[8:11], s40 offen lds
    s_add_u32 m0, s38, 11264
    s_nop 0
    buffer_load_dwordx4 v178, s[8:11], s40 offen lds
    s_add_u32 m0, s38, 19456
    s_nop 0
    buffer_load_dwordx4 v179, s[8:11], s40 offen lds
    s_add_u32 s39, s39, 128
    s_add_u32 s40, s40, 393216
    s_add_u32 m0, s37, 16384
    s_nop 0
    buffer_load_dwordx4 v160, s[4:7], s39 offen lds
    s_add_u32 m0, s37, 17408
    s_nop 0
    buffer_load_dwordx4 v161, s[4:7], s39 offen lds
    s_add_u32 m0, s37, 18432
    s_nop 0
    buffer_load_dwordx4 v162, s[4:7], s39 offen lds
    s_add_u32 m0, s37, 19456
    s_nop 0
    buffer_load_dwordx4 v163, s[4:7], s39 offen lds
    s_add_u32 m0, s37, 20480
    s_nop 0
    buffer_load_dwordx4 v164, s[4:7], s39 offen lds
    s_add_u32 m0, s37, 21504
    s_nop 0
    buffer_load_dwordx4 v165, s[4:7], s39 offen lds
    s_add_u32 m0, s37, 22528
    s_nop 0
    buffer_load_dwordx4 v166, s[4:7], s39 offen lds
    s_add_u32 m0, s37, 23552
    s_nop 0
    buffer_load_dwordx4 v167, s[4:7], s39 offen lds
    s_add_u32 m0, s38, 24576
    s_nop 0
    buffer_load_dwordx4 v168, s[8:11], s40 offen lds
    s_add_u32 m0, s38, 32768
    s_nop 0
    buffer_load_dwordx4 v169, s[8:11], s40 offen lds
    s_add_u32 m0, s38, 40960
    s_nop 0
    buffer_load_dwordx4 v170, s[8:11], s40 offen lds
    s_add_u32 m0, s38, 25600
    s_nop 0
    buffer_load_dwordx4 v171, s[8:11], s40 offen lds
    s_add_u32 m0, s38, 33792
    s_nop 0
    buffer_load_dwordx4 v172, s[8:11], s40 offen lds
    s_add_u32 m0, s38, 41984
    s_nop 0
    buffer_load_dwordx4 v173, s[8:11], s40 offen lds
    s_add_u32 m0, s38, 26624
    s_nop 0
    buffer_load_dwordx4 v174, s[8:11], s40 offen lds
    s_add_u32 m0, s38, 34816
    s_nop 0
    buffer_load_dwordx4 v175, s[8:11], s40 offen lds
    s_add_u32 m0, s38, 43008
    s_nop 0
    buffer_load_dwordx4 v176, s[8:11], s40 offen lds
    s_add_u32 m0, s38, 27648
    s_nop 0
    buffer_load_dwordx4 v177, s[8:11], s40 offen lds
    s_add_u32 m0, s38, 35840
    s_nop 0
    buffer_load_dwordx4 v178, s[8:11], s40 offen lds
    s_add_u32 m0, s38, 44032
    s_nop 0
    buffer_load_dwordx4 v179, s[8:11], s40 offen lds
    s_add_u32 s39, s39, 128
    s_add_u32 s40, s40, 393216
    s_add_u32 m0, s37, 32768
    s_nop 0
    buffer_load_dwordx4 v160, s[4:7], s39 offen lds
    s_add_u32 m0, s37, 33792
    s_nop 0
    buffer_load_dwordx4 v161, s[4:7], s39 offen lds
    s_add_u32 m0, s37, 34816
    s_nop 0
    buffer_load_dwordx4 v162, s[4:7], s39 offen lds
    s_add_u32 m0, s37, 35840
    s_nop 0
    buffer_load_dwordx4 v163, s[4:7], s39 offen lds
    s_add_u32 m0, s37, 36864
    s_nop 0
    buffer_load_dwordx4 v164, s[4:7], s39 offen lds
    s_add_u32 m0, s37, 37888
    s_nop 0
    buffer_load_dwordx4 v165, s[4:7], s39 offen lds
    s_add_u32 m0, s37, 38912
    s_nop 0
    buffer_load_dwordx4 v166, s[4:7], s39 offen lds
    s_add_u32 m0, s37, 39936
    s_nop 0
    buffer_load_dwordx4 v167, s[4:7], s39 offen lds
    s_add_u32 m0, s38, 49152
    s_nop 0
    buffer_load_dwordx4 v168, s[8:11], s40 offen lds
    s_add_u32 m0, s38, 57344
    s_nop 0
    buffer_load_dwordx4 v169, s[8:11], s40 offen lds
    s_add_u32 m0, s38, 65536
    s_nop 0
    buffer_load_dwordx4 v170, s[8:11], s40 offen lds
    s_add_u32 m0, s38, 50176
    s_nop 0
    buffer_load_dwordx4 v171, s[8:11], s40 offen lds
    s_add_u32 m0, s38, 58368
    s_nop 0
    buffer_load_dwordx4 v172, s[8:11], s40 offen lds
    s_add_u32 m0, s38, 66560
    s_nop 0
    buffer_load_dwordx4 v173, s[8:11], s40 offen lds
    s_add_u32 m0, s38, 51200
    s_nop 0
    buffer_load_dwordx4 v174, s[8:11], s40 offen lds
    s_add_u32 m0, s38, 59392
    s_nop 0
    buffer_load_dwordx4 v175, s[8:11], s40 offen lds
    s_add_u32 m0, s38, 67584
    s_nop 0
    buffer_load_dwordx4 v176, s[8:11], s40 offen lds
    s_add_u32 m0, s38, 52224
    s_nop 0
    buffer_load_dwordx4 v177, s[8:11], s40 offen lds
    s_add_u32 m0, s38, 60416
    s_nop 0
    buffer_load_dwordx4 v178, s[8:11], s40 offen lds
    s_add_u32 m0, s38, 68608
    s_nop 0
    buffer_load_dwordx4 v179, s[8:11], s40 offen lds
    s_add_u32 s39, s39, 128
    s_add_u32 s40, s40, 393216
    s_waitcnt vmcnt(40)
    s_barrier
    s_waitcnt vmcnt(20)
    s_barrier
    s_add_u32 m0, s37, 0
    s_nop 0
    buffer_load_dwordx4 v160, s[4:7], s39 offen lds
    s_add_u32 m0, s37, 1024
    s_nop 0
    buffer_load_dwordx4 v161, s[4:7], s39 offen lds
    s_add_u32 m0, s37, 2048
    s_nop 0
    buffer_load_dwordx4 v162, s[4:7], s39 offen lds
    s_add_u32 m0, s37, 3072
    s_nop 0
    buffer_load_dwordx4 v163, s[4:7], s39 offen lds
    s_add_u32 m0, s37, 4096
    s_nop 0
    buffer_load_dwordx4 v164, s[4:7], s39 offen lds
    s_add_u32 m0, s37, 5120
    s_nop 0
    buffer_load_dwordx4 v165, s[4:7], s39 offen lds
    s_add_u32 m0, s37, 6144
    s_nop 0
    buffer_load_dwordx4 v166, s[4:7], s39 offen lds
    s_add_u32 m0, s37, 7168
    s_nop 0
    buffer_load_dwordx4 v167, s[4:7], s39 offen lds
    s_add_u32 m0, s38, 0
    s_nop 0
    buffer_load_dwordx4 v168, s[8:11], s40 offen lds
    s_add_u32 m0, s38, 8192
    s_nop 0
    buffer_load_dwordx4 v169, s[8:11], s40 offen lds
    s_add_u32 m0, s38, 16384
    s_nop 0
    buffer_load_dwordx4 v170, s[8:11], s40 offen lds
    s_add_u32 m0, s38, 1024
    s_nop 0
    buffer_load_dwordx4 v171, s[8:11], s40 offen lds
    s_add_u32 m0, s38, 9216
    s_nop 0
    buffer_load_dwordx4 v172, s[8:11], s40 offen lds
    s_add_u32 m0, s38, 17408
    s_nop 0
    buffer_load_dwordx4 v173, s[8:11], s40 offen lds
    s_add_u32 m0, s38, 2048
    s_nop 0
    buffer_load_dwordx4 v174, s[8:11], s40 offen lds
    s_add_u32 m0, s38, 10240
    s_nop 0
    buffer_load_dwordx4 v175, s[8:11], s40 offen lds
    s_add_u32 m0, s38, 18432
    s_nop 0
    buffer_load_dwordx4 v176, s[8:11], s40 offen lds
    s_add_u32 m0, s38, 3072
    s_nop 0
    buffer_load_dwordx4 v177, s[8:11], s40 offen lds
    s_add_u32 m0, s38, 11264
    s_nop 0
    buffer_load_dwordx4 v178, s[8:11], s40 offen lds
    s_add_u32 m0, s38, 19456
    s_nop 0
    buffer_load_dwordx4 v179, s[8:11], s40 offen lds
    s_add_u32 s39, s39, 128
    s_add_u32 s40, s40, 393216
    s_waitcnt vmcnt(20)
    s_barrier
    s_add_u32 m0, s37, 16384
    s_nop 0
    buffer_load_dwordx4 v160, s[4:7], s39 offen lds
    s_add_u32 m0, s37, 17408
    s_nop 0
    buffer_load_dwordx4 v161, s[4:7], s39 offen lds
    s_add_u32 m0, s37, 18432
    s_nop 0
    buffer_load_dwordx4 v162, s[4:7], s39 offen lds
    s_add_u32 m0, s37, 19456
    s_nop 0
    buffer_load_dwordx4 v163, s[4:7], s39 offen lds
    s_add_u32 m0, s37, 20480
    s_nop 0
    buffer_load_dwordx4 v164, s[4:7], s39 offen lds
    s_add_u32 m0, s37, 21504
    s_nop 0
    buffer_load_dwordx4 v165, s[4:7], s39 offen lds
    s_add_u32 m0, s37, 22528
    s_nop 0
    buffer_load_dwordx4 v166, s[4:7], s39 offen lds
    s_add_u32 m0, s37, 23552
    s_nop 0
    buffer_load_dwordx4 v167, s[4:7], s39 offen lds
    s_add_u32 m0, s38, 24576
    s_nop 0
    buffer_load_dwordx4 v168, s[8:11], s40 offen lds
    s_add_u32 m0, s38, 32768
    s_nop 0
    buffer_load_dwordx4 v169, s[8:11], s40 offen lds
    s_add_u32 m0, s38, 40960
    s_nop 0
    buffer_load_dwordx4 v170, s[8:11], s40 offen lds
    s_add_u32 m0, s38, 25600
    s_nop 0
    buffer_load_dwordx4 v171, s[8:11], s40 offen lds
    s_add_u32 m0, s38, 33792
    s_nop 0
    buffer_load_dwordx4 v172, s[8:11], s40 offen lds
    s_add_u32 m0, s38, 41984
    s_nop 0
    buffer_load_dwordx4 v173, s[8:11], s40 offen lds
    s_add_u32 m0, s38, 26624
    s_nop 0
    buffer_load_dwordx4 v174, s[8:11], s40 offen lds
    s_add_u32 m0, s38, 34816
    s_nop 0
    buffer_load_dwordx4 v175, s[8:11], s40 offen lds
    s_add_u32 m0, s38, 43008
    s_nop 0
    buffer_load_dwordx4 v176, s[8:11], s40 offen lds
    s_add_u32 m0, s38, 27648
    s_nop 0
    buffer_load_dwordx4 v177, s[8:11], s40 offen lds
    s_add_u32 m0, s38, 35840
    s_nop 0
    buffer_load_dwordx4 v178, s[8:11], s40 offen lds
    s_add_u32 m0, s38, 44032
    s_nop 0
    buffer_load_dwordx4 v179, s[8:11], s40 offen lds
    s_add_u32 s39, s39, 128
    s_add_u32 s40, s40, 393216
    s_waitcnt vmcnt(20)
    s_barrier
    s_add_u32 m0, s37, 32768
    s_nop 0
    buffer_load_dwordx4 v160, s[4:7], s39 offen lds
    s_add_u32 m0, s37, 33792
    s_nop 0
    buffer_load_dwordx4 v161, s[4:7], s39 offen lds
    s_add_u32 m0, s37, 34816
    s_nop 0
    buffer_load_dwordx4 v162, s[4:7], s39 offen lds
    s_add_u32 m0, s37, 35840
    s_nop 0
    buffer_load_dwordx4 v163, s[4:7], s39 offen lds
    s_add_u32 m0, s37, 36864
    s_nop 0
    buffer_load_dwordx4 v164, s[4:7], s39 offen lds
    s_add_u32 m0, s37, 37888
    s_nop 0
    buffer_load_dwordx4 v165, s[4:7], s39 offen lds
    s_add_u32 m0, s37, 38912
    s_nop 0
    buffer_load_dwordx4 v166, s[4:7], s39 offen lds
    s_add_u32 m0, s37, 39936
    s_nop 0
    buffer_load_dwordx4 v167, s[4:7], s39 offen lds
    s_add_u32 m0, s38, 49152
    s_nop 0
    buffer_load_dwordx4 v168, s[8:11], s40 offen lds
    s_add_u32 m0, s38, 57344
    s_nop 0
    buffer_load_dwordx4 v169, s[8:11], s40 offen lds
    s_add_u32 m0, s38, 65536
    s_nop 0
    buffer_load_dwordx4 v170, s[8:11], s40 offen lds
    s_add_u32 m0, s38, 50176
    s_nop 0
    buffer_load_dwordx4 v171, s[8:11], s40 offen lds
    s_add_u32 m0, s38, 58368
    s_nop 0
    buffer_load_dwordx4 v172, s[8:11], s40 offen lds
    s_add_u32 m0, s38, 66560
    s_nop 0
    buffer_load_dwordx4 v173, s[8:11], s40 offen lds
    s_add_u32 m0, s38, 51200
    s_nop 0
    buffer_load_dwordx4 v174, s[8:11], s40 offen lds
    s_add_u32 m0, s38, 59392
    s_nop 0
    buffer_load_dwordx4 v175, s[8:11], s40 offen lds
    s_add_u32 m0, s38, 67584
    s_nop 0
    buffer_load_dwordx4 v176, s[8:11], s40 offen lds
    s_add_u32 m0, s38, 52224
    s_nop 0
    buffer_load_dwordx4 v177, s[8:11], s40 offen lds
    s_add_u32 m0, s38, 60416
    s_nop 0
    buffer_load_dwordx4 v178, s[8:11], s40 offen lds
    s_add_u32 m0, s38, 68608
    s_nop 0
    buffer_load_dwordx4 v179, s[8:11], s40 offen lds
    s_add_u32 s39, s39, 128
    s_add_u32 s40, s40, 393216
    s_waitcnt vmcnt(20)
    s_barrier
    s_add_u32 m0, s37, 0
    s_nop 0
    buffer_load_dwordx4 v160, s[4:7], s39 offen lds
    s_add_u32 m0, s37, 1024
    s_nop 0
    buffer_load_dwordx4 v161, s[4:7], s39 offen lds
    s_add_u32 m0, s37, 2048
    s_nop 0
    buffer_load_dwordx4 v162, s[4:7], s39 offen lds
    s_add_u32 m0, s37, 3072
    s_nop 0
    buffer_load_dwordx4 v163, s[4:7], s39 offen lds
    s_add_u32 m0, s37, 4096
    s_nop 0
    buffer_load_dwordx4 v164, s[4:7], s39 offen lds
    s_add_u32 m0, s37, 5120
    s_nop 0
    buffer_load_dwordx4 v165, s[4:7], s39 offen lds
    s_add_u32 m0, s37, 6144
    s_nop 0
    buffer_load_dwordx4 v166, s[4:7], s39 offen lds
    s_add_u32 m0, s37, 7168
    s_nop 0
    buffer_load_dwordx4 v167, s[4:7], s39 offen lds
    s_add_u32 m0, s38, 0
    s_nop 0
    buffer_load_dwordx4 v168, s[8:11], s40 offen lds
    s_add_u32 m0, s38, 8192
    s_nop 0
    buffer_load_dwordx4 v169, s[8:11], s40 offen lds
    s_add_u32 m0, s38, 16384
    s_nop 0
    buffer_load_dwordx4 v170, s[8:11], s40 offen lds
    s_add_u32 m0, s38, 1024
    s_nop 0
    buffer_load_dwordx4 v171, s[8:11], s40 offen lds
    s_add_u32 m0, s38, 9216
    s_nop 0
    buffer_load_dwordx4 v172, s[8:11], s40 offen lds
    s_add_u32 m0, s38, 17408
    s_nop 0
    buffer_load_dwordx4 v173, s[8:11], s40 offen lds
    s_add_u32 m0, s38, 2048
    s_nop 0
    buffer_load_dwordx4 v174, s[8:11], s40 offen lds
    s_add_u32 m0, s38, 10240
    s_nop 0
    buffer_load_dwordx4 v175, s[8:11], s40 offen lds
    s_add_u32 m0, s38, 18432
    s_nop 0
    buffer_load_dwordx4 v176, s[8:11], s40 offen lds
    s_add_u32 m0, s38, 3072
    s_nop 0
    buffer_load_dwordx4 v177, s[8:11], s40 offen lds
    s_add_u32 m0, s38, 11264
    s_nop 0
    buffer_load_dwordx4 v178, s[8:11], s40 offen lds
    s_add_u32 m0, s38, 19456
    s_nop 0
    buffer_load_dwordx4 v179, s[8:11], s40 offen lds
    s_add_u32 s39, s39, 128
    s_add_u32 s40, s40, 393216
    s_waitcnt vmcnt(20)
    s_barrier
    s_add_u32 m0, s37, 16384
    s_nop 0
    buffer_load_dwordx4 v160, s[4:7], s39 offen lds
    s_add_u32 m0, s37, 17408
    s_nop 0
    buffer_load_dwordx4 v161, s[4:7], s39 offen lds
    s_add_u32 m0, s37, 18432
    s_nop 0
    buffer_load_dwordx4 v162, s[4:7], s39 offen lds
    s_add_u32 m0, s37, 19456
    s_nop 0
    buffer_load_dwordx4 v163, s[4:7], s39 offen lds
    s_add_u32 m0, s37, 20480
    s_nop 0
    buffer_load_dwordx4 v164, s[4:7], s39 offen lds
    s_add_u32 m0, s37, 21504
    s_nop 0
    buffer_load_dwordx4 v165, s[4:7], s39 offen lds
    s_add_u32 m0, s37, 22528
    s_nop 0
    buffer_load_dwordx4 v166, s[4:7], s39 offen lds
    s_add_u32 m0, s37, 23552
    s_nop 0
    buffer_load_dwordx4 v167, s[4:7], s39 offen lds
    s_add_u32 m0, s38, 24576
    s_nop 0
    buffer_load_dwordx4 v168, s[8:11], s40 offen lds
    s_add_u32 m0, s38, 32768
    s_nop 0
    buffer_load_dwordx4 v169, s[8:11], s40 offen lds
    s_add_u32 m0, s38, 40960
    s_nop 0
    buffer_load_dwordx4 v170, s[8:11], s40 offen lds
    s_add_u32 m0, s38, 25600
    s_nop 0
    buffer_load_dwordx4 v171, s[8:11], s40 offen lds
    s_add_u32 m0, s38, 33792
    s_nop 0
    buffer_load_dwordx4 v172, s[8:11], s40 offen lds
    s_add_u32 m0, s38, 41984
    s_nop 0
    buffer_load_dwordx4 v173, s[8:11], s40 offen lds
    s_add_u32 m0, s38, 26624
    s_nop 0
    buffer_load_dwordx4 v174, s[8:11], s40 offen lds
    s_add_u32 m0, s38, 34816
    s_nop 0
    buffer_load_dwordx4 v175, s[8:11], s40 offen lds
    s_add_u32 m0, s38, 43008
    s_nop 0
    buffer_load_dwordx4 v176, s[8:11], s40 offen lds
    s_add_u32 m0, s38, 27648
    s_nop 0
    buffer_load_dwordx4 v177, s[8:11], s40 offen lds
    s_add_u32 m0, s38, 35840
    s_nop 0
    buffer_load_dwordx4 v178, s[8:11], s40 offen lds
    s_add_u32 m0, s38, 44032
    s_nop 0
    buffer_load_dwordx4 v179, s[8:11], s40 offen lds
    s_add_u32 s39, s39, 128
    s_add_u32 s40, s40, 393216
    s_waitcnt vmcnt(20)
    s_barrier
    s_add_u32 m0, s37, 32768
    s_nop 0
    buffer_load_dwordx4 v160, s[4:7], s39 offen lds
    s_add_u32 m0, s37, 33792
    s_nop 0
    buffer_load_dwordx4 v161, s[4:7], s39 offen lds
    s_add_u32 m0, s37, 34816
    s_nop 0
    buffer_load_dwordx4 v162, s[4:7], s39 offen lds
    s_add_u32 m0, s37, 35840
    s_nop 0
    buffer_load_dwordx4 v163, s[4:7], s39 offen lds
    s_add_u32 m0, s37, 36864
    s_nop 0
    buffer_load_dwordx4 v164, s[4:7], s39 offen lds
    s_add_u32 m0, s37, 37888
    s_nop 0
    buffer_load_dwordx4 v165, s[4:7], s39 offen lds
    s_add_u32 m0, s37, 38912
    s_nop 0
    buffer_load_dwordx4 v166, s[4:7], s39 offen lds
    s_add_u32 m0, s37, 39936
    s_nop 0
    buffer_load_dwordx4 v167, s[4:7], s39 offen lds
    s_add_u32 m0, s38, 49152
    s_nop 0
    buffer_load_dwordx4 v168, s[8:11], s40 offen lds
    s_add_u32 m0, s38, 57344
    s_nop 0
    buffer_load_dwordx4 v169, s[8:11], s40 offen lds
    s_add_u32 m0, s38, 65536
    s_nop 0
    buffer_load_dwordx4 v170, s[8:11], s40 offen lds
    s_add_u32 m0, s38, 50176
    s_nop 0
    buffer_load_dwordx4 v171, s[8:11], s40 offen lds
    s_add_u32 m0, s38, 58368
    s_nop 0
    buffer_load_dwordx4 v172, s[8:11], s40 offen lds
    s_add_u32 m0, s38, 66560
    s_nop 0
    buffer_load_dwordx4 v173, s[8:11], s40 offen lds
    s_add_u32 m0, s38, 51200
    s_nop 0
    buffer_load_dwordx4 v174, s[8:11], s40 offen lds
    s_add_u32 m0, s38, 59392
    s_nop 0
    buffer_load_dwordx4 v175, s[8:11], s40 offen lds
    s_add_u32 m0, s38, 67584
    s_nop 0
    buffer_load_dwordx4 v176, s[8:11], s40 offen lds
    s_add_u32 m0, s38, 52224
    s_nop 0
    buffer_load_dwordx4 v177, s[8:11], s40 offen lds
    s_add_u32 m0, s38, 60416
    s_nop 0
    buffer_load_dwordx4 v178, s[8:11], s40 offen lds
    s_add_u32 m0, s38, 68608
    s_nop 0
    buffer_load_dwordx4 v179, s[8:11], s40 offen lds
    s_add_u32 s39, s39, 128
    s_add_u32 s40, s40, 393216
    s_waitcnt vmcnt(20)
    s_barrier
    s_add_u32 m0, s37, 0
    s_nop 0
    buffer_load_dwordx4 v160, s[4:7], s39 offen lds
    s_add_u32 m0, s37, 1024
    s_nop 0
    buffer_load_dwordx4 v161, s[4:7], s39 offen lds
    s_add_u32 m0, s37, 2048
    s_nop 0
    buffer_load_dwordx4 v162, s[4:7], s39 offen lds
    s_add_u32 m0, s37, 3072
    s_nop 0
    buffer_load_dwordx4 v163, s[4:7], s39 offen lds
    s_add_u32 m0, s37, 4096
    s_nop 0
    buffer_load_dwordx4 v164, s[4:7], s39 offen lds
    s_add_u32 m0, s37, 5120
    s_nop 0
    buffer_load_dwordx4 v165, s[4:7], s39 offen lds
    s_add_u32 m0, s37, 6144
    s_nop 0
    buffer_load_dwordx4 v166, s[4:7], s39 offen lds
    s_add_u32 m0, s37, 7168
    s_nop 0
    buffer_load_dwordx4 v167, s[4:7], s39 offen lds
    s_add_u32 m0, s38, 0
    s_nop 0
    buffer_load_dwordx4 v168, s[8:11], s40 offen lds
    s_add_u32 m0, s38, 8192
    s_nop 0
    buffer_load_dwordx4 v169, s[8:11], s40 offen lds
    s_add_u32 m0, s38, 16384
    s_nop 0
    buffer_load_dwordx4 v170, s[8:11], s40 offen lds
    s_add_u32 m0, s38, 1024
    s_nop 0
    buffer_load_dwordx4 v171, s[8:11], s40 offen lds
    s_add_u32 m0, s38, 9216
    s_nop 0
    buffer_load_dwordx4 v172, s[8:11], s40 offen lds
    s_add_u32 m0, s38, 17408
    s_nop 0
    buffer_load_dwordx4 v173, s[8:11], s40 offen lds
    s_add_u32 m0, s38, 2048
    s_nop 0
    buffer_load_dwordx4 v174, s[8:11], s40 offen lds
    s_add_u32 m0, s38, 10240
    s_nop 0
    buffer_load_dwordx4 v175, s[8:11], s40 offen lds
    s_add_u32 m0, s38, 18432
    s_nop 0
    buffer_load_dwordx4 v176, s[8:11], s40 offen lds
    s_add_u32 m0, s38, 3072
    s_nop 0
    buffer_load_dwordx4 v177, s[8:11], s40 offen lds
    s_add_u32 m0, s38, 11264
    s_nop 0
    buffer_load_dwordx4 v178, s[8:11], s40 offen lds
    s_add_u32 m0, s38, 19456
    s_nop 0
    buffer_load_dwordx4 v179, s[8:11], s40 offen lds
    s_add_u32 s39, s39, 128
    s_add_u32 s40, s40, 393216
    s_waitcnt vmcnt(20)
    s_barrier
    s_add_u32 m0, s37, 16384
    s_nop 0
    buffer_load_dwordx4 v160, s[4:7], s39 offen lds
    s_add_u32 m0, s37, 17408
    s_nop 0
    buffer_load_dwordx4 v161, s[4:7], s39 offen lds
    s_add_u32 m0, s37, 18432
    s_nop 0
    buffer_load_dwordx4 v162, s[4:7], s39 offen lds
    s_add_u32 m0, s37, 19456
    s_nop 0
    buffer_load_dwordx4 v163, s[4:7], s39 offen lds
    s_add_u32 m0, s37, 20480
    s_nop 0
    buffer_load_dwordx4 v164, s[4:7], s39 offen lds
    s_add_u32 m0, s37, 21504
    s_nop 0
    buffer_load_dwordx4 v165, s[4:7], s39 offen lds
    s_add_u32 m0, s37, 22528
    s_nop 0
    buffer_load_dwordx4 v166, s[4:7], s39 offen lds
    s_add_u32 m0, s37, 23552
    s_nop 0
    buffer_load_dwordx4 v167, s[4:7], s39 offen lds
    s_add_u32 m0, s38, 24576
    s_nop 0
    buffer_load_dwordx4 v168, s[8:11], s40 offen lds
    s_add_u32 m0, s38, 32768
    s_nop 0
    buffer_load_dwordx4 v169, s[8:11], s40 offen lds
    s_add_u32 m0, s38, 40960
    s_nop 0
    buffer_load_dwordx4 v170, s[8:11], s40 offen lds
    s_add_u32 m0, s38, 25600
    s_nop 0
    buffer_load_dwordx4 v171, s[8:11], s40 offen lds
    s_add_u32 m0, s38, 33792
    s_nop 0
    buffer_load_dwordx4 v172, s[8:11], s40 offen lds
    s_add_u32 m0, s38, 41984
    s_nop 0
    buffer_load_dwordx4 v173, s[8:11], s40 offen lds
    s_add_u32 m0, s38, 26624
    s_nop 0
    buffer_load_dwordx4 v174, s[8:11], s40 offen lds
    s_add_u32 m0, s38, 34816
    s_nop 0
    buffer_load_dwordx4 v175, s[8:11], s40 offen lds
    s_add_u32 m0, s38, 43008
    s_nop 0
    buffer_load_dwordx4 v176, s[8:11], s40 offen lds
    s_add_u32 m0, s38, 27648
    s_nop 0
    buffer_load_dwordx4 v177, s[8:11], s40 offen lds
    s_add_u32 m0, s38, 35840
    s_nop 0
    buffer_load_dwordx4 v178, s[8:11], s40 offen lds
    s_add_u32 m0, s38, 44032
    s_nop 0
    buffer_load_dwordx4 v179, s[8:11], s40 offen lds
    s_add_u32 s39, s39, 128
    s_add_u32 s40, s40, 393216
    s_waitcnt vmcnt(20)
    s_barrier
    s_add_u32 m0, s37, 32768
    s_nop 0
    buffer_load_dwordx4 v160, s[4:7], s39 offen lds
    s_add_u32 m0, s37, 33792
    s_nop 0
    buffer_load_dwordx4 v161, s[4:7], s39 offen lds
    s_add_u32 m0, s37, 34816
    s_nop 0
    buffer_load_dwordx4 v162, s[4:7], s39 offen lds
    s_add_u32 m0, s37, 35840
    s_nop 0
    buffer_load_dwordx4 v163, s[4:7], s39 offen lds
    s_add_u32 m0, s37, 36864
    s_nop 0
    buffer_load_dwordx4 v164, s[4:7], s39 offen lds
    s_add_u32 m0, s37, 37888
    s_nop 0
    buffer_load_dwordx4 v165, s[4:7], s39 offen lds
    s_add_u32 m0, s37, 38912
    s_nop 0
    buffer_load_dwordx4 v166, s[4:7], s39 offen lds
    s_add_u32 m0, s37, 39936
    s_nop 0
    buffer_load_dwordx4 v167, s[4:7], s39 offen lds
    s_add_u32 m0, s38, 49152
    s_nop 0
    buffer_load_dwordx4 v168, s[8:11], s40 offen lds
    s_add_u32 m0, s38, 57344
    s_nop 0
    buffer_load_dwordx4 v169, s[8:11], s40 offen lds
    s_add_u32 m0, s38, 65536
    s_nop 0
    buffer_load_dwordx4 v170, s[8:11], s40 offen lds
    s_add_u32 m0, s38, 50176
    s_nop 0
    buffer_load_dwordx4 v171, s[8:11], s40 offen lds
    s_add_u32 m0, s38, 58368
    s_nop 0
    buffer_load_dwordx4 v172, s[8:11], s40 offen lds
    s_add_u32 m0, s38, 66560
    s_nop 0
    buffer_load_dwordx4 v173, s[8:11], s40 offen lds
    s_add_u32 m0, s38, 51200
    s_nop 0
    buffer_load_dwordx4 v174, s[8:11], s40 offen lds
    s_add_u32 m0, s38, 59392
    s_nop 0
    buffer_load_dwordx4 v175, s[8:11], s40 offen lds
    s_add_u32 m0, s38, 67584
    s_nop 0
    buffer_load_dwordx4 v176, s[8:11], s40 offen lds
    s_add_u32 m0, s38, 52224
    s_nop 0
    buffer_load_dwordx4 v177, s[8:11], s40 offen lds
    s_add_u32 m0, s38, 60416
    s_nop 0
    buffer_load_dwordx4 v178, s[8:11], s40 offen lds
    s_add_u32 m0, s38, 68608
    s_nop 0
    buffer_load_dwordx4 v179, s[8:11], s40 offen lds
    s_add_u32 s39, s39, 128
    s_add_u32 s40, s40, 393216
    s_waitcnt vmcnt(20)
    s_barrier
    s_add_u32 m0, s37, 0
    s_nop 0
    buffer_load_dwordx4 v160, s[4:7], s39 offen lds
    s_add_u32 m0, s37, 1024
    s_nop 0
    buffer_load_dwordx4 v161, s[4:7], s39 offen lds
    s_add_u32 m0, s37, 2048
    s_nop 0
    buffer_load_dwordx4 v162, s[4:7], s39 offen lds
    s_add_u32 m0, s37, 3072
    s_nop 0
    buffer_load_dwordx4 v163, s[4:7], s39 offen lds
    s_add_u32 m0, s37, 4096
    s_nop 0
    buffer_load_dwordx4 v164, s[4:7], s39 offen lds
    s_add_u32 m0, s37, 5120
    s_nop 0
    buffer_load_dwordx4 v165, s[4:7], s39 offen lds
    s_add_u32 m0, s37, 6144
    s_nop 0
    buffer_load_dwordx4 v166, s[4:7], s39 offen lds
    s_add_u32 m0, s37, 7168
    s_nop 0
    buffer_load_dwordx4 v167, s[4:7], s39 offen lds
    s_add_u32 m0, s38, 0
    s_nop 0
    buffer_load_dwordx4 v168, s[8:11], s40 offen lds
    s_add_u32 m0, s38, 8192
    s_nop 0
    buffer_load_dwordx4 v169, s[8:11], s40 offen lds
    s_add_u32 m0, s38, 16384
    s_nop 0
    buffer_load_dwordx4 v170, s[8:11], s40 offen lds
    s_add_u32 m0, s38, 1024
    s_nop 0
    buffer_load_dwordx4 v171, s[8:11], s40 offen lds
    s_add_u32 m0, s38, 9216
    s_nop 0
    buffer_load_dwordx4 v172, s[8:11], s40 offen lds
    s_add_u32 m0, s38, 17408
    s_nop 0
    buffer_load_dwordx4 v173, s[8:11], s40 offen lds
    s_add_u32 m0, s38, 2048
    s_nop 0
    buffer_load_dwordx4 v174, s[8:11], s40 offen lds
    s_add_u32 m0, s38, 10240
    s_nop 0
    buffer_load_dwordx4 v175, s[8:11], s40 offen lds
    s_add_u32 m0, s38, 18432
    s_nop 0
    buffer_load_dwordx4 v176, s[8:11], s40 offen lds
    s_add_u32 m0, s38, 3072
    s_nop 0
    buffer_load_dwordx4 v177, s[8:11], s40 offen lds
    s_add_u32 m0, s38, 11264
    s_nop 0
    buffer_load_dwordx4 v178, s[8:11], s40 offen lds
    s_add_u32 m0, s38, 19456
    s_nop 0
    buffer_load_dwordx4 v179, s[8:11], s40 offen lds
    s_add_u32 s39, s39, 128
    s_add_u32 s40, s40, 393216
    s_waitcnt vmcnt(20)
    s_barrier
    s_add_u32 m0, s37, 16384
    s_nop 0
    buffer_load_dwordx4 v160, s[4:7], s39 offen lds
    s_add_u32 m0, s37, 17408
    s_nop 0
    buffer_load_dwordx4 v161, s[4:7], s39 offen lds
    s_add_u32 m0, s37, 18432
    s_nop 0
    buffer_load_dwordx4 v162, s[4:7], s39 offen lds
    s_add_u32 m0, s37, 19456
    s_nop 0
    buffer_load_dwordx4 v163, s[4:7], s39 offen lds
    s_add_u32 m0, s37, 20480
    s_nop 0
    buffer_load_dwordx4 v164, s[4:7], s39 offen lds
    s_add_u32 m0, s37, 21504
    s_nop 0
    buffer_load_dwordx4 v165, s[4:7], s39 offen lds
    s_add_u32 m0, s37, 22528
    s_nop 0
    buffer_load_dwordx4 v166, s[4:7], s39 offen lds
    s_add_u32 m0, s37, 23552
    s_nop 0
    buffer_load_dwordx4 v167, s[4:7], s39 offen lds
    s_add_u32 m0, s38, 24576
    s_nop 0
    buffer_load_dwordx4 v168, s[8:11], s40 offen lds
    s_add_u32 m0, s38, 32768
    s_nop 0
    buffer_load_dwordx4 v169, s[8:11], s40 offen lds
    s_add_u32 m0, s38, 40960
    s_nop 0
    buffer_load_dwordx4 v170, s[8:11], s40 offen lds
    s_add_u32 m0, s38, 25600
    s_nop 0
    buffer_load_dwordx4 v171, s[8:11], s40 offen lds
    s_add_u32 m0, s38, 33792
    s_nop 0
    buffer_load_dwordx4 v172, s[8:11], s40 offen lds
    s_add_u32 m0, s38, 41984
    s_nop 0
    buffer_load_dwordx4 v173, s[8:11], s40 offen lds
    s_add_u32 m0, s38, 26624
    s_nop 0
    buffer_load_dwordx4 v174, s[8:11], s40 offen lds
    s_add_u32 m0, s38, 34816
    s_nop 0
    buffer_load_dwordx4 v175, s[8:11], s40 offen lds
    s_add_u32 m0, s38, 43008
    s_nop 0
    buffer_load_dwordx4 v176, s[8:11], s40 offen lds
    s_add_u32 m0, s38, 27648
    s_nop 0
    buffer_load_dwordx4 v177, s[8:11], s40 offen lds
    s_add_u32 m0, s38, 35840
    s_nop 0
    buffer_load_dwordx4 v178, s[8:11], s40 offen lds
    s_add_u32 m0, s38, 44032
    s_nop 0
    buffer_load_dwordx4 v179, s[8:11], s40 offen lds
    s_add_u32 s39, s39, 128
    s_add_u32 s40, s40, 393216
    s_waitcnt vmcnt(20)
    s_barrier
    s_add_u32 m0, s37, 32768
    s_nop 0
    buffer_load_dwordx4 v160, s[4:7], s39 offen lds
    s_add_u32 m0, s37, 33792
    s_nop 0
    buffer_load_dwordx4 v161, s[4:7], s39 offen lds
    s_add_u32 m0, s37, 34816
    s_nop 0
    buffer_load_dwordx4 v162, s[4:7], s39 offen lds
    s_add_u32 m0, s37, 35840
    s_nop 0
    buffer_load_dwordx4 v163, s[4:7], s39 offen lds
    s_add_u32 m0, s37, 36864
    s_nop 0
    buffer_load_dwordx4 v164, s[4:7], s39 offen lds
    s_add_u32 m0, s37, 37888
    s_nop 0
    buffer_load_dwordx4 v165, s[4:7], s39 offen lds
    s_add_u32 m0, s37, 38912
    s_nop 0
    buffer_load_dwordx4 v166, s[4:7], s39 offen lds
    s_add_u32 m0, s37, 39936
    s_nop 0
    buffer_load_dwordx4 v167, s[4:7], s39 offen lds
    s_add_u32 m0, s38, 49152
    s_nop 0
    buffer_load_dwordx4 v168, s[8:11], s40 offen lds
    s_add_u32 m0, s38, 57344
    s_nop 0
    buffer_load_dwordx4 v169, s[8:11], s40 offen lds
    s_add_u32 m0, s38, 65536
    s_nop 0
    buffer_load_dwordx4 v170, s[8:11], s40 offen lds
    s_add_u32 m0, s38, 50176
    s_nop 0
    buffer_load_dwordx4 v171, s[8:11], s40 offen lds
    s_add_u32 m0, s38, 58368
    s_nop 0
    buffer_load_dwordx4 v172, s[8:11], s40 offen lds
    s_add_u32 m0, s38, 66560
    s_nop 0
    buffer_load_dwordx4 v173, s[8:11], s40 offen lds
    s_add_u32 m0, s38, 51200
    s_nop 0
    buffer_load_dwordx4 v174, s[8:11], s40 offen lds
    s_add_u32 m0, s38, 59392
    s_nop 0
    buffer_load_dwordx4 v175, s[8:11], s40 offen lds
    s_add_u32 m0, s38, 67584
    s_nop 0
    buffer_load_dwordx4 v176, s[8:11], s40 offen lds
    s_add_u32 m0, s38, 52224
    s_nop 0
    buffer_load_dwordx4 v177, s[8:11], s40 offen lds
    s_add_u32 m0, s38, 60416
    s_nop 0
    buffer_load_dwordx4 v178, s[8:11], s40 offen lds
    s_add_u32 m0, s38, 68608
    s_nop 0
    buffer_load_dwordx4 v179, s[8:11], s40 offen lds
    s_add_u32 s39, s39, 128
    s_add_u32 s40, s40, 393216
    s_waitcnt vmcnt(20)
    s_barrier
    s_add_u32 m0, s37, 0
    s_nop 0
    buffer_load_dwordx4 v160, s[4:7], s39 offen lds
    s_add_u32 m0, s37, 1024
    s_nop 0
    buffer_load_dwordx4 v161, s[4:7], s39 offen lds
    s_add_u32 m0, s37, 2048
    s_nop 0
    buffer_load_dwordx4 v162, s[4:7], s39 offen lds
    s_add_u32 m0, s37, 3072
    s_nop 0
    buffer_load_dwordx4 v163, s[4:7], s39 offen lds
    s_add_u32 m0, s37, 4096
    s_nop 0
    buffer_load_dwordx4 v164, s[4:7], s39 offen lds
    s_add_u32 m0, s37, 5120
    s_nop 0
    buffer_load_dwordx4 v165, s[4:7], s39 offen lds
    s_add_u32 m0, s37, 6144
    s_nop 0
    buffer_load_dwordx4 v166, s[4:7], s39 offen lds
    s_add_u32 m0, s37, 7168
    s_nop 0
    buffer_load_dwordx4 v167, s[4:7], s39 offen lds
    s_add_u32 m0, s38, 0
    s_nop 0
    buffer_load_dwordx4 v168, s[8:11], s40 offen lds
    s_add_u32 m0, s38, 8192
    s_nop 0
    buffer_load_dwordx4 v169, s[8:11], s40 offen lds
    s_add_u32 m0, s38, 16384
    s_nop 0
    buffer_load_dwordx4 v170, s[8:11], s40 offen lds
    s_add_u32 m0, s38, 1024
    s_nop 0
    buffer_load_dwordx4 v171, s[8:11], s40 offen lds
    s_add_u32 m0, s38, 9216
    s_nop 0
    buffer_load_dwordx4 v172, s[8:11], s40 offen lds
    s_add_u32 m0, s38, 17408
    s_nop 0
    buffer_load_dwordx4 v173, s[8:11], s40 offen lds
    s_add_u32 m0, s38, 2048
    s_nop 0
    buffer_load_dwordx4 v174, s[8:11], s40 offen lds
    s_add_u32 m0, s38, 10240
    s_nop 0
    buffer_load_dwordx4 v175, s[8:11], s40 offen lds
    s_add_u32 m0, s38, 18432
    s_nop 0
    buffer_load_dwordx4 v176, s[8:11], s40 offen lds
    s_add_u32 m0, s38, 3072
    s_nop 0
    buffer_load_dwordx4 v177, s[8:11], s40 offen lds
    s_add_u32 m0, s38, 11264
    s_nop 0
    buffer_load_dwordx4 v178, s[8:11], s40 offen lds
    s_add_u32 m0, s38, 19456
    s_nop 0
    buffer_load_dwordx4 v179, s[8:11], s40 offen lds
    s_add_u32 s39, s39, 128
    s_add_u32 s40, s40, 393216
    s_waitcnt vmcnt(20)
    s_barrier
    s_waitcnt vmcnt(0)
    s_barrier
    s_branch K1_END
K1_PREP:
    s_mov_b32 s20, s68
    s_and_b32 s21, s69, 0xffff
    s_mov_b32 s22, 4194304
    s_mov_b32 s23, 0x00020000
    s_mov_b32 s24, s70
    s_and_b32 s25, s71, 0xffff
    s_mov_b32 s26, 4194304
    s_mov_b32 s27, 0x00020000
    s_mov_b32 s28, s72
    s_and_b32 s29, s73, 0xffff
    s_mov_b32 s30, 8192
    s_mov_b32 s31, 0x00020000
    v_and_b32 v210, 127, v210
    s_lshr_b32 s42, s2, 4
    s_lshl_b32 s42, s42, 7
    s_and_b32 s43, s2, 15
    s_lshl_b32 s43, s43, 6
    v_lshrrev_b32 v128, 3, v210
    v_lshlrev_b32 v128, 2, v128
    v_add_u32 v128, s42, v128
    v_and_b32 v129, 7, v210
    v_lshlrev_b32 v129, 3, v129
    v_add_u32 v129, s43, v129
    v_lshlrev_b32 v134, 11, v128
    v_lshlrev_b32 v131, 1, v129
    v_add_u32 v134, v134, v131
    v_add_u32 v146, 0, v134
    v_subrev_u32 v144, 6144, v146
    v_subrev_u32 v145, 2048, v146
    v_add_u32 v147, 4096, v146
    v_add_u32 v150, 131072, v134
    v_subrev_u32 v148, 6144, v150
    v_subrev_u32 v149, 2048, v150
    v_add_u32 v151, 4096, v150
    v_lshlrev_b32 v131, 3, v129
    s_movk_i32 s43, 4608
    v_mul_lo_u32 v132, v129, s43
    v_lshlrev_b32 v133, 1, v128
    v_sub_u32 v132, v132, v133
    v_add_u32 v132, 3960, v132
    s_barrier
    s_barrier
    s_barrier
    s_barrier
    buffer_load_dwordx4 v[88:91], v131, s[28:31], 0 offen offset:0
    buffer_load_dwordx4 v[92:95], v131, s[28:31], 0 offen offset:16
    buffer_load_dwordx4 v[96:99], v131, s[28:31], 0 offen offset:32
    buffer_load_dwordx4 v[100:103], v131, s[28:31], 0 offen offset:48
    buffer_load_dwordx4 v[0:3], v144, s[20:23], 0 offen offset:0 nt
    s_barrier
    buffer_load_dwordx4 v[4:7], v144, s[20:23], 0 offen offset:2048 nt
    buffer_load_dwordx4 v[8:11], v145, s[20:23], 0 offen nt
    buffer_load_dwordx4 v[12:15], v146, s[20:23], 0 offen offset:0 nt
    buffer_load_dwordx4 v[28:31], v146, s[24:27], 0 offen offset:0 nt
    buffer_load_dwordx4 v[16:19], v146, s[20:23], 0 offen offset:2048 nt
    s_barrier
    buffer_load_dwordx4 v[32:35], v146, s[24:27], 0 offen offset:2048 nt
    buffer_load_dwordx4 v[20:23], v147, s[20:23], 0 offen offset:0 nt
    buffer_load_dwordx4 v[36:39], v147, s[24:27], 0 offen offset:0 nt
    buffer_load_dwordx4 v[24:27], v147, s[20:23], 0 offen offset:2048 nt
    buffer_load_dwordx4 v[40:43], v147, s[24:27], 0 offen offset:2048 nt
    s_barrier
    buffer_load_dwordx4 v[44:47], v148, s[20:23], 0 offen offset:0 nt
    buffer_load_dwordx4 v[48:51], v148, s[20:23], 0 offen offset:2048 nt
    buffer_load_dwordx4 v[52:55], v149, s[20:23], 0 offen nt
    buffer_load_dwordx4 v[56:59], v150, s[20:23], 0 offen offset:0 nt
    buffer_load_dwordx4 v[72:75], v150, s[24:27], 0 offen offset:0 nt
    s_barrier
    buffer_load_dwordx4 v[60:63], v150, s[20:23], 0 offen offset:2048 nt
    buffer_load_dwordx4 v[76:79], v150, s[24:27], 0 offen offset:2048 nt
    buffer_load_dwordx4 v[64:67], v151, s[20:23], 0 offen offset:0 nt
    buffer_load_dwordx4 v[80:83], v151, s[24:27], 0 offen offset:0 nt
    buffer_load_dwordx4 v[68:71], v151, s[20:23], 0 offen offset:2048 nt
    s_barrier
    buffer_load_dwordx4 v[84:87], v151, s[24:27], 0 offen offset:2048 nt
    s_barrier
    s_waitcnt vmcnt(0)
    v_lshlrev_b32 v111, 16, v88
    v_and_b32 v112, 0xffff0000, v88
    v_lshlrev_b32 v113, 16, v89
    v_and_b32 v114, 0xffff0000, v89
    v_lshlrev_b32 v104, 16, v0
    v_lshlrev_b32 v105, 16, v4
    v_lshlrev_b32 v106, 16, v8
    v_lshlrev_b32 v107, 16, v12
    v_lshlrev_b32 v108, 16, v16
    v_lshlrev_b32 v109, 16, v20
    v_lshlrev_b32 v110, 16, v24
    v_lshlrev_b32 v115, 16, v28
    v_lshlrev_b32 v116, 16, v32
    v_lshlrev_b32 v117, 16, v36
    v_lshlrev_b32 v118, 16, v40
    v_mul_f32 v119, v104, v114
    v_mul_f32 v120, v105, v114
    v_mul_f32 v121, v106, v114
    v_mul_f32 v122, v107, v114
    v_cvt_pk_bf16_f32 v119, 0, v119
    v_cvt_pk_bf16_f32 v120, 0, v120
    v_cvt_pk_bf16_f32 v121, 0, v121
    v_cvt_pk_bf16_f32 v122, 0, v122
    v_mul_f32 v152, v105, v113
    v_mul_f32 v153, v106, v113
    v_mul_f32 v154, v107, v113
    v_mul_f32 v155, v108, v113
    v_cvt_pk_bf16_f32 v152, 0, v152
    v_cvt_pk_bf16_f32 v153, 0, v153
    v_cvt_pk_bf16_f32 v154, 0, v154
    v_cvt_pk_bf16_f32 v155, 0, v155
    v_add_f32 v119, v119, v152
    v_add_f32 v120, v120, v153
    v_add_f32 v121, v121, v154
    v_add_f32 v122, v122, v155
    v_cvt_pk_bf16_f32 v119, 0, v119
    v_cvt_pk_bf16_f32 v120, 0, v120
    v_cvt_pk_bf16_f32 v121, 0, v121
    v_cvt_pk_bf16_f32 v122, 0, v122
    v_mul_f32 v152, v106, v112
    v_mul_f32 v153, v107, v112
    v_mul_f32 v154, v108, v112
    v_mul_f32 v155, v109, v112
    v_cvt_pk_bf16_f32 v152, 0, v152
    v_cvt_pk_bf16_f32 v153, 0, v153
    v_cvt_pk_bf16_f32 v154, 0, v154
    v_cvt_pk_bf16_f32 v155, 0, v155
    v_add_f32 v119, v119, v152
    v_add_f32 v120, v120, v153
    v_add_f32 v121, v121, v154
    v_add_f32 v122, v122, v155
    v_cvt_pk_bf16_f32 v119, 0, v119
    v_cvt_pk_bf16_f32 v120, 0, v120
    v_cvt_pk_bf16_f32 v121, 0, v121
    v_cvt_pk_bf16_f32 v122, 0, v122
    v_mul_f32 v152, v107, v111
    v_mul_f32 v153, v108, v111
    v_mul_f32 v154, v109, v111
    v_mul_f32 v155, v110, v111
    v_cvt_pk_bf16_f32 v152, 0, v152
    v_cvt_pk_bf16_f32 v153, 0, v153
    v_cvt_pk_bf16_f32 v154, 0, v154
    v_cvt_pk_bf16_f32 v155, 0, v155
    v_add_f32 v119, v119, v152
    v_add_f32 v120, v120, v153
    v_add_f32 v121, v121, v154
    v_add_f32 v122, v122, v155
    v_cvt_pk_bf16_f32 v119, 0, v119
    v_cvt_pk_bf16_f32 v120, 0, v120
    v_cvt_pk_bf16_f32 v121, 0, v121
    v_cvt_pk_bf16_f32 v122, 0, v122
    v_mul_f32 v119, v119, v115
    v_mul_f32 v120, v120, v116
    v_mul_f32 v121, v121, v117
    v_mul_f32 v122, v122, v118
    v_cvt_pk_bf16_f32 v124, v122, v121
    v_cvt_pk_bf16_f32 v125, v120, v119
    buffer_store_dwordx2 v[124:125], v132, s[12:15], 0 offen offset:128
    v_lshlrev_b32 v104, 16, v44
    v_lshlrev_b32 v105, 16, v48
    v_lshlrev_b32 v106, 16, v52
    v_lshlrev_b32 v107, 16, v56
    v_lshlrev_b32 v108, 16, v60
    v_lshlrev_b32 v109, 16, v64
    v_lshlrev_b32 v110, 16, v68
    v_lshlrev_b32 v115, 16, v72
    v_lshlrev_b32 v116, 16, v76
    v_lshlrev_b32 v117, 16, v80
    v_lshlrev_b32 v118, 16, v84
    v_mul_f32 v119, v104, v114
    v_mul_f32 v120, v105, v114
    v_mul_f32 v121, v106, v114
    v_mul_f32 v122, v107, v114
    v_cvt_pk_bf16_f32 v119, 0, v119
    v_cvt_pk_bf16_f32 v120, 0, v120
    v_cvt_pk_bf16_f32 v121, 0, v121
    v_cvt_pk_bf16_f32 v122, 0, v122
    v_mul_f32 v152, v105, v113
    v_mul_f32 v153, v106, v113
    v_mul_f32 v154, v107, v113
    v_mul_f32 v155, v108, v113
    v_cvt_pk_bf16_f32 v152, 0, v152
    v_cvt_pk_bf16_f32 v153, 0, v153
    v_cvt_pk_bf16_f32 v154, 0, v154
    v_cvt_pk_bf16_f32 v155, 0, v155
    v_add_f32 v119, v119, v152
    v_add_f32 v120, v120, v153
    v_add_f32 v121, v121, v154
    v_add_f32 v122, v122, v155
    v_cvt_pk_bf16_f32 v119, 0, v119
    v_cvt_pk_bf16_f32 v120, 0, v120
    v_cvt_pk_bf16_f32 v121, 0, v121
    v_cvt_pk_bf16_f32 v122, 0, v122
    v_mul_f32 v152, v106, v112
    v_mul_f32 v153, v107, v112
    v_mul_f32 v154, v108, v112
    v_mul_f32 v155, v109, v112
    v_cvt_pk_bf16_f32 v152, 0, v152
    v_cvt_pk_bf16_f32 v153, 0, v153
    v_cvt_pk_bf16_f32 v154, 0, v154
    v_cvt_pk_bf16_f32 v155, 0, v155
    v_add_f32 v119, v119, v152
    v_add_f32 v120, v120, v153
    v_add_f32 v121, v121, v154
    v_add_f32 v122, v122, v155
    v_cvt_pk_bf16_f32 v119, 0, v119
    v_cvt_pk_bf16_f32 v120, 0, v120
    v_cvt_pk_bf16_f32 v121, 0, v121
    v_cvt_pk_bf16_f32 v122, 0, v122
    v_mul_f32 v152, v107, v111
    v_mul_f32 v153, v108, v111
    v_mul_f32 v154, v109, v111
    v_mul_f32 v155, v110, v111
    v_cvt_pk_bf16_f32 v152, 0, v152
    v_cvt_pk_bf16_f32 v153, 0, v153
    v_cvt_pk_bf16_f32 v154, 0, v154
    v_cvt_pk_bf16_f32 v155, 0, v155
    v_add_f32 v119, v119, v152
    v_add_f32 v120, v120, v153
    v_add_f32 v121, v121, v154
    v_add_f32 v122, v122, v155
    v_cvt_pk_bf16_f32 v119, 0, v119
    v_cvt_pk_bf16_f32 v120, 0, v120
    v_cvt_pk_bf16_f32 v121, 0, v121
    v_cvt_pk_bf16_f32 v122, 0, v122
    v_mul_f32 v119, v119, v115
    v_mul_f32 v120, v120, v116
    v_mul_f32 v121, v121, v117
    v_mul_f32 v122, v122, v118
    v_cvt_pk_bf16_f32 v126, v122, v121
    v_cvt_pk_bf16_f32 v127, v120, v119
    buffer_store_dwordx2 v[126:127], v132, s[12:15], 0 offen offset:0
    v_add_u32 v132, 4608, v132
    s_barrier
    v_lshlrev_b32 v111, 16, v90
    v_and_b32 v112, 0xffff0000, v90
    v_lshlrev_b32 v113, 16, v91
    v_and_b32 v114, 0xffff0000, v91
    v_and_b32 v104, 0xffff0000, v0
    v_and_b32 v105, 0xffff0000, v4
    v_and_b32 v106, 0xffff0000, v8
    v_and_b32 v107, 0xffff0000, v12
    v_and_b32 v108, 0xffff0000, v16
    v_and_b32 v109, 0xffff0000, v20
    v_and_b32 v110, 0xffff0000, v24
    v_and_b32 v115, 0xffff0000, v28
    v_and_b32 v116, 0xffff0000, v32
    v_and_b32 v117, 0xffff0000, v36
    v_and_b32 v118, 0xffff0000, v40
    v_mul_f32 v119, v104, v114
    v_mul_f32 v120, v105, v114
    v_mul_f32 v121, v106, v114
    v_mul_f32 v122, v107, v114
    v_cvt_pk_bf16_f32 v119, 0, v119
    v_cvt_pk_bf16_f32 v120, 0, v120
    v_cvt_pk_bf16_f32 v121, 0, v121
    v_cvt_pk_bf16_f32 v122, 0, v122
    v_mul_f32 v152, v105, v113
    v_mul_f32 v153, v106, v113
    v_mul_f32 v154, v107, v113
    v_mul_f32 v155, v108, v113
    v_cvt_pk_bf16_f32 v152, 0, v152
    v_cvt_pk_bf16_f32 v153, 0, v153
    v_cvt_pk_bf16_f32 v154, 0, v154
    v_cvt_pk_bf16_f32 v155, 0, v155
    v_add_f32 v119, v119, v152
    v_add_f32 v120, v120, v153
    v_add_f32 v121, v121, v154
    v_add_f32 v122, v122, v155
    v_cvt_pk_bf16_f32 v119, 0, v119
    v_cvt_pk_bf16_f32 v120, 0, v120
    v_cvt_pk_bf16_f32 v121, 0, v121
    v_cvt_pk_bf16_f32 v122, 0, v122
    v_mul_f32 v152, v106, v112
    v_mul_f32 v153, v107, v112
    v_mul_f32 v154, v108, v112
    v_mul_f32 v155, v109, v112
    v_cvt_pk_bf16_f32 v152, 0, v152
    v_cvt_pk_bf16_f32 v153, 0, v153
    v_cvt_pk_bf16_f32 v154, 0, v154
    v_cvt_pk_bf16_f32 v155, 0, v155
    v_add_f32 v119, v119, v152
    v_add_f32 v120, v120, v153
    v_add_f32 v121, v121, v154
    v_add_f32 v122, v122, v155
    v_cvt_pk_bf16_f32 v119, 0, v119
    v_cvt_pk_bf16_f32 v120, 0, v120
    v_cvt_pk_bf16_f32 v121, 0, v121
    v_cvt_pk_bf16_f32 v122, 0, v122
    v_mul_f32 v152, v107, v111
    v_mul_f32 v153, v108, v111
    v_mul_f32 v154, v109, v111
    v_mul_f32 v155, v110, v111
    v_cvt_pk_bf16_f32 v152, 0, v152
    v_cvt_pk_bf16_f32 v153, 0, v153
    v_cvt_pk_bf16_f32 v154, 0, v154
    v_cvt_pk_bf16_f32 v155, 0, v155
    v_add_f32 v119, v119, v152
    v_add_f32 v120, v120, v153
    v_add_f32 v121, v121, v154
    v_add_f32 v122, v122, v155
    v_cvt_pk_bf16_f32 v119, 0, v119
    v_cvt_pk_bf16_f32 v120, 0, v120
    v_cvt_pk_bf16_f32 v121, 0, v121
    v_cvt_pk_bf16_f32 v122, 0, v122
    v_mul_f32 v119, v119, v115
    v_mul_f32 v120, v120, v116
    v_mul_f32 v121, v121, v117
    v_mul_f32 v122, v122, v118
    v_cvt_pk_bf16_f32 v124, v122, v121
    v_cvt_pk_bf16_f32 v125, v120, v119
    buffer_store_dwordx2 v[124:125], v132, s[12:15], 0 offen offset:128
    v_and_b32 v104, 0xffff0000, v44
    v_and_b32 v105, 0xffff0000, v48
    v_and_b32 v106, 0xffff0000, v52
    v_and_b32 v107, 0xffff0000, v56
    v_and_b32 v108, 0xffff0000, v60
    v_and_b32 v109, 0xffff0000, v64
    v_and_b32 v110, 0xffff0000, v68
    v_and_b32 v115, 0xffff0000, v72
    v_and_b32 v116, 0xffff0000, v76
    v_and_b32 v117, 0xffff0000, v80
    v_and_b32 v118, 0xffff0000, v84
    v_mul_f32 v119, v104, v114
    v_mul_f32 v120, v105, v114
    v_mul_f32 v121, v106, v114
    v_mul_f32 v122, v107, v114
    v_cvt_pk_bf16_f32 v119, 0, v119
    v_cvt_pk_bf16_f32 v120, 0, v120
    v_cvt_pk_bf16_f32 v121, 0, v121
    v_cvt_pk_bf16_f32 v122, 0, v122
    v_mul_f32 v152, v105, v113
    v_mul_f32 v153, v106, v113
    v_mul_f32 v154, v107, v113
    v_mul_f32 v155, v108, v113
    v_cvt_pk_bf16_f32 v152, 0, v152
    v_cvt_pk_bf16_f32 v153, 0, v153
    v_cvt_pk_bf16_f32 v154, 0, v154
    v_cvt_pk_bf16_f32 v155, 0, v155
    v_add_f32 v119, v119, v152
    v_add_f32 v120, v120, v153
    v_add_f32 v121, v121, v154
    v_add_f32 v122, v122, v155
    v_cvt_pk_bf16_f32 v119, 0, v119
    v_cvt_pk_bf16_f32 v120, 0, v120
    v_cvt_pk_bf16_f32 v121, 0, v121
    v_cvt_pk_bf16_f32 v122, 0, v122
    v_mul_f32 v152, v106, v112
    v_mul_f32 v153, v107, v112
    v_mul_f32 v154, v108, v112
    v_mul_f32 v155, v109, v112
    v_cvt_pk_bf16_f32 v152, 0, v152
    v_cvt_pk_bf16_f32 v153, 0, v153
    v_cvt_pk_bf16_f32 v154, 0, v154
    v_cvt_pk_bf16_f32 v155, 0, v155
    v_add_f32 v119, v119, v152
    v_add_f32 v120, v120, v153
    v_add_f32 v121, v121, v154
    v_add_f32 v122, v122, v155
    v_cvt_pk_bf16_f32 v119, 0, v119
    v_cvt_pk_bf16_f32 v120, 0, v120
    v_cvt_pk_bf16_f32 v121, 0, v121
    v_cvt_pk_bf16_f32 v122, 0, v122
    v_mul_f32 v152, v107, v111
    v_mul_f32 v153, v108, v111
    v_mul_f32 v154, v109, v111
    v_mul_f32 v155, v110, v111
    v_cvt_pk_bf16_f32 v152, 0, v152
    v_cvt_pk_bf16_f32 v153, 0, v153
    v_cvt_pk_bf16_f32 v154, 0, v154
    v_cvt_pk_bf16_f32 v155, 0, v155
    v_add_f32 v119, v119, v152
    v_add_f32 v120, v120, v153
    v_add_f32 v121, v121, v154
    v_add_f32 v122, v122, v155
    v_cvt_pk_bf16_f32 v119, 0, v119
    v_cvt_pk_bf16_f32 v120, 0, v120
    v_cvt_pk_bf16_f32 v121, 0, v121
    v_cvt_pk_bf16_f32 v122, 0, v122
    v_mul_f32 v119, v119, v115
    v_mul_f32 v120, v120, v116
    v_mul_f32 v121, v121, v117
    v_mul_f32 v122, v122, v118
    v_cvt_pk_bf16_f32 v126, v122, v121
    v_cvt_pk_bf16_f32 v127, v120, v119
    buffer_store_dwordx2 v[126:127], v132, s[12:15], 0 offen offset:0
    v_add_u32 v132, 4608, v132
    s_barrier
    v_lshlrev_b32 v111, 16, v92
    v_and_b32 v112, 0xffff0000, v92
    v_lshlrev_b32 v113, 16, v93
    v_and_b32 v114, 0xffff0000, v93
    v_lshlrev_b32 v104, 16, v1
    v_lshlrev_b32 v105, 16, v5
    v_lshlrev_b32 v106, 16, v9
    v_lshlrev_b32 v107, 16, v13
    v_lshlrev_b32 v108, 16, v17
    v_lshlrev_b32 v109, 16, v21
    v_lshlrev_b32 v110, 16, v25
    v_lshlrev_b32 v115, 16, v29
    v_lshlrev_b32 v116, 16, v33
    v_lshlrev_b32 v117, 16, v37
    v_lshlrev_b32 v118, 16, v41
    v_mul_f32 v119, v104, v114
    v_mul_f32 v120, v105, v114
    v_mul_f32 v121, v106, v114
    v_mul_f32 v122, v107, v114
    v_cvt_pk_bf16_f32 v119, 0, v119
    v_cvt_pk_bf16_f32 v120, 0, v120
    v_cvt_pk_bf16_f32 v121, 0, v121
    v_cvt_pk_bf16_f32 v122, 0, v122
    v_mul_f32 v152, v105, v113
    v_mul_f32 v153, v106, v113
    v_mul_f32 v154, v107, v113
    v_mul_f32 v155, v108, v113
    v_cvt_pk_bf16_f32 v152, 0, v152
    v_cvt_pk_bf16_f32 v153, 0, v153
    v_cvt_pk_bf16_f32 v154, 0, v154
    v_cvt_pk_bf16_f32 v155, 0, v155
    v_add_f32 v119, v119, v152
    v_add_f32 v120, v120, v153
    v_add_f32 v121, v121, v154
    v_add_f32 v122, v122, v155
    v_cvt_pk_bf16_f32 v119, 0, v119
    v_cvt_pk_bf16_f32 v120, 0, v120
    v_cvt_pk_bf16_f32 v121, 0, v121
    v_cvt_pk_bf16_f32 v122, 0, v122
    v_mul_f32 v152, v106, v112
    v_mul_f32 v153, v107, v112
    v_mul_f32 v154, v108, v112
    v_mul_f32 v155, v109, v112
    v_cvt_pk_bf16_f32 v152, 0, v152
    v_cvt_pk_bf16_f32 v153, 0, v153
    v_cvt_pk_bf16_f32 v154, 0, v154
    v_cvt_pk_bf16_f32 v155, 0, v155
    v_add_f32 v119, v119, v152
    v_add_f32 v120, v120, v153
    v_add_f32 v121, v121, v154
    v_add_f32 v122, v122, v155
    v_cvt_pk_bf16_f32 v119, 0, v119
    v_cvt_pk_bf16_f32 v120, 0, v120
    v_cvt_pk_bf16_f32 v121, 0, v121
    v_cvt_pk_bf16_f32 v122, 0, v122
    v_mul_f32 v152, v107, v111
    v_mul_f32 v153, v108, v111
    v_mul_f32 v154, v109, v111
    v_mul_f32 v155, v110, v111
    v_cvt_pk_bf16_f32 v152, 0, v152
    v_cvt_pk_bf16_f32 v153, 0, v153
    v_cvt_pk_bf16_f32 v154, 0, v154
    v_cvt_pk_bf16_f32 v155, 0, v155
    v_add_f32 v119, v119, v152
    v_add_f32 v120, v120, v153
    v_add_f32 v121, v121, v154
    v_add_f32 v122, v122, v155
    v_cvt_pk_bf16_f32 v119, 0, v119
    v_cvt_pk_bf16_f32 v120, 0, v120
    v_cvt_pk_bf16_f32 v121, 0, v121
    v_cvt_pk_bf16_f32 v122, 0, v122
    v_mul_f32 v119, v119, v115
    v_mul_f32 v120, v120, v116
    v_mul_f32 v121, v121, v117
    v_mul_f32 v122, v122, v118
    v_cvt_pk_bf16_f32 v124, v122, v121
    v_cvt_pk_bf16_f32 v125, v120, v119
    buffer_store_dwordx2 v[124:125], v132, s[12:15], 0 offen offset:128
    v_lshlrev_b32 v104, 16, v45
    v_lshlrev_b32 v105, 16, v49
    v_lshlrev_b32 v106, 16, v53
    v_lshlrev_b32 v107, 16, v57
    v_lshlrev_b32 v108, 16, v61
    v_lshlrev_b32 v109, 16, v65
    v_lshlrev_b32 v110, 16, v69
    v_lshlrev_b32 v115, 16, v73
    v_lshlrev_b32 v116, 16, v77
    v_lshlrev_b32 v117, 16, v81
    v_lshlrev_b32 v118, 16, v85
    v_mul_f32 v119, v104, v114
    v_mul_f32 v120, v105, v114
    v_mul_f32 v121, v106, v114
    v_mul_f32 v122, v107, v114
    v_cvt_pk_bf16_f32 v119, 0, v119
    v_cvt_pk_bf16_f32 v120, 0, v120
    v_cvt_pk_bf16_f32 v121, 0, v121
    v_cvt_pk_bf16_f32 v122, 0, v122
    v_mul_f32 v152, v105, v113
    v_mul_f32 v153, v106, v113
    v_mul_f32 v154, v107, v113
    v_mul_f32 v155, v108, v113
    v_cvt_pk_bf16_f32 v152, 0, v152
    v_cvt_pk_bf16_f32 v153, 0, v153
    v_cvt_pk_bf16_f32 v154, 0, v154
    v_cvt_pk_bf16_f32 v155, 0, v155
    v_add_f32 v119, v119, v152
    v_add_f32 v120, v120, v153
    v_add_f32 v121, v121, v154
    v_add_f32 v122, v122, v155
    v_cvt_pk_bf16_f32 v119, 0, v119
    v_cvt_pk_bf16_f32 v120, 0, v120
    v_cvt_pk_bf16_f32 v121, 0, v121
    v_cvt_pk_bf16_f32 v122, 0, v122
    v_mul_f32 v152, v106, v112
    v_mul_f32 v153, v107, v112
    v_mul_f32 v154, v108, v112
    v_mul_f32 v155, v109, v112
    v_cvt_pk_bf16_f32 v152, 0, v152
    v_cvt_pk_bf16_f32 v153, 0, v153
    v_cvt_pk_bf16_f32 v154, 0, v154
    v_cvt_pk_bf16_f32 v155, 0, v155
    v_add_f32 v119, v119, v152
    v_add_f32 v120, v120, v153
    v_add_f32 v121, v121, v154
    v_add_f32 v122, v122, v155
    v_cvt_pk_bf16_f32 v119, 0, v119
    v_cvt_pk_bf16_f32 v120, 0, v120
    v_cvt_pk_bf16_f32 v121, 0, v121
    v_cvt_pk_bf16_f32 v122, 0, v122
    v_mul_f32 v152, v107, v111
    v_mul_f32 v153, v108, v111
    v_mul_f32 v154, v109, v111
    v_mul_f32 v155, v110, v111
    v_cvt_pk_bf16_f32 v152, 0, v152
    v_cvt_pk_bf16_f32 v153, 0, v153
    v_cvt_pk_bf16_f32 v154, 0, v154
    v_cvt_pk_bf16_f32 v155, 0, v155
    v_add_f32 v119, v119, v152
    v_add_f32 v120, v120, v153
    v_add_f32 v121, v121, v154
    v_add_f32 v122, v122, v155
    v_cvt_pk_bf16_f32 v119, 0, v119
    v_cvt_pk_bf16_f32 v120, 0, v120
    v_cvt_pk_bf16_f32 v121, 0, v121
    v_cvt_pk_bf16_f32 v122, 0, v122
    v_mul_f32 v119, v119, v115
    v_mul_f32 v120, v120, v116
    v_mul_f32 v121, v121, v117
    v_mul_f32 v122, v122, v118
    v_cvt_pk_bf16_f32 v126, v122, v121
    v_cvt_pk_bf16_f32 v127, v120, v119
    buffer_store_dwordx2 v[126:127], v132, s[12:15], 0 offen offset:0
    v_add_u32 v132, 4608, v132
    s_barrier
    v_lshlrev_b32 v111, 16, v94
    v_and_b32 v112, 0xffff0000, v94
    v_lshlrev_b32 v113, 16, v95
    v_and_b32 v114, 0xffff0000, v95
    v_and_b32 v104, 0xffff0000, v1
    v_and_b32 v105, 0xffff0000, v5
    v_and_b32 v106, 0xffff0000, v9
    v_and_b32 v107, 0xffff0000, v13
    v_and_b32 v108, 0xffff0000, v17
    v_and_b32 v109, 0xffff0000, v21
    v_and_b32 v110, 0xffff0000, v25
    v_and_b32 v115, 0xffff0000, v29
    v_and_b32 v116, 0xffff0000, v33
    v_and_b32 v117, 0xffff0000, v37
    v_and_b32 v118, 0xffff0000, v41
    v_mul_f32 v119, v104, v114
    v_mul_f32 v120, v105, v114
    v_mul_f32 v121, v106, v114
    v_mul_f32 v122, v107, v114
    v_cvt_pk_bf16_f32 v119, 0, v119
    v_cvt_pk_bf16_f32 v120, 0, v120
    v_cvt_pk_bf16_f32 v121, 0, v121
    v_cvt_pk_bf16_f32 v122, 0, v122
    v_mul_f32 v152, v105, v113
    v_mul_f32 v153, v106, v113
    v_mul_f32 v154, v107, v113
    v_mul_f32 v155, v108, v113
    v_cvt_pk_bf16_f32 v152, 0, v152
    v_cvt_pk_bf16_f32 v153, 0, v153
    v_cvt_pk_bf16_f32 v154, 0, v154
    v_cvt_pk_bf16_f32 v155, 0, v155
    v_add_f32 v119, v119, v152
    v_add_f32 v120, v120, v153
    v_add_f32 v121, v121, v154
    v_add_f32 v122, v122, v155
    v_cvt_pk_bf16_f32 v119, 0, v119
    v_cvt_pk_bf16_f32 v120, 0, v120
    v_cvt_pk_bf16_f32 v121, 0, v121
    v_cvt_pk_bf16_f32 v122, 0, v122
    v_mul_f32 v152, v106, v112
    v_mul_f32 v153, v107, v112
    v_mul_f32 v154, v108, v112
    v_mul_f32 v155, v109, v112
    v_cvt_pk_bf16_f32 v152, 0, v152
    v_cvt_pk_bf16_f32 v153, 0, v153
    v_cvt_pk_bf16_f32 v154, 0, v154
    v_cvt_pk_bf16_f32 v155, 0, v155
    v_add_f32 v119, v119, v152
    v_add_f32 v120, v120, v153
    v_add_f32 v121, v121, v154
    v_add_f32 v122, v122, v155
    v_cvt_pk_bf16_f32 v119, 0, v119
    v_cvt_pk_bf16_f32 v120, 0, v120
    v_cvt_pk_bf16_f32 v121, 0, v121
    v_cvt_pk_bf16_f32 v122, 0, v122
    v_mul_f32 v152, v107, v111
    v_mul_f32 v153, v108, v111
    v_mul_f32 v154, v109, v111
    v_mul_f32 v155, v110, v111
    v_cvt_pk_bf16_f32 v152, 0, v152
    v_cvt_pk_bf16_f32 v153, 0, v153
    v_cvt_pk_bf16_f32 v154, 0, v154
    v_cvt_pk_bf16_f32 v155, 0, v155
    v_add_f32 v119, v119, v152
    v_add_f32 v120, v120, v153
    v_add_f32 v121, v121, v154
    v_add_f32 v122, v122, v155
    v_cvt_pk_bf16_f32 v119, 0, v119
    v_cvt_pk_bf16_f32 v120, 0, v120
    v_cvt_pk_bf16_f32 v121, 0, v121
    v_cvt_pk_bf16_f32 v122, 0, v122
    v_mul_f32 v119, v119, v115
    v_mul_f32 v120, v120, v116
    v_mul_f32 v121, v121, v117
    v_mul_f32 v122, v122, v118
    v_cvt_pk_bf16_f32 v124, v122, v121
    v_cvt_pk_bf16_f32 v125, v120, v119
    buffer_store_dwordx2 v[124:125], v132, s[12:15], 0 offen offset:128
    v_and_b32 v104, 0xffff0000, v45
    v_and_b32 v105, 0xffff0000, v49
    v_and_b32 v106, 0xffff0000, v53
    v_and_b32 v107, 0xffff0000, v57
    v_and_b32 v108, 0xffff0000, v61
    v_and_b32 v109, 0xffff0000, v65
    v_and_b32 v110, 0xffff0000, v69
    v_and_b32 v115, 0xffff0000, v73
    v_and_b32 v116, 0xffff0000, v77
    v_and_b32 v117, 0xffff0000, v81
    v_and_b32 v118, 0xffff0000, v85
    v_mul_f32 v119, v104, v114
    v_mul_f32 v120, v105, v114
    v_mul_f32 v121, v106, v114
    v_mul_f32 v122, v107, v114
    v_cvt_pk_bf16_f32 v119, 0, v119
    v_cvt_pk_bf16_f32 v120, 0, v120
    v_cvt_pk_bf16_f32 v121, 0, v121
    v_cvt_pk_bf16_f32 v122, 0, v122
    v_mul_f32 v152, v105, v113
    v_mul_f32 v153, v106, v113
    v_mul_f32 v154, v107, v113
    v_mul_f32 v155, v108, v113
    v_cvt_pk_bf16_f32 v152, 0, v152
    v_cvt_pk_bf16_f32 v153, 0, v153
    v_cvt_pk_bf16_f32 v154, 0, v154
    v_cvt_pk_bf16_f32 v155, 0, v155
    v_add_f32 v119, v119, v152
    v_add_f32 v120, v120, v153
    v_add_f32 v121, v121, v154
    v_add_f32 v122, v122, v155
    v_cvt_pk_bf16_f32 v119, 0, v119
    v_cvt_pk_bf16_f32 v120, 0, v120
    v_cvt_pk_bf16_f32 v121, 0, v121
    v_cvt_pk_bf16_f32 v122, 0, v122
    v_mul_f32 v152, v106, v112
    v_mul_f32 v153, v107, v112
    v_mul_f32 v154, v108, v112
    v_mul_f32 v155, v109, v112
    v_cvt_pk_bf16_f32 v152, 0, v152
    v_cvt_pk_bf16_f32 v153, 0, v153
    v_cvt_pk_bf16_f32 v154, 0, v154
    v_cvt_pk_bf16_f32 v155, 0, v155
    v_add_f32 v119, v119, v152
    v_add_f32 v120, v120, v153
    v_add_f32 v121, v121, v154
    v_add_f32 v122, v122, v155
    v_cvt_pk_bf16_f32 v119, 0, v119
    v_cvt_pk_bf16_f32 v120, 0, v120
    v_cvt_pk_bf16_f32 v121, 0, v121
    v_cvt_pk_bf16_f32 v122, 0, v122
    v_mul_f32 v152, v107, v111
    v_mul_f32 v153, v108, v111
    v_mul_f32 v154, v109, v111
    v_mul_f32 v155, v110, v111
    v_cvt_pk_bf16_f32 v152, 0, v152
    v_cvt_pk_bf16_f32 v153, 0, v153
    v_cvt_pk_bf16_f32 v154, 0, v154
    v_cvt_pk_bf16_f32 v155, 0, v155
    v_add_f32 v119, v119, v152
    v_add_f32 v120, v120, v153
    v_add_f32 v121, v121, v154
    v_add_f32 v122, v122, v155
    v_cvt_pk_bf16_f32 v119, 0, v119
    v_cvt_pk_bf16_f32 v120, 0, v120
    v_cvt_pk_bf16_f32 v121, 0, v121
    v_cvt_pk_bf16_f32 v122, 0, v122
    v_mul_f32 v119, v119, v115
    v_mul_f32 v120, v120, v116
    v_mul_f32 v121, v121, v117
    v_mul_f32 v122, v122, v118
    v_cvt_pk_bf16_f32 v126, v122, v121
    v_cvt_pk_bf16_f32 v127, v120, v119
    buffer_store_dwordx2 v[126:127], v132, s[12:15], 0 offen offset:0
    v_add_u32 v132, 4608, v132
    s_barrier
    v_lshlrev_b32 v111, 16, v96
    v_and_b32 v112, 0xffff0000, v96
    v_lshlrev_b32 v113, 16, v97
    v_and_b32 v114, 0xffff0000, v97
    v_lshlrev_b32 v104, 16, v2
    v_lshlrev_b32 v105, 16, v6
    v_lshlrev_b32 v106, 16, v10
    v_lshlrev_b32 v107, 16, v14
    v_lshlrev_b32 v108, 16, v18
    v_lshlrev_b32 v109, 16, v22
    v_lshlrev_b32 v110, 16, v26
    v_lshlrev_b32 v115, 16, v30
    v_lshlrev_b32 v116, 16, v34
    v_lshlrev_b32 v117, 16, v38
    v_lshlrev_b32 v118, 16, v42
    v_mul_f32 v119, v104, v114
    v_mul_f32 v120, v105, v114
    v_mul_f32 v121, v106, v114
    v_mul_f32 v122, v107, v114
    v_cvt_pk_bf16_f32 v119, 0, v119
    v_cvt_pk_bf16_f32 v120, 0, v120
    v_cvt_pk_bf16_f32 v121, 0, v121
    v_cvt_pk_bf16_f32 v122, 0, v122
    v_mul_f32 v152, v105, v113
    v_mul_f32 v153, v106, v113
    v_mul_f32 v154, v107, v113
    v_mul_f32 v155, v108, v113
    v_cvt_pk_bf16_f32 v152, 0, v152
    v_cvt_pk_bf16_f32 v153, 0, v153
    v_cvt_pk_bf16_f32 v154, 0, v154
    v_cvt_pk_bf16_f32 v155, 0, v155
    v_add_f32 v119, v119, v152
    v_add_f32 v120, v120, v153
    v_add_f32 v121, v121, v154
    v_add_f32 v122, v122, v155
    v_cvt_pk_bf16_f32 v119, 0, v119
    v_cvt_pk_bf16_f32 v120, 0, v120
    v_cvt_pk_bf16_f32 v121, 0, v121
    v_cvt_pk_bf16_f32 v122, 0, v122
    v_mul_f32 v152, v106, v112
    v_mul_f32 v153, v107, v112
    v_mul_f32 v154, v108, v112
    v_mul_f32 v155, v109, v112
    v_cvt_pk_bf16_f32 v152, 0, v152
    v_cvt_pk_bf16_f32 v153, 0, v153
    v_cvt_pk_bf16_f32 v154, 0, v154
    v_cvt_pk_bf16_f32 v155, 0, v155
    v_add_f32 v119, v119, v152
    v_add_f32 v120, v120, v153
    v_add_f32 v121, v121, v154
    v_add_f32 v122, v122, v155
    v_cvt_pk_bf16_f32 v119, 0, v119
    v_cvt_pk_bf16_f32 v120, 0, v120
    v_cvt_pk_bf16_f32 v121, 0, v121
    v_cvt_pk_bf16_f32 v122, 0, v122
    v_mul_f32 v152, v107, v111
    v_mul_f32 v153, v108, v111
    v_mul_f32 v154, v109, v111
    v_mul_f32 v155, v110, v111
    v_cvt_pk_bf16_f32 v152, 0, v152
    v_cvt_pk_bf16_f32 v153, 0, v153
    v_cvt_pk_bf16_f32 v154, 0, v154
    v_cvt_pk_bf16_f32 v155, 0, v155
    v_add_f32 v119, v119, v152
    v_add_f32 v120, v120, v153
    v_add_f32 v121, v121, v154
    v_add_f32 v122, v122, v155
    v_cvt_pk_bf16_f32 v119, 0, v119
    v_cvt_pk_bf16_f32 v120, 0, v120
    v_cvt_pk_bf16_f32 v121, 0, v121
    v_cvt_pk_bf16_f32 v122, 0, v122
    v_mul_f32 v119, v119, v115
    v_mul_f32 v120, v120, v116
    v_mul_f32 v121, v121, v117
    v_mul_f32 v122, v122, v118
    v_cvt_pk_bf16_f32 v124, v122, v121
    v_cvt_pk_bf16_f32 v125, v120, v119
    buffer_store_dwordx2 v[124:125], v132, s[12:15], 0 offen offset:128
    v_lshlrev_b32 v104, 16, v46
    v_lshlrev_b32 v105, 16, v50
    v_lshlrev_b32 v106, 16, v54
    v_lshlrev_b32 v107, 16, v58
    v_lshlrev_b32 v108, 16, v62
    v_lshlrev_b32 v109, 16, v66
    v_lshlrev_b32 v110, 16, v70
    v_lshlrev_b32 v115, 16, v74
    v_lshlrev_b32 v116, 16, v78
    v_lshlrev_b32 v117, 16, v82
    v_lshlrev_b32 v118, 16, v86
    v_mul_f32 v119, v104, v114
    v_mul_f32 v120, v105, v114
    v_mul_f32 v121, v106, v114
    v_mul_f32 v122, v107, v114
    v_cvt_pk_bf16_f32 v119, 0, v119
    v_cvt_pk_bf16_f32 v120, 0, v120
    v_cvt_pk_bf16_f32 v121, 0, v121
    v_cvt_pk_bf16_f32 v122, 0, v122
    v_mul_f32 v152, v105, v113
    v_mul_f32 v153, v106, v113
    v_mul_f32 v154, v107, v113
    v_mul_f32 v155, v108, v113
    v_cvt_pk_bf16_f32 v152, 0, v152
    v_cvt_pk_bf16_f32 v153, 0, v153
    v_cvt_pk_bf16_f32 v154, 0, v154
    v_cvt_pk_bf16_f32 v155, 0, v155
    v_add_f32 v119, v119, v152
    v_add_f32 v120, v120, v153
    v_add_f32 v121, v121, v154
    v_add_f32 v122, v122, v155
    v_cvt_pk_bf16_f32 v119, 0, v119
    v_cvt_pk_bf16_f32 v120, 0, v120
    v_cvt_pk_bf16_f32 v121, 0, v121
    v_cvt_pk_bf16_f32 v122, 0, v122
    v_mul_f32 v152, v106, v112
    v_mul_f32 v153, v107, v112
    v_mul_f32 v154, v108, v112
    v_mul_f32 v155, v109, v112
    v_cvt_pk_bf16_f32 v152, 0, v152
    v_cvt_pk_bf16_f32 v153, 0, v153
    v_cvt_pk_bf16_f32 v154, 0, v154
    v_cvt_pk_bf16_f32 v155, 0, v155
    v_add_f32 v119, v119, v152
    v_add_f32 v120, v120, v153
    v_add_f32 v121, v121, v154
    v_add_f32 v122, v122, v155
    v_cvt_pk_bf16_f32 v119, 0, v119
    v_cvt_pk_bf16_f32 v120, 0, v120
    v_cvt_pk_bf16_f32 v121, 0, v121
    v_cvt_pk_bf16_f32 v122, 0, v122
    v_mul_f32 v152, v107, v111
    v_mul_f32 v153, v108, v111
    v_mul_f32 v154, v109, v111
    v_mul_f32 v155, v110, v111
    v_cvt_pk_bf16_f32 v152, 0, v152
    v_cvt_pk_bf16_f32 v153, 0, v153
    v_cvt_pk_bf16_f32 v154, 0, v154
    v_cvt_pk_bf16_f32 v155, 0, v155
    v_add_f32 v119, v119, v152
    v_add_f32 v120, v120, v153
    v_add_f32 v121, v121, v154
    v_add_f32 v122, v122, v155
    v_cvt_pk_bf16_f32 v119, 0, v119
    v_cvt_pk_bf16_f32 v120, 0, v120
    v_cvt_pk_bf16_f32 v121, 0, v121
    v_cvt_pk_bf16_f32 v122, 0, v122
    v_mul_f32 v119, v119, v115
    v_mul_f32 v120, v120, v116
    v_mul_f32 v121, v121, v117
    v_mul_f32 v122, v122, v118
    v_cvt_pk_bf16_f32 v126, v122, v121
    v_cvt_pk_bf16_f32 v127, v120, v119
    buffer_store_dwordx2 v[126:127], v132, s[12:15], 0 offen offset:0
    v_add_u32 v132, 4608, v132
    s_barrier
    v_lshlrev_b32 v111, 16, v98
    v_and_b32 v112, 0xffff0000, v98
    v_lshlrev_b32 v113, 16, v99
    v_and_b32 v114, 0xffff0000, v99
    v_and_b32 v104, 0xffff0000, v2
    v_and_b32 v105, 0xffff0000, v6
    v_and_b32 v106, 0xffff0000, v10
    v_and_b32 v107, 0xffff0000, v14
    v_and_b32 v108, 0xffff0000, v18
    v_and_b32 v109, 0xffff0000, v22
    v_and_b32 v110, 0xffff0000, v26
    v_and_b32 v115, 0xffff0000, v30
    v_and_b32 v116, 0xffff0000, v34
    v_and_b32 v117, 0xffff0000, v38
    v_and_b32 v118, 0xffff0000, v42
    v_mul_f32 v119, v104, v114
    v_mul_f32 v120, v105, v114
    v_mul_f32 v121, v106, v114
    v_mul_f32 v122, v107, v114
    v_cvt_pk_bf16_f32 v119, 0, v119
    v_cvt_pk_bf16_f32 v120, 0, v120
    v_cvt_pk_bf16_f32 v121, 0, v121
    v_cvt_pk_bf16_f32 v122, 0, v122
    v_mul_f32 v152, v105, v113
    v_mul_f32 v153, v106, v113
    v_mul_f32 v154, v107, v113
    v_mul_f32 v155, v108, v113
    v_cvt_pk_bf16_f32 v152, 0, v152
    v_cvt_pk_bf16_f32 v153, 0, v153
    v_cvt_pk_bf16_f32 v154, 0, v154
    v_cvt_pk_bf16_f32 v155, 0, v155
    v_add_f32 v119, v119, v152
    v_add_f32 v120, v120, v153
    v_add_f32 v121, v121, v154
    v_add_f32 v122, v122, v155
    v_cvt_pk_bf16_f32 v119, 0, v119
    v_cvt_pk_bf16_f32 v120, 0, v120
    v_cvt_pk_bf16_f32 v121, 0, v121
    v_cvt_pk_bf16_f32 v122, 0, v122
    v_mul_f32 v152, v106, v112
    v_mul_f32 v153, v107, v112
    v_mul_f32 v154, v108, v112
    v_mul_f32 v155, v109, v112
    v_cvt_pk_bf16_f32 v152, 0, v152
    v_cvt_pk_bf16_f32 v153, 0, v153
    v_cvt_pk_bf16_f32 v154, 0, v154
    v_cvt_pk_bf16_f32 v155, 0, v155
    v_add_f32 v119, v119, v152
    v_add_f32 v120, v120, v153
    v_add_f32 v121, v121, v154
    v_add_f32 v122, v122, v155
    v_cvt_pk_bf16_f32 v119, 0, v119
    v_cvt_pk_bf16_f32 v120, 0, v120
    v_cvt_pk_bf16_f32 v121, 0, v121
    v_cvt_pk_bf16_f32 v122, 0, v122
    v_mul_f32 v152, v107, v111
    v_mul_f32 v153, v108, v111
    v_mul_f32 v154, v109, v111
    v_mul_f32 v155, v110, v111
    v_cvt_pk_bf16_f32 v152, 0, v152
    v_cvt_pk_bf16_f32 v153, 0, v153
    v_cvt_pk_bf16_f32 v154, 0, v154
    v_cvt_pk_bf16_f32 v155, 0, v155
    v_add_f32 v119, v119, v152
    v_add_f32 v120, v120, v153
    v_add_f32 v121, v121, v154
    v_add_f32 v122, v122, v155
    v_cvt_pk_bf16_f32 v119, 0, v119
    v_cvt_pk_bf16_f32 v120, 0, v120
    v_cvt_pk_bf16_f32 v121, 0, v121
    v_cvt_pk_bf16_f32 v122, 0, v122
    v_mul_f32 v119, v119, v115
    v_mul_f32 v120, v120, v116
    v_mul_f32 v121, v121, v117
    v_mul_f32 v122, v122, v118
    v_cvt_pk_bf16_f32 v124, v122, v121
    v_cvt_pk_bf16_f32 v125, v120, v119
    buffer_store_dwordx2 v[124:125], v132, s[12:15], 0 offen offset:128
    v_and_b32 v104, 0xffff0000, v46
    v_and_b32 v105, 0xffff0000, v50
    v_and_b32 v106, 0xffff0000, v54
    v_and_b32 v107, 0xffff0000, v58
    v_and_b32 v108, 0xffff0000, v62
    v_and_b32 v109, 0xffff0000, v66
    v_and_b32 v110, 0xffff0000, v70
    v_and_b32 v115, 0xffff0000, v74
    v_and_b32 v116, 0xffff0000, v78
    v_and_b32 v117, 0xffff0000, v82
    v_and_b32 v118, 0xffff0000, v86
    v_mul_f32 v119, v104, v114
    v_mul_f32 v120, v105, v114
    v_mul_f32 v121, v106, v114
    v_mul_f32 v122, v107, v114
    v_cvt_pk_bf16_f32 v119, 0, v119
    v_cvt_pk_bf16_f32 v120, 0, v120
    v_cvt_pk_bf16_f32 v121, 0, v121
    v_cvt_pk_bf16_f32 v122, 0, v122
    v_mul_f32 v152, v105, v113
    v_mul_f32 v153, v106, v113
    v_mul_f32 v154, v107, v113
    v_mul_f32 v155, v108, v113
    v_cvt_pk_bf16_f32 v152, 0, v152
    v_cvt_pk_bf16_f32 v153, 0, v153
    v_cvt_pk_bf16_f32 v154, 0, v154
    v_cvt_pk_bf16_f32 v155, 0, v155
    v_add_f32 v119, v119, v152
    v_add_f32 v120, v120, v153
    v_add_f32 v121, v121, v154
    v_add_f32 v122, v122, v155
    v_cvt_pk_bf16_f32 v119, 0, v119
    v_cvt_pk_bf16_f32 v120, 0, v120
    v_cvt_pk_bf16_f32 v121, 0, v121
    v_cvt_pk_bf16_f32 v122, 0, v122
    v_mul_f32 v152, v106, v112
    v_mul_f32 v153, v107, v112
    v_mul_f32 v154, v108, v112
    v_mul_f32 v155, v109, v112
    v_cvt_pk_bf16_f32 v152, 0, v152
    v_cvt_pk_bf16_f32 v153, 0, v153
    v_cvt_pk_bf16_f32 v154, 0, v154
    v_cvt_pk_bf16_f32 v155, 0, v155
    v_add_f32 v119, v119, v152
    v_add_f32 v120, v120, v153
    v_add_f32 v121, v121, v154
    v_add_f32 v122, v122, v155
    v_cvt_pk_bf16_f32 v119, 0, v119
    v_cvt_pk_bf16_f32 v120, 0, v120
    v_cvt_pk_bf16_f32 v121, 0, v121
    v_cvt_pk_bf16_f32 v122, 0, v122
    v_mul_f32 v152, v107, v111
    v_mul_f32 v153, v108, v111
    v_mul_f32 v154, v109, v111
    v_mul_f32 v155, v110, v111
    v_cvt_pk_bf16_f32 v152, 0, v152
    v_cvt_pk_bf16_f32 v153, 0, v153
    v_cvt_pk_bf16_f32 v154, 0, v154
    v_cvt_pk_bf16_f32 v155, 0, v155
    v_add_f32 v119, v119, v152
    v_add_f32 v120, v120, v153
    v_add_f32 v121, v121, v154
    v_add_f32 v122, v122, v155
    v_cvt_pk_bf16_f32 v119, 0, v119
    v_cvt_pk_bf16_f32 v120, 0, v120
    v_cvt_pk_bf16_f32 v121, 0, v121
    v_cvt_pk_bf16_f32 v122, 0, v122
    v_mul_f32 v119, v119, v115
    v_mul_f32 v120, v120, v116
    v_mul_f32 v121, v121, v117
    v_mul_f32 v122, v122, v118
    v_cvt_pk_bf16_f32 v126, v122, v121
    v_cvt_pk_bf16_f32 v127, v120, v119
    buffer_store_dwordx2 v[126:127], v132, s[12:15], 0 offen offset:0
    v_add_u32 v132, 4608, v132
    s_barrier
    v_lshlrev_b32 v111, 16, v100
    v_and_b32 v112, 0xffff0000, v100
    v_lshlrev_b32 v113, 16, v101
    v_and_b32 v114, 0xffff0000, v101
    v_lshlrev_b32 v104, 16, v3
    v_lshlrev_b32 v105, 16, v7
    v_lshlrev_b32 v106, 16, v11
    v_lshlrev_b32 v107, 16, v15
    v_lshlrev_b32 v108, 16, v19
    v_lshlrev_b32 v109, 16, v23
    v_lshlrev_b32 v110, 16, v27
    v_lshlrev_b32 v115, 16, v31
    v_lshlrev_b32 v116, 16, v35
    v_lshlrev_b32 v117, 16, v39
    v_lshlrev_b32 v118, 16, v43
    v_mul_f32 v119, v104, v114
    v_mul_f32 v120, v105, v114
    v_mul_f32 v121, v106, v114
    v_mul_f32 v122, v107, v114
    v_cvt_pk_bf16_f32 v119, 0, v119
    v_cvt_pk_bf16_f32 v120, 0, v120
    v_cvt_pk_bf16_f32 v121, 0, v121
    v_cvt_pk_bf16_f32 v122, 0, v122
    v_mul_f32 v152, v105, v113
    v_mul_f32 v153, v106, v113
    v_mul_f32 v154, v107, v113
    v_mul_f32 v155, v108, v113
    v_cvt_pk_bf16_f32 v152, 0, v152
    v_cvt_pk_bf16_f32 v153, 0, v153
    v_cvt_pk_bf16_f32 v154, 0, v154
    v_cvt_pk_bf16_f32 v155, 0, v155
    v_add_f32 v119, v119, v152
    v_add_f32 v120, v120, v153
    v_add_f32 v121, v121, v154
    v_add_f32 v122, v122, v155
    v_cvt_pk_bf16_f32 v119, 0, v119
    v_cvt_pk_bf16_f32 v120, 0, v120
    v_cvt_pk_bf16_f32 v121, 0, v121
    v_cvt_pk_bf16_f32 v122, 0, v122
    v_mul_f32 v152, v106, v112
    v_mul_f32 v153, v107, v112
    v_mul_f32 v154, v108, v112
    v_mul_f32 v155, v109, v112
    v_cvt_pk_bf16_f32 v152, 0, v152
    v_cvt_pk_bf16_f32 v153, 0, v153
    v_cvt_pk_bf16_f32 v154, 0, v154
    v_cvt_pk_bf16_f32 v155, 0, v155
    v_add_f32 v119, v119, v152
    v_add_f32 v120, v120, v153
    v_add_f32 v121, v121, v154
    v_add_f32 v122, v122, v155
    v_cvt_pk_bf16_f32 v119, 0, v119
    v_cvt_pk_bf16_f32 v120, 0, v120
    v_cvt_pk_bf16_f32 v121, 0, v121
    v_cvt_pk_bf16_f32 v122, 0, v122
    v_mul_f32 v152, v107, v111
    v_mul_f32 v153, v108, v111
    v_mul_f32 v154, v109, v111
    v_mul_f32 v155, v110, v111
    v_cvt_pk_bf16_f32 v152, 0, v152
    v_cvt_pk_bf16_f32 v153, 0, v153
    v_cvt_pk_bf16_f32 v154, 0, v154
    v_cvt_pk_bf16_f32 v155, 0, v155
    v_add_f32 v119, v119, v152
    v_add_f32 v120, v120, v153
    v_add_f32 v121, v121, v154
    v_add_f32 v122, v122, v155
    v_cvt_pk_bf16_f32 v119, 0, v119
    v_cvt_pk_bf16_f32 v120, 0, v120
    v_cvt_pk_bf16_f32 v121, 0, v121
    v_cvt_pk_bf16_f32 v122, 0, v122
    v_mul_f32 v119, v119, v115
    v_mul_f32 v120, v120, v116
    v_mul_f32 v121, v121, v117
    v_mul_f32 v122, v122, v118
    v_cvt_pk_bf16_f32 v124, v122, v121
    v_cvt_pk_bf16_f32 v125, v120, v119
    buffer_store_dwordx2 v[124:125], v132, s[12:15], 0 offen offset:128
    v_lshlrev_b32 v104, 16, v47
    v_lshlrev_b32 v105, 16, v51
    v_lshlrev_b32 v106, 16, v55
    v_lshlrev_b32 v107, 16, v59
    v_lshlrev_b32 v108, 16, v63
    v_lshlrev_b32 v109, 16, v67
    v_lshlrev_b32 v110, 16, v71
    v_lshlrev_b32 v115, 16, v75
    v_lshlrev_b32 v116, 16, v79
    v_lshlrev_b32 v117, 16, v83
    v_lshlrev_b32 v118, 16, v87
    v_mul_f32 v119, v104, v114
    v_mul_f32 v120, v105, v114
    v_mul_f32 v121, v106, v114
    v_mul_f32 v122, v107, v114
    v_cvt_pk_bf16_f32 v119, 0, v119
    v_cvt_pk_bf16_f32 v120, 0, v120
    v_cvt_pk_bf16_f32 v121, 0, v121
    v_cvt_pk_bf16_f32 v122, 0, v122
    v_mul_f32 v152, v105, v113
    v_mul_f32 v153, v106, v113
    v_mul_f32 v154, v107, v113
    v_mul_f32 v155, v108, v113
    v_cvt_pk_bf16_f32 v152, 0, v152
    v_cvt_pk_bf16_f32 v153, 0, v153
    v_cvt_pk_bf16_f32 v154, 0, v154
    v_cvt_pk_bf16_f32 v155, 0, v155
    v_add_f32 v119, v119, v152
    v_add_f32 v120, v120, v153
    v_add_f32 v121, v121, v154
    v_add_f32 v122, v122, v155
    v_cvt_pk_bf16_f32 v119, 0, v119
    v_cvt_pk_bf16_f32 v120, 0, v120
    v_cvt_pk_bf16_f32 v121, 0, v121
    v_cvt_pk_bf16_f32 v122, 0, v122
    v_mul_f32 v152, v106, v112
    v_mul_f32 v153, v107, v112
    v_mul_f32 v154, v108, v112
    v_mul_f32 v155, v109, v112
    v_cvt_pk_bf16_f32 v152, 0, v152
    v_cvt_pk_bf16_f32 v153, 0, v153
    v_cvt_pk_bf16_f32 v154, 0, v154
    v_cvt_pk_bf16_f32 v155, 0, v155
    v_add_f32 v119, v119, v152
    v_add_f32 v120, v120, v153
    v_add_f32 v121, v121, v154
    v_add_f32 v122, v122, v155
    v_cvt_pk_bf16_f32 v119, 0, v119
    v_cvt_pk_bf16_f32 v120, 0, v120
    v_cvt_pk_bf16_f32 v121, 0, v121
    v_cvt_pk_bf16_f32 v122, 0, v122
    v_mul_f32 v152, v107, v111
    v_mul_f32 v153, v108, v111
    v_mul_f32 v154, v109, v111
    v_mul_f32 v155, v110, v111
    v_cvt_pk_bf16_f32 v152, 0, v152
    v_cvt_pk_bf16_f32 v153, 0, v153
    v_cvt_pk_bf16_f32 v154, 0, v154
    v_cvt_pk_bf16_f32 v155, 0, v155
    v_add_f32 v119, v119, v152
    v_add_f32 v120, v120, v153
    v_add_f32 v121, v121, v154
    v_add_f32 v122, v122, v155
    v_cvt_pk_bf16_f32 v119, 0, v119
    v_cvt_pk_bf16_f32 v120, 0, v120
    v_cvt_pk_bf16_f32 v121, 0, v121
    v_cvt_pk_bf16_f32 v122, 0, v122
    v_mul_f32 v119, v119, v115
    v_mul_f32 v120, v120, v116
    v_mul_f32 v121, v121, v117
    v_mul_f32 v122, v122, v118
    v_cvt_pk_bf16_f32 v126, v122, v121
    v_cvt_pk_bf16_f32 v127, v120, v119
    buffer_store_dwordx2 v[126:127], v132, s[12:15], 0 offen offset:0
    v_add_u32 v132, 4608, v132
    s_barrier
    v_lshlrev_b32 v111, 16, v102
    v_and_b32 v112, 0xffff0000, v102
    v_lshlrev_b32 v113, 16, v103
    v_and_b32 v114, 0xffff0000, v103
    v_and_b32 v104, 0xffff0000, v3
    v_and_b32 v105, 0xffff0000, v7
    v_and_b32 v106, 0xffff0000, v11
    v_and_b32 v107, 0xffff0000, v15
    v_and_b32 v108, 0xffff0000, v19
    v_and_b32 v109, 0xffff0000, v23
    v_and_b32 v110, 0xffff0000, v27
    v_and_b32 v115, 0xffff0000, v31
    v_and_b32 v116, 0xffff0000, v35
    v_and_b32 v117, 0xffff0000, v39
    v_and_b32 v118, 0xffff0000, v43
    v_mul_f32 v119, v104, v114
    v_mul_f32 v120, v105, v114
    v_mul_f32 v121, v106, v114
    v_mul_f32 v122, v107, v114
    v_cvt_pk_bf16_f32 v119, 0, v119
    v_cvt_pk_bf16_f32 v120, 0, v120
    v_cvt_pk_bf16_f32 v121, 0, v121
    v_cvt_pk_bf16_f32 v122, 0, v122
    v_mul_f32 v152, v105, v113
    v_mul_f32 v153, v106, v113
    v_mul_f32 v154, v107, v113
    v_mul_f32 v155, v108, v113
    v_cvt_pk_bf16_f32 v152, 0, v152
    v_cvt_pk_bf16_f32 v153, 0, v153
    v_cvt_pk_bf16_f32 v154, 0, v154
    v_cvt_pk_bf16_f32 v155, 0, v155
    v_add_f32 v119, v119, v152
    v_add_f32 v120, v120, v153
    v_add_f32 v121, v121, v154
    v_add_f32 v122, v122, v155
    v_cvt_pk_bf16_f32 v119, 0, v119
    v_cvt_pk_bf16_f32 v120, 0, v120
    v_cvt_pk_bf16_f32 v121, 0, v121
    v_cvt_pk_bf16_f32 v122, 0, v122
    v_mul_f32 v152, v106, v112
    v_mul_f32 v153, v107, v112
    v_mul_f32 v154, v108, v112
    v_mul_f32 v155, v109, v112
    v_cvt_pk_bf16_f32 v152, 0, v152
    v_cvt_pk_bf16_f32 v153, 0, v153
    v_cvt_pk_bf16_f32 v154, 0, v154
    v_cvt_pk_bf16_f32 v155, 0, v155
    v_add_f32 v119, v119, v152
    v_add_f32 v120, v120, v153
    v_add_f32 v121, v121, v154
    v_add_f32 v122, v122, v155
    v_cvt_pk_bf16_f32 v119, 0, v119
    v_cvt_pk_bf16_f32 v120, 0, v120
    v_cvt_pk_bf16_f32 v121, 0, v121
    v_cvt_pk_bf16_f32 v122, 0, v122
    v_mul_f32 v152, v107, v111
    v_mul_f32 v153, v108, v111
    v_mul_f32 v154, v109, v111
    v_mul_f32 v155, v110, v111
    v_cvt_pk_bf16_f32 v152, 0, v152
    v_cvt_pk_bf16_f32 v153, 0, v153
    v_cvt_pk_bf16_f32 v154, 0, v154
    v_cvt_pk_bf16_f32 v155, 0, v155
    v_add_f32 v119, v119, v152
    v_add_f32 v120, v120, v153
    v_add_f32 v121, v121, v154
    v_add_f32 v122, v122, v155
    v_cvt_pk_bf16_f32 v119, 0, v119
    v_cvt_pk_bf16_f32 v120, 0, v120
    v_cvt_pk_bf16_f32 v121, 0, v121
    v_cvt_pk_bf16_f32 v122, 0, v122
    v_mul_f32 v119, v119, v115
    v_mul_f32 v120, v120, v116
    v_mul_f32 v121, v121, v117
    v_mul_f32 v122, v122, v118
    v_cvt_pk_bf16_f32 v124, v122, v121
    v_cvt_pk_bf16_f32 v125, v120, v119
    buffer_store_dwordx2 v[124:125], v132, s[12:15], 0 offen offset:128
    v_and_b32 v104, 0xffff0000, v47
    v_and_b32 v105, 0xffff0000, v51
    v_and_b32 v106, 0xffff0000, v55
    v_and_b32 v107, 0xffff0000, v59
    v_and_b32 v108, 0xffff0000, v63
    v_and_b32 v109, 0xffff0000, v67
    v_and_b32 v110, 0xffff0000, v71
    v_and_b32 v115, 0xffff0000, v75
    v_and_b32 v116, 0xffff0000, v79
    v_and_b32 v117, 0xffff0000, v83
    v_and_b32 v118, 0xffff0000, v87
    v_mul_f32 v119, v104, v114
    v_mul_f32 v120, v105, v114
    v_mul_f32 v121, v106, v114
    v_mul_f32 v122, v107, v114
    v_cvt_pk_bf16_f32 v119, 0, v119
    v_cvt_pk_bf16_f32 v120, 0, v120
    v_cvt_pk_bf16_f32 v121, 0, v121
    v_cvt_pk_bf16_f32 v122, 0, v122
    v_mul_f32 v152, v105, v113
    v_mul_f32 v153, v106, v113
    v_mul_f32 v154, v107, v113
    v_mul_f32 v155, v108, v113
    v_cvt_pk_bf16_f32 v152, 0, v152
    v_cvt_pk_bf16_f32 v153, 0, v153
    v_cvt_pk_bf16_f32 v154, 0, v154
    v_cvt_pk_bf16_f32 v155, 0, v155
    v_add_f32 v119, v119, v152
    v_add_f32 v120, v120, v153
    v_add_f32 v121, v121, v154
    v_add_f32 v122, v122, v155
    v_cvt_pk_bf16_f32 v119, 0, v119
    v_cvt_pk_bf16_f32 v120, 0, v120
    v_cvt_pk_bf16_f32 v121, 0, v121
    v_cvt_pk_bf16_f32 v122, 0, v122
    v_mul_f32 v152, v106, v112
    v_mul_f32 v153, v107, v112
    v_mul_f32 v154, v108, v112
    v_mul_f32 v155, v109, v112
    v_cvt_pk_bf16_f32 v152, 0, v152
    v_cvt_pk_bf16_f32 v153, 0, v153
    v_cvt_pk_bf16_f32 v154, 0, v154
    v_cvt_pk_bf16_f32 v155, 0, v155
    v_add_f32 v119, v119, v152
    v_add_f32 v120, v120, v153
    v_add_f32 v121, v121, v154
    v_add_f32 v122, v122, v155
    v_cvt_pk_bf16_f32 v119, 0, v119
    v_cvt_pk_bf16_f32 v120, 0, v120
    v_cvt_pk_bf16_f32 v121, 0, v121
    v_cvt_pk_bf16_f32 v122, 0, v122
    v_mul_f32 v152, v107, v111
    v_mul_f32 v153, v108, v111
    v_mul_f32 v154, v109, v111
    v_mul_f32 v155, v110, v111
    v_cvt_pk_bf16_f32 v152, 0, v152
    v_cvt_pk_bf16_f32 v153, 0, v153
    v_cvt_pk_bf16_f32 v154, 0, v154
    v_cvt_pk_bf16_f32 v155, 0, v155
    v_add_f32 v119, v119, v152
    v_add_f32 v120, v120, v153
    v_add_f32 v121, v121, v154
    v_add_f32 v122, v122, v155
    v_cvt_pk_bf16_f32 v119, 0, v119
    v_cvt_pk_bf16_f32 v120, 0, v120
    v_cvt_pk_bf16_f32 v121, 0, v121
    v_cvt_pk_bf16_f32 v122, 0, v122
    v_mul_f32 v119, v119, v115
    v_mul_f32 v120, v120, v116
    v_mul_f32 v121, v121, v117
    v_mul_f32 v122, v122, v118
    v_cvt_pk_bf16_f32 v126, v122, v121
    v_cvt_pk_bf16_f32 v127, v120, v119
    buffer_store_dwordx2 v[126:127], v132, s[12:15], 0 offen offset:0
    s_cmp_lt_u32 s2, 16
    s_cbranch_scc0 K1_END
    v_lshrrev_b32 v128, 1, v210
    s_lshl_b32 s42, s2, 6
    v_add_u32 v128, s42, v128
    s_movk_i32 s43, 4608
    v_mul_lo_u32 v128, v128, s43
    v_and_b32 v129, 1, v210
    v_lshlrev_b32 v129, 8, v129
    v_add_u32 v128, v128, v129
    v_add_u32 v128, 4096, v128
    v_mov_b32 v140, 0
    v_mov_b32 v141, 0
    v_mov_b32 v142, 0
    v_mov_b32 v143, 0
    buffer_store_dwordx4 v[140:143], v128, s[12:15], 0 offen offset:0
    buffer_store_dwordx4 v[140:143], v128, s[12:15], 0 offen offset:16
    buffer_store_dwordx4 v[140:143], v128, s[12:15], 0 offen offset:32
    buffer_store_dwordx4 v[140:143], v128, s[12:15], 0 offen offset:48
    buffer_store_dwordx4 v[140:143], v128, s[12:15], 0 offen offset:64
    buffer_store_dwordx4 v[140:143], v128, s[12:15], 0 offen offset:80
    buffer_store_dwordx4 v[140:143], v128, s[12:15], 0 offen offset:96
    buffer_store_dwordx4 v[140:143], v128, s[12:15], 0 offen offset:112
    buffer_store_dwordx4 v[140:143], v128, s[12:15], 0 offen offset:128
    buffer_store_dwordx4 v[140:143], v128, s[12:15], 0 offen offset:144
    buffer_store_dwordx4 v[140:143], v128, s[12:15], 0 offen offset:160
    buffer_store_dwordx4 v[140:143], v128, s[12:15], 0 offen offset:176
    buffer_store_dwordx4 v[140:143], v128, s[12:15], 0 offen offset:192
    buffer_store_dwordx4 v[140:143], v128, s[12:15], 0 offen offset:208
    buffer_store_dwordx4 v[140:143], v128, s[12:15], 0 offen offset:224
    buffer_store_dwordx4 v[140:143], v128, s[12:15], 0 offen offset:240
K1_END:
    s_endpgm
.globl k2_kernel
.p2align 8
.type k2_kernel,@function
k2_kernel:
    s_cmp_ge_u32 s2, 256
    s_cbranch_scc1 K2_END
    s_load_dwordx2 s[60:61], s[0:1], 96
    s_load_dwordx4 s[64:67], s[0:1], 32
    s_load_dwordx2 s[68:69], s[0:1], 64
    s_load_dwordx2 s[70:71], s[0:1], 0
    v_and_b32 v250, 63, v0
    v_lshrrev_b32 v244, 6, v0
    s_nop 0
    v_readfirstlane_b32 s32, v244
    s_and_b32 s39, s32, 3
    v_lshlrev_b32 v244, 4, v250
    s_waitcnt lgkmcnt(0)
    s_mov_b32 s4, s60
    s_and_b32 s5, s61, 0xffff
    s_mov_b32 s6, 268435456
    s_mov_b32 s7, 0x00020000
    v_mov_b32 v245, 116736
    v_mov_b32 v246, 0
    ds_write_b32 v245, v246
    s_waitcnt lgkmcnt(0)
    s_barrier
    s_cmp_ge_u32 s32, 4
    s_cbranch_scc1 K2_O
    s_mov_b32 s8, s64
    s_and_b32 s9, s65, 0xffff
    s_mov_b32 s10, 4194304
    s_mov_b32 s11, 0x00020000
    s_mov_b32 s12, s66
    s_and_b32 s13, s67, 0xffff
    s_mov_b32 s14, 2048
    s_mov_b32 s15, 0x00020000
    s_lshl_b32 s35, s2, 2
    s_add_u32 s35, s35, s32
    s_mul_i32 s38, s32, 27648
    s_lshl_b32 s36, s35, 12
    s_add_u32 m0, s38, 128
    s_add_u32 s37, s36, 0
    buffer_load_dwordx4 v244, s[8:11], s37 offen nt lds
    s_add_u32 m0, s38, 1152
    s_add_u32 s37, s36, 1024
    buffer_load_dwordx4 v244, s[8:11], s37 offen nt lds
    s_add_u32 m0, s38, 2176
    s_add_u32 s37, s36, 2048
    buffer_load_dwordx4 v244, s[8:11], s37 offen nt lds
    s_add_u32 m0, s38, 3200
    s_add_u32 s37, s36, 3072
    buffer_load_dwordx4 v244, s[8:11], s37 offen nt lds
    v_mov_b32 v245, 0
    buffer_load_dwordx4 v[200:203], v245, s[8:11], s36 offen
    s_mul_i32 s36, s35, 4608
    s_add_u32 m0, s38, 8960
    s_add_u32 s37, s36, 12
    buffer_load_dwordx4 v244, s[4:7], s37 offen lds
    s_add_u32 m0, s38, 13600
    s_add_u32 s37, s36, 8
    buffer_load_dwordx4 v244, s[4:7], s37 offen lds
    s_add_u32 m0, s38, 18240
    s_add_u32 s37, s36, 4
    buffer_load_dwordx4 v244, s[4:7], s37 offen lds
    s_add_u32 m0, s38, 22880
    s_add_u32 s37, s36, 0
    buffer_load_dwordx4 v244, s[4:7], s37 offen lds
    s_add_u32 m0, s38, 9984
    s_add_u32 s37, s36, 1036
    buffer_load_dwordx4 v244, s[4:7], s37 offen lds
    s_add_u32 m0, s38, 14624
    s_add_u32 s37, s36, 1032
    buffer_load_dwordx4 v244, s[4:7], s37 offen lds
    s_add_u32 m0, s38, 19264
    s_add_u32 s37, s36, 1028
    buffer_load_dwordx4 v244, s[4:7], s37 offen lds
    s_add_u32 m0, s38, 23904
    s_add_u32 s37, s36, 1024
    buffer_load_dwordx4 v244, s[4:7], s37 offen lds
    s_add_u32 m0, s38, 11008
    s_add_u32 s37, s36, 2060
    buffer_load_dwordx4 v244, s[4:7], s37 offen lds
    s_add_u32 m0, s38, 15648
    s_add_u32 s37, s36, 2056
    buffer_load_dwordx4 v244, s[4:7], s37 offen lds
    s_add_u32 m0, s38, 20288
    s_add_u32 s37, s36, 2052
    buffer_load_dwordx4 v244, s[4:7], s37 offen lds
    s_add_u32 m0, s38, 24928
    s_add_u32 s37, s36, 2048
    buffer_load_dwordx4 v244, s[4:7], s37 offen lds
    s_add_u32 m0, s38, 12032
    s_add_u32 s37, s36, 3084
    buffer_load_dwordx4 v244, s[4:7], s37 offen lds
    s_add_u32 m0, s38, 16672
    s_add_u32 s37, s36, 3080
    buffer_load_dwordx4 v244, s[4:7], s37 offen lds
    s_add_u32 m0, s38, 21312
    s_add_u32 s37, s36, 3076
    buffer_load_dwordx4 v244, s[4:7], s37 offen lds
    s_add_u32 m0, s38, 25952
    s_add_u32 s37, s36, 3072
    buffer_load_dwordx4 v244, s[4:7], s37 offen lds
    s_mov_b64 exec, 0xffffff
    s_add_u32 m0, s38, 13056
    s_add_u32 s37, s36, 4108
    buffer_load_dwordx4 v244, s[4:7], s37 offen lds
    s_add_u32 m0, s38, 17696
    s_add_u32 s37, s36, 4104
    buffer_load_dwordx4 v244, s[4:7], s37 offen lds
    s_add_u32 m0, s38, 22336
    s_add_u32 s37, s36, 4100
    buffer_load_dwordx4 v244, s[4:7], s37 offen lds
    s_add_u32 m0, s38, 26976
    s_add_u32 s37, s36, 4096
    buffer_load_dwordx4 v244, s[4:7], s37 offen lds
    s_mov_b64 exec, -1
    s_lshl_b32 s36, s35, 12
    s_add_u32 m0, s38, 4624
    s_add_u32 s37, s36, 14
    buffer_load_dwordx4 v244, s[8:11], s37 offen nt lds
    s_add_u32 m0, s38, 5648
    s_add_u32 s37, s36, 1038
    buffer_load_dwordx4 v244, s[8:11], s37 offen nt lds
    s_add_u32 m0, s38, 6672
    s_add_u32 s37, s36, 2062
    buffer_load_dwordx4 v244, s[8:11], s37 offen nt lds
    s_add_u32 m0, s38, 7696
    s_add_u32 s37, s36, 3086
    buffer_load_dwordx4 v244, s[8:11], s37 offen nt lds
    s_lshl_b32 s36, s35, 1
    buffer_load_ushort v208, v245, s[12:15], s36 offen
    v_mov_b32 v204, 0
    v_mov_b32 v205, 0
    v_mov_b32 v206, 0
    v_mov_b32 v207, 0
    v_add_u32 v247, s38, v244
    s_mov_b64 exec, 0xff
    ds_write_b128 v247, v[204:207] offset:0
    ds_write_b128 v247, v[204:207] offset:4480
    s_mov_b64 exec, -1
    v_and_b32 v245, 15, v250
    v_lshrrev_b32 v246, 4, v250
    v_lshrrev_b32 v248, 1, v245
    v_add_u32 v248, v248, v246
    v_lshlrev_b32 v248, 4, v248
    v_and_b32 v160, 1, v245
    v_sub_u32 v160, 1, v160
    s_movk_i32 s36, 4480
    v_mul_lo_u32 v160, v160, s36
    v_add_u32 v160, v160, v248
    s_add_u32 s36, s38, 16
    v_add_u32 v160, s36, v160
    v_and_b32 v161, 3, v245
    s_movk_i32 s36, 4640
    v_mul_lo_u32 v161, v161, s36
    v_lshrrev_b32 v248, 2, v245
    v_lshlrev_b32 v248, 7, v248
    v_sub_u32 v161, v161, v248
    v_lshlrev_b32 v248, 4, v246
    v_add_u32 v161, v161, v248
    s_add_u32 s36, s38, 9344
    v_add_u32 v161, s36, v161
    s_waitcnt vmcnt(0)
    s_mov_b64 exec, 1
    v_lshlrev_b32 v204, 16, v200
    v_alignbit_b32 v205, v201, v200, 16
    v_alignbit_b32 v206, v202, v201, 16
    v_alignbit_b32 v207, v203, v202, 16
    ds_write_b128 v247, v[204:207] offset:4608
    s_mov_b64 exec, -1
    s_waitcnt lgkmcnt(0)
    ds_read_b128 v[32:35], v160 offset:0
    ds_read_b128 v[64:67], v161 offset:3584
    ds_read_b128 v[36:39], v160 offset:512
    ds_read_b128 v[68:71], v161 offset:3072
    ds_read_b128 v[40:43], v160 offset:1024
    ds_read_b128 v[72:75], v161 offset:2560
    ds_read_b128 v[44:47], v160 offset:1536
    ds_read_b128 v[76:79], v161 offset:2048
    ds_read_b128 v[48:51], v160 offset:2048
    ds_read_b128 v[80:83], v161 offset:1536
    ds_read_b128 v[52:55], v160 offset:2560
    ds_read_b128 v[84:87], v161 offset:1024
    ds_read_b128 v[56:59], v160 offset:3072
    ds_read_b128 v[88:91], v161 offset:512
    ds_read_b128 v[60:63], v160 offset:3584
    ds_read_b128 v[92:95], v161 offset:0
    s_waitcnt lgkmcnt(0)
    v_mfma_f32_16x16x32_bf16 v[0:3], v[32:35], v[64:67], 0
    ds_read_b128 v[96:99], v160 offset:64
    ds_read_b128 v[128:131], v161 offset:3648
    ds_read_b128 v[100:103], v160 offset:576
    ds_read_b128 v[132:135], v161 offset:3136
    v_mfma_f32_16x16x32_bf16 v[4:7], v[32:35], v[68:71], 0
    ds_read_b128 v[104:107], v160 offset:1088
    v_mfma_f32_16x16x32_bf16 v[4:7], v[36:39], v[64:67], v[4:7]
    v_mfma_f32_16x16x32_bf16 v[8:11], v[32:35], v[72:75], 0
    ds_read_b128 v[136:139], v161 offset:2624
    v_mfma_f32_16x16x32_bf16 v[8:11], v[36:39], v[68:71], v[8:11]
    v_mfma_f32_16x16x32_bf16 v[8:11], v[40:43], v[64:67], v[8:11]
    ds_read_b128 v[108:111], v160 offset:1600
    v_mfma_f32_16x16x32_bf16 v[12:15], v[32:35], v[76:79], 0
    v_mfma_f32_16x16x32_bf16 v[12:15], v[36:39], v[72:75], v[12:15]
    ds_read_b128 v[140:143], v161 offset:2112
    v_mfma_f32_16x16x32_bf16 v[12:15], v[40:43], v[68:71], v[12:15]
    v_mfma_f32_16x16x32_bf16 v[12:15], v[44:47], v[64:67], v[12:15]
    v_mfma_f32_16x16x32_bf16 v[16:19], v[32:35], v[80:83], 0
    ds_read_b128 v[112:115], v160 offset:2112
    v_mfma_f32_16x16x32_bf16 v[16:19], v[36:39], v[76:79], v[16:19]
    v_mfma_f32_16x16x32_bf16 v[16:19], v[40:43], v[72:75], v[16:19]
    ds_read_b128 v[144:147], v161 offset:1600
    v_mfma_f32_16x16x32_bf16 v[16:19], v[44:47], v[68:71], v[16:19]
    v_mfma_f32_16x16x32_bf16 v[16:19], v[48:51], v[64:67], v[16:19]
    ds_read_b128 v[116:119], v160 offset:2624
    v_mfma_f32_16x16x32_bf16 v[20:23], v[32:35], v[84:87], 0
    v_mfma_f32_16x16x32_bf16 v[20:23], v[36:39], v[80:83], v[20:23]
    ds_read_b128 v[148:151], v161 offset:1088
    v_mfma_f32_16x16x32_bf16 v[20:23], v[40:43], v[76:79], v[20:23]
    v_mfma_f32_16x16x32_bf16 v[20:23], v[44:47], v[72:75], v[20:23]
    v_mfma_f32_16x16x32_bf16 v[20:23], v[48:51], v[68:71], v[20:23]
    ds_read_b128 v[120:123], v160 offset:3136
    v_mfma_f32_16x16x32_bf16 v[20:23], v[52:55], v[64:67], v[20:23]
    v_mfma_f32_16x16x32_bf16 v[24:27], v[32:35], v[88:91], 0
    ds_read_b128 v[152:155], v161 offset:576
    v_mfma_f32_16x16x32_bf16 v[24:27], v[36:39], v[84:87], v[24:27]
    v_mfma_f32_16x16x32_bf16 v[24:27], v[40:43], v[80:83], v[24:27]
    ds_read_b128 v[124:127], v160 offset:3648
    v_mfma_f32_16x16x32_bf16 v[24:27], v[44:47], v[76:79], v[24:27]
    v_mfma_f32_16x16x32_bf16 v[24:27], v[48:51], v[72:75], v[24:27]
    ds_read_b128 v[156:159], v161 offset:64
    v_mfma_f32_16x16x32_bf16 v[24:27], v[52:55], v[68:71], v[24:27]
    v_mfma_f32_16x16x32_bf16 v[24:27], v[56:59], v[64:67], v[24:27]
    v_mfma_f32_16x16x32_bf16 v[28:31], v[32:35], v[92:95], 0
    v_mfma_f32_16x16x32_bf16 v[28:31], v[36:39], v[88:91], v[28:31]
    v_mfma_f32_16x16x32_bf16 v[28:31], v[40:43], v[84:87], v[28:31]
    v_mfma_f32_16x16x32_bf16 v[28:31], v[44:47], v[80:83], v[28:31]
    v_mfma_f32_16x16x32_bf16 v[28:31], v[48:51], v[76:79], v[28:31]
    v_mfma_f32_16x16x32_bf16 v[28:31], v[52:55], v[72:75], v[28:31]
    v_mfma_f32_16x16x32_bf16 v[28:31], v[56:59], v[68:71], v[28:31]
    v_mfma_f32_16x16x32_bf16 v[28:31], v[60:63], v[64:67], v[28:31]
    s_waitcnt lgkmcnt(0)
    v_mfma_f32_16x16x32_bf16 v[0:3], v[96:99], v[128:131], v[0:3]
    ds_read_b128 v[32:35], v160 offset:128
    ds_read_b128 v[64:67], v161 offset:3712
    ds_read_b128 v[36:39], v160 offset:640
    ds_read_b128 v[68:71], v161 offset:3200
    v_mfma_f32_16x16x32_bf16 v[4:7], v[96:99], v[132:135], v[4:7]
    ds_read_b128 v[40:43], v160 offset:1152
    v_mfma_f32_16x16x32_bf16 v[4:7], v[100:103], v[128:131], v[4:7]
    v_mfma_f32_16x16x32_bf16 v[8:11], v[96:99], v[136:139], v[8:11]
    ds_read_b128 v[72:75], v161 offset:2688
    v_mfma_f32_16x16x32_bf16 v[8:11], v[100:103], v[132:135], v[8:11]
    v_mfma_f32_16x16x32_bf16 v[8:11], v[104:107], v[128:131], v[8:11]
    ds_read_b128 v[44:47], v160 offset:1664
    v_mfma_f32_16x16x32_bf16 v[12:15], v[96:99], v[140:143], v[12:15]
    v_mfma_f32_16x16x32_bf16 v[12:15], v[100:103], v[136:139], v[12:15]
    ds_read_b128 v[76:79], v161 offset:2176
    v_mfma_f32_16x16x32_bf16 v[12:15], v[104:107], v[132:135], v[12:15]
    v_mfma_f32_16x16x32_bf16 v[12:15], v[108:111], v[128:131], v[12:15]
    v_mfma_f32_16x16x32_bf16 v[16:19], v[96:99], v[144:147], v[16:19]
    ds_read_b128 v[48:51], v160 offset:2176
    v_mfma_f32_16x16x32_bf16 v[16:19], v[100:103], v[140:143], v[16:19]
    v_mfma_f32_16x16x32_bf16 v[16:19], v[104:107], v[136:139], v[16:19]
    ds_read_b128 v[80:83], v161 offset:1664
    v_mfma_f32_16x16x32_bf16 v[16:19], v[108:111], v[132:135], v[16:19]
    v_mfma_f32_16x16x32_bf16 v[16:19], v[112:115], v[128:131], v[16:19]
    ds_read_b128 v[52:55], v160 offset:2688
    v_mfma_f32_16x16x32_bf16 v[20:23], v[96:99], v[148:151], v[20:23]
    v_mfma_f32_16x16x32_bf16 v[20:23], v[100:103], v[144:147], v[20:23]
    ds_read_b128 v[84:87], v161 offset:1152
    v_mfma_f32_16x16x32_bf16 v[20:23], v[104:107], v[140:143], v[20:23]
    v_mfma_f32_16x16x32_bf16 v[20:23], v[108:111], v[136:139], v[20:23]
    v_mfma_f32_16x16x32_bf16 v[20:23], v[112:115], v[132:135], v[20:23]
    ds_read_b128 v[56:59], v160 offset:3200
    v_mfma_f32_16x16x32_bf16 v[20:23], v[116:119], v[128:131], v[20:23]
    v_mfma_f32_16x16x32_bf16 v[24:27], v[96:99], v[152:155], v[24:27]
    ds_read_b128 v[88:91], v161 offset:640
    v_mfma_f32_16x16x32_bf16 v[24:27], v[100:103], v[148:151], v[24:27]
    v_mfma_f32_16x16x32_bf16 v[24:27], v[104:107], v[144:147], v[24:27]
    ds_read_b128 v[60:63], v160 offset:3712
    v_mfma_f32_16x16x32_bf16 v[24:27], v[108:111], v[140:143], v[24:27]
    v_mfma_f32_16x16x32_bf16 v[24:27], v[112:115], v[136:139], v[24:27]
    ds_read_b128 v[92:95], v161 offset:128
    v_mfma_f32_16x16x32_bf16 v[24:27], v[116:119], v[132:135], v[24:27]
    v_mfma_f32_16x16x32_bf16 v[24:27], v[120:123], v[128:131], v[24:27]
    v_mfma_f32_16x16x32_bf16 v[28:31], v[96:99], v[156:159], v[28:31]
    v_mfma_f32_16x16x32_bf16 v[28:31], v[100:103], v[152:155], v[28:31]
    v_mfma_f32_16x16x32_bf16 v[28:31], v[104:107], v[148:151], v[28:31]
    v_mfma_f32_16x16x32_bf16 v[28:31], v[108:111], v[144:147], v[28:31]
    v_mfma_f32_16x16x32_bf16 v[28:31], v[112:115], v[140:143], v[28:31]
    v_mfma_f32_16x16x32_bf16 v[28:31], v[116:119], v[136:139], v[28:31]
    v_mfma_f32_16x16x32_bf16 v[28:31], v[120:123], v[132:135], v[28:31]
    v_mfma_f32_16x16x32_bf16 v[28:31], v[124:127], v[128:131], v[28:31]
    s_waitcnt lgkmcnt(0)
    v_mfma_f32_16x16x32_bf16 v[0:3], v[32:35], v[64:67], v[0:3]
    ds_read_b128 v[96:99], v160 offset:192
    ds_read_b128 v[128:131], v161 offset:3776
    ds_read_b128 v[100:103], v160 offset:704
    ds_read_b128 v[132:135], v161 offset:3264
    v_mfma_f32_16x16x32_bf16 v[4:7], v[32:35], v[68:71], v[4:7]
    ds_read_b128 v[104:107], v160 offset:1216
    v_mfma_f32_16x16x32_bf16 v[4:7], v[36:39], v[64:67], v[4:7]
    v_mfma_f32_16x16x32_bf16 v[8:11], v[32:35], v[72:75], v[8:11]
    ds_read_b128 v[136:139], v161 offset:2752
    v_mfma_f32_16x16x32_bf16 v[8:11], v[36:39], v[68:71], v[8:11]
    v_mfma_f32_16x16x32_bf16 v[8:11], v[40:43], v[64:67], v[8:11]
    ds_read_b128 v[108:111], v160 offset:1728
    v_mfma_f32_16x16x32_bf16 v[12:15], v[32:35], v[76:79], v[12:15]
    v_mfma_f32_16x16x32_bf16 v[12:15], v[36:39], v[72:75], v[12:15]
    ds_read_b128 v[140:143], v161 offset:2240
    v_mfma_f32_16x16x32_bf16 v[12:15], v[40:43], v[68:71], v[12:15]
    v_mfma_f32_16x16x32_bf16 v[12:15], v[44:47], v[64:67], v[12:15]
    v_mfma_f32_16x16x32_bf16 v[16:19], v[32:35], v[80:83], v[16:19]
    ds_read_b128 v[112:115], v160 offset:2240
    v_mfma_f32_16x16x32_bf16 v[16:19], v[36:39], v[76:79], v[16:19]
    v_mfma_f32_16x16x32_bf16 v[16:19], v[40:43], v[72:75], v[16:19]
    ds_read_b128 v[144:147], v161 offset:1728
    v_mfma_f32_16x16x32_bf16 v[16:19], v[44:47], v[68:71], v[16:19]
    v_mfma_f32_16x16x32_bf16 v[16:19], v[48:51], v[64:67], v[16:19]
    ds_read_b128 v[116:119], v160 offset:2752
    v_mfma_f32_16x16x32_bf16 v[20:23], v[32:35], v[84:87], v[20:23]
    v_mfma_f32_16x16x32_bf16 v[20:23], v[36:39], v[80:83], v[20:23]
    ds_read_b128 v[148:151], v161 offset:1216
    v_mfma_f32_16x16x32_bf16 v[20:23], v[40:43], v[76:79], v[20:23]
    v_mfma_f32_16x16x32_bf16 v[20:23], v[44:47], v[72:75], v[20:23]
    v_mfma_f32_16x16x32_bf16 v[20:23], v[48:51], v[68:71], v[20:23]
    ds_read_b128 v[120:123], v160 offset:3264
    v_mfma_f32_16x16x32_bf16 v[20:23], v[52:55], v[64:67], v[20:23]
    v_mfma_f32_16x16x32_bf16 v[24:27], v[32:35], v[88:91], v[24:27]
    ds_read_b128 v[152:155], v161 offset:704
    v_mfma_f32_16x16x32_bf16 v[24:27], v[36:39], v[84:87], v[24:27]
    v_mfma_f32_16x16x32_bf16 v[24:27], v[40:43], v[80:83], v[24:27]
    ds_read_b128 v[124:127], v160 offset:3776
    v_mfma_f32_16x16x32_bf16 v[24:27], v[44:47], v[76:79], v[24:27]
    v_mfma_f32_16x16x32_bf16 v[24:27], v[48:51], v[72:75], v[24:27]
    ds_read_b128 v[156:159], v161 offset:192
    v_mfma_f32_16x16x32_bf16 v[24:27], v[52:55], v[68:71], v[24:27]
    v_mfma_f32_16x16x32_bf16 v[24:27], v[56:59], v[64:67], v[24:27]
    v_mfma_f32_16x16x32_bf16 v[28:31], v[32:35], v[92:95], v[28:31]
    v_mfma_f32_16x16x32_bf16 v[28:31], v[36:39], v[88:91], v[28:31]
    v_mfma_f32_16x16x32_bf16 v[28:31], v[40:43], v[84:87], v[28:31]
    v_mfma_f32_16x16x32_bf16 v[28:31], v[44:47], v[80:83], v[28:31]
    v_mfma_f32_16x16x32_bf16 v[28:31], v[48:51], v[76:79], v[28:31]
    v_mfma_f32_16x16x32_bf16 v[28:31], v[52:55], v[72:75], v[28:31]
    v_mfma_f32_16x16x32_bf16 v[28:31], v[56:59], v[68:71], v[28:31]
    v_mfma_f32_16x16x32_bf16 v[28:31], v[60:63], v[64:67], v[28:31]
    s_waitcnt lgkmcnt(0)
    v_mfma_f32_16x16x32_bf16 v[0:3], v[96:99], v[128:131], v[0:3]
    ds_read_b128 v[32:35], v160 offset:256
    ds_read_b128 v[64:67], v161 offset:3840
    ds_read_b128 v[36:39], v160 offset:768
    ds_read_b128 v[68:71], v161 offset:3328
    v_mfma_f32_16x16x32_bf16 v[4:7], v[96:99], v[132:135], v[4:7]
    ds_read_b128 v[40:43], v160 offset:1280
    v_mfma_f32_16x16x32_bf16 v[4:7], v[100:103], v[128:131], v[4:7]
    v_mfma_f32_16x16x32_bf16 v[8:11], v[96:99], v[136:139], v[8:11]
    ds_read_b128 v[72:75], v161 offset:2816
    v_mfma_f32_16x16x32_bf16 v[8:11], v[100:103], v[132:135], v[8:11]
    v_mfma_f32_16x16x32_bf16 v[8:11], v[104:107], v[128:131], v[8:11]
    ds_read_b128 v[44:47], v160 offset:1792
    v_mfma_f32_16x16x32_bf16 v[12:15], v[96:99], v[140:143], v[12:15]
    v_mfma_f32_16x16x32_bf16 v[12:15], v[100:103], v[136:139], v[12:15]
    ds_read_b128 v[76:79], v161 offset:2304
    v_mfma_f32_16x16x32_bf16 v[12:15], v[104:107], v[132:135], v[12:15]
    v_mfma_f32_16x16x32_bf16 v[12:15], v[108:111], v[128:131], v[12:15]
    v_mfma_f32_16x16x32_bf16 v[16:19], v[96:99], v[144:147], v[16:19]
    ds_read_b128 v[48:51], v160 offset:2304
    v_mfma_f32_16x16x32_bf16 v[16:19], v[100:103], v[140:143], v[16:19]
    v_mfma_f32_16x16x32_bf16 v[16:19], v[104:107], v[136:139], v[16:19]
    ds_read_b128 v[80:83], v161 offset:1792
    v_mfma_f32_16x16x32_bf16 v[16:19], v[108:111], v[132:135], v[16:19]
    v_mfma_f32_16x16x32_bf16 v[16:19], v[112:115], v[128:131], v[16:19]
    ds_read_b128 v[52:55], v160 offset:2816
    v_mfma_f32_16x16x32_bf16 v[20:23], v[96:99], v[148:151], v[20:23]
    v_mfma_f32_16x16x32_bf16 v[20:23], v[100:103], v[144:147], v[20:23]
    ds_read_b128 v[84:87], v161 offset:1280
    v_mfma_f32_16x16x32_bf16 v[20:23], v[104:107], v[140:143], v[20:23]
    v_mfma_f32_16x16x32_bf16 v[20:23], v[108:111], v[136:139], v[20:23]
    v_mfma_f32_16x16x32_bf16 v[20:23], v[112:115], v[132:135], v[20:23]
    ds_read_b128 v[56:59], v160 offset:3328
    v_mfma_f32_16x16x32_bf16 v[20:23], v[116:119], v[128:131], v[20:23]
    v_mfma_f32_16x16x32_bf16 v[24:27], v[96:99], v[152:155], v[24:27]
    ds_read_b128 v[88:91], v161 offset:768
    v_mfma_f32_16x16x32_bf16 v[24:27], v[100:103], v[148:151], v[24:27]
    v_mfma_f32_16x16x32_bf16 v[24:27], v[104:107], v[144:147], v[24:27]
    ds_read_b128 v[60:63], v160 offset:3840
    v_mfma_f32_16x16x32_bf16 v[24:27], v[108:111], v[140:143], v[24:27]
    v_mfma_f32_16x16x32_bf16 v[24:27], v[112:115], v[136:139], v[24:27]
    ds_read_b128 v[92:95], v161 offset:256
    v_mfma_f32_16x16x32_bf16 v[24:27], v[116:119], v[132:135], v[24:27]
    v_mfma_f32_16x16x32_bf16 v[24:27], v[120:123], v[128:131], v[24:27]
    v_mfma_f32_16x16x32_bf16 v[28:31], v[96:99], v[156:159], v[28:31]
    v_mfma_f32_16x16x32_bf16 v[28:31], v[100:103], v[152:155], v[28:31]
    v_mfma_f32_16x16x32_bf16 v[28:31], v[104:107], v[148:151], v[28:31]
    v_mfma_f32_16x16x32_bf16 v[28:31], v[108:111], v[144:147], v[28:31]
    v_mfma_f32_16x16x32_bf16 v[28:31], v[112:115], v[140:143], v[28:31]
    v_mfma_f32_16x16x32_bf16 v[28:31], v[116:119], v[136:139], v[28:31]
    v_mfma_f32_16x16x32_bf16 v[28:31], v[120:123], v[132:135], v[28:31]
    v_mfma_f32_16x16x32_bf16 v[28:31], v[124:127], v[128:131], v[28:31]
    s_waitcnt lgkmcnt(0)
    v_mfma_f32_16x16x32_bf16 v[0:3], v[32:35], v[64:67], v[0:3]
    ds_read_b128 v[96:99], v160 offset:320
    ds_read_b128 v[128:131], v161 offset:3904
    ds_read_b128 v[100:103], v160 offset:832
    ds_read_b128 v[132:135], v161 offset:3392
    v_mfma_f32_16x16x32_bf16 v[4:7], v[32:35], v[68:71], v[4:7]
    ds_read_b128 v[104:107], v160 offset:1344
    v_mfma_f32_16x16x32_bf16 v[4:7], v[36:39], v[64:67], v[4:7]
    v_mfma_f32_16x16x32_bf16 v[8:11], v[32:35], v[72:75], v[8:11]
    ds_read_b128 v[136:139], v161 offset:2880
    v_mfma_f32_16x16x32_bf16 v[8:11], v[36:39], v[68:71], v[8:11]
    v_mfma_f32_16x16x32_bf16 v[8:11], v[40:43], v[64:67], v[8:11]
    ds_read_b128 v[108:111], v160 offset:1856
    v_mfma_f32_16x16x32_bf16 v[12:15], v[32:35], v[76:79], v[12:15]
    v_mfma_f32_16x16x32_bf16 v[12:15], v[36:39], v[72:75], v[12:15]
    ds_read_b128 v[140:143], v161 offset:2368
    v_mfma_f32_16x16x32_bf16 v[12:15], v[40:43], v[68:71], v[12:15]
    v_mfma_f32_16x16x32_bf16 v[12:15], v[44:47], v[64:67], v[12:15]
    v_mfma_f32_16x16x32_bf16 v[16:19], v[32:35], v[80:83], v[16:19]
    ds_read_b128 v[112:115], v160 offset:2368
    v_mfma_f32_16x16x32_bf16 v[16:19], v[36:39], v[76:79], v[16:19]
    v_mfma_f32_16x16x32_bf16 v[16:19], v[40:43], v[72:75], v[16:19]
    ds_read_b128 v[144:147], v161 offset:1856
    v_mfma_f32_16x16x32_bf16 v[16:19], v[44:47], v[68:71], v[16:19]
    v_mfma_f32_16x16x32_bf16 v[16:19], v[48:51], v[64:67], v[16:19]
    ds_read_b128 v[116:119], v160 offset:2880
    v_mfma_f32_16x16x32_bf16 v[20:23], v[32:35], v[84:87], v[20:23]
    v_mfma_f32_16x16x32_bf16 v[20:23], v[36:39], v[80:83], v[20:23]
    ds_read_b128 v[148:151], v161 offset:1344
    v_mfma_f32_16x16x32_bf16 v[20:23], v[40:43], v[76:79], v[20:23]
    v_mfma_f32_16x16x32_bf16 v[20:23], v[44:47], v[72:75], v[20:23]
    v_mfma_f32_16x16x32_bf16 v[20:23], v[48:51], v[68:71], v[20:23]
    ds_read_b128 v[120:123], v160 offset:3392
    v_mfma_f32_16x16x32_bf16 v[20:23], v[52:55], v[64:67], v[20:23]
    v_mfma_f32_16x16x32_bf16 v[24:27], v[32:35], v[88:91], v[24:27]
    ds_read_b128 v[152:155], v161 offset:832
    v_mfma_f32_16x16x32_bf16 v[24:27], v[36:39], v[84:87], v[24:27]
    v_mfma_f32_16x16x32_bf16 v[24:27], v[40:43], v[80:83], v[24:27]
    ds_read_b128 v[124:127], v160 offset:3904
    v_mfma_f32_16x16x32_bf16 v[24:27], v[44:47], v[76:79], v[24:27]
    v_mfma_f32_16x16x32_bf16 v[24:27], v[48:51], v[72:75], v[24:27]
    ds_read_b128 v[156:159], v161 offset:320
    v_mfma_f32_16x16x32_bf16 v[24:27], v[52:55], v[68:71], v[24:27]
    v_mfma_f32_16x16x32_bf16 v[24:27], v[56:59], v[64:67], v[24:27]
    v_mfma_f32_16x16x32_bf16 v[28:31], v[32:35], v[92:95], v[28:31]
    v_mfma_f32_16x16x32_bf16 v[28:31], v[36:39], v[88:91], v[28:31]
    v_mfma_f32_16x16x32_bf16 v[28:31], v[40:43], v[84:87], v[28:31]
    v_mfma_f32_16x16x32_bf16 v[28:31], v[44:47], v[80:83], v[28:31]
    v_mfma_f32_16x16x32_bf16 v[28:31], v[48:51], v[76:79], v[28:31]
    v_mfma_f32_16x16x32_bf16 v[28:31], v[52:55], v[72:75], v[28:31]
    v_mfma_f32_16x16x32_bf16 v[28:31], v[56:59], v[68:71], v[28:31]
    v_mfma_f32_16x16x32_bf16 v[28:31], v[60:63], v[64:67], v[28:31]
    s_waitcnt lgkmcnt(0)
    v_mfma_f32_16x16x32_bf16 v[0:3], v[96:99], v[128:131], v[0:3]
    ds_read_b128 v[32:35], v160 offset:384
    ds_read_b128 v[64:67], v161 offset:3968
    ds_read_b128 v[36:39], v160 offset:896
    ds_read_b128 v[68:71], v161 offset:3456
    v_mfma_f32_16x16x32_bf16 v[4:7], v[96:99], v[132:135], v[4:7]
    ds_read_b128 v[40:43], v160 offset:1408
    v_mfma_f32_16x16x32_bf16 v[4:7], v[100:103], v[128:131], v[4:7]
    v_mfma_f32_16x16x32_bf16 v[8:11], v[96:99], v[136:139], v[8:11]
    ds_read_b128 v[72:75], v161 offset:2944
    v_mfma_f32_16x16x32_bf16 v[8:11], v[100:103], v[132:135], v[8:11]
    v_mfma_f32_16x16x32_bf16 v[8:11], v[104:107], v[128:131], v[8:11]
    ds_read_b128 v[44:47], v160 offset:1920
    v_mfma_f32_16x16x32_bf16 v[12:15], v[96:99], v[140:143], v[12:15]
    v_mfma_f32_16x16x32_bf16 v[12:15], v[100:103], v[136:139], v[12:15]
    ds_read_b128 v[76:79], v161 offset:2432
    v_mfma_f32_16x16x32_bf16 v[12:15], v[104:107], v[132:135], v[12:15]
    v_mfma_f32_16x16x32_bf16 v[12:15], v[108:111], v[128:131], v[12:15]
    v_mfma_f32_16x16x32_bf16 v[16:19], v[96:99], v[144:147], v[16:19]
    ds_read_b128 v[48:51], v160 offset:2432
    v_mfma_f32_16x16x32_bf16 v[16:19], v[100:103], v[140:143], v[16:19]
    v_mfma_f32_16x16x32_bf16 v[16:19], v[104:107], v[136:139], v[16:19]
    ds_read_b128 v[80:83], v161 offset:1920
    v_mfma_f32_16x16x32_bf16 v[16:19], v[108:111], v[132:135], v[16:19]
    v_mfma_f32_16x16x32_bf16 v[16:19], v[112:115], v[128:131], v[16:19]
    ds_read_b128 v[52:55], v160 offset:2944
    v_mfma_f32_16x16x32_bf16 v[20:23], v[96:99], v[148:151], v[20:23]
    v_mfma_f32_16x16x32_bf16 v[20:23], v[100:103], v[144:147], v[20:23]
    ds_read_b128 v[84:87], v161 offset:1408
    v_mfma_f32_16x16x32_bf16 v[20:23], v[104:107], v[140:143], v[20:23]
    v_mfma_f32_16x16x32_bf16 v[20:23], v[108:111], v[136:139], v[20:23]
    v_mfma_f32_16x16x32_bf16 v[20:23], v[112:115], v[132:135], v[20:23]
    ds_read_b128 v[56:59], v160 offset:3456
    v_mfma_f32_16x16x32_bf16 v[20:23], v[116:119], v[128:131], v[20:23]
    v_mfma_f32_16x16x32_bf16 v[24:27], v[96:99], v[152:155], v[24:27]
    ds_read_b128 v[88:91], v161 offset:896
    v_mfma_f32_16x16x32_bf16 v[24:27], v[100:103], v[148:151], v[24:27]
    v_mfma_f32_16x16x32_bf16 v[24:27], v[104:107], v[144:147], v[24:27]
    ds_read_b128 v[60:63], v160 offset:3968
    v_mfma_f32_16x16x32_bf16 v[24:27], v[108:111], v[140:143], v[24:27]
    v_mfma_f32_16x16x32_bf16 v[24:27], v[112:115], v[136:139], v[24:27]
    ds_read_b128 v[92:95], v161 offset:384
    v_mfma_f32_16x16x32_bf16 v[24:27], v[116:119], v[132:135], v[24:27]
    v_mfma_f32_16x16x32_bf16 v[24:27], v[120:123], v[128:131], v[24:27]
    v_mfma_f32_16x16x32_bf16 v[28:31], v[96:99], v[156:159], v[28:31]
    v_mfma_f32_16x16x32_bf16 v[28:31], v[100:103], v[152:155], v[28:31]
    v_mfma_f32_16x16x32_bf16 v[28:31], v[104:107], v[148:151], v[28:31]
    v_mfma_f32_16x16x32_bf16 v[28:31], v[108:111], v[144:147], v[28:31]
    v_mfma_f32_16x16x32_bf16 v[28:31], v[112:115], v[140:143], v[28:31]
    v_mfma_f32_16x16x32_bf16 v[28:31], v[116:119], v[136:139], v[28:31]
    v_mfma_f32_16x16x32_bf16 v[28:31], v[120:123], v[132:135], v[28:31]
    v_mfma_f32_16x16x32_bf16 v[28:31], v[124:127], v[128:131], v[28:31]
    s_waitcnt lgkmcnt(0)
    v_mfma_f32_16x16x32_bf16 v[0:3], v[32:35], v[64:67], v[0:3]
    ds_read_b128 v[96:99], v160 offset:448
    ds_read_b128 v[128:131], v161 offset:4032
    ds_read_b128 v[100:103], v160 offset:960
    ds_read_b128 v[132:135], v161 offset:3520
    v_mfma_f32_16x16x32_bf16 v[4:7], v[32:35], v[68:71], v[4:7]
    ds_read_b128 v[104:107], v160 offset:1472
    v_mfma_f32_16x16x32_bf16 v[4:7], v[36:39], v[64:67], v[4:7]
    v_mfma_f32_16x16x32_bf16 v[8:11], v[32:35], v[72:75], v[8:11]
    ds_read_b128 v[136:139], v161 offset:3008
    v_mfma_f32_16x16x32_bf16 v[8:11], v[36:39], v[68:71], v[8:11]
    v_mfma_f32_16x16x32_bf16 v[8:11], v[40:43], v[64:67], v[8:11]
    ds_read_b128 v[108:111], v160 offset:1984
    v_mfma_f32_16x16x32_bf16 v[12:15], v[32:35], v[76:79], v[12:15]
    v_mfma_f32_16x16x32_bf16 v[12:15], v[36:39], v[72:75], v[12:15]
    ds_read_b128 v[140:143], v161 offset:2496
    v_mfma_f32_16x16x32_bf16 v[12:15], v[40:43], v[68:71], v[12:15]
    v_mfma_f32_16x16x32_bf16 v[12:15], v[44:47], v[64:67], v[12:15]
    v_mfma_f32_16x16x32_bf16 v[16:19], v[32:35], v[80:83], v[16:19]
    ds_read_b128 v[112:115], v160 offset:2496
    v_mfma_f32_16x16x32_bf16 v[16:19], v[36:39], v[76:79], v[16:19]
    v_mfma_f32_16x16x32_bf16 v[16:19], v[40:43], v[72:75], v[16:19]
    ds_read_b128 v[144:147], v161 offset:1984
    v_mfma_f32_16x16x32_bf16 v[16:19], v[44:47], v[68:71], v[16:19]
    v_mfma_f32_16x16x32_bf16 v[16:19], v[48:51], v[64:67], v[16:19]
    ds_read_b128 v[116:119], v160 offset:3008
    v_mfma_f32_16x16x32_bf16 v[20:23], v[32:35], v[84:87], v[20:23]
    v_mfma_f32_16x16x32_bf16 v[20:23], v[36:39], v[80:83], v[20:23]
    ds_read_b128 v[148:151], v161 offset:1472
    v_mfma_f32_16x16x32_bf16 v[20:23], v[40:43], v[76:79], v[20:23]
    v_mfma_f32_16x16x32_bf16 v[20:23], v[44:47], v[72:75], v[20:23]
    v_mfma_f32_16x16x32_bf16 v[20:23], v[48:51], v[68:71], v[20:23]
    ds_read_b128 v[120:123], v160 offset:3520
    v_mfma_f32_16x16x32_bf16 v[20:23], v[52:55], v[64:67], v[20:23]
    v_mfma_f32_16x16x32_bf16 v[24:27], v[32:35], v[88:91], v[24:27]
    ds_read_b128 v[152:155], v161 offset:960
    v_mfma_f32_16x16x32_bf16 v[24:27], v[36:39], v[84:87], v[24:27]
    v_mfma_f32_16x16x32_bf16 v[24:27], v[40:43], v[80:83], v[24:27]
    ds_read_b128 v[124:127], v160 offset:4032
    v_mfma_f32_16x16x32_bf16 v[24:27], v[44:47], v[76:79], v[24:27]
    v_mfma_f32_16x16x32_bf16 v[24:27], v[48:51], v[72:75], v[24:27]
    ds_read_b128 v[156:159], v161 offset:448
    v_mfma_f32_16x16x32_bf16 v[24:27], v[52:55], v[68:71], v[24:27]
    v_mfma_f32_16x16x32_bf16 v[24:27], v[56:59], v[64:67], v[24:27]
    v_mfma_f32_16x16x32_bf16 v[28:31], v[32:35], v[92:95], v[28:31]
    v_mfma_f32_16x16x32_bf16 v[28:31], v[36:39], v[88:91], v[28:31]
    v_mfma_f32_16x16x32_bf16 v[28:31], v[40:43], v[84:87], v[28:31]
    v_mfma_f32_16x16x32_bf16 v[28:31], v[44:47], v[80:83], v[28:31]
    v_mfma_f32_16x16x32_bf16 v[28:31], v[48:51], v[76:79], v[28:31]
    v_mfma_f32_16x16x32_bf16 v[28:31], v[52:55], v[72:75], v[28:31]
    v_mfma_f32_16x16x32_bf16 v[28:31], v[56:59], v[68:71], v[28:31]
    v_mfma_f32_16x16x32_bf16 v[28:31], v[60:63], v[64:67], v[28:31]
    s_waitcnt lgkmcnt(0)
    v_mfma_f32_16x16x32_bf16 v[0:3], v[96:99], v[128:131], v[0:3]
    v_mfma_f32_16x16x32_bf16 v[4:7], v[96:99], v[132:135], v[4:7]
    v_mfma_f32_16x16x32_bf16 v[4:7], v[100:103], v[128:131], v[4:7]
    v_mfma_f32_16x16x32_bf16 v[8:11], v[96:99], v[136:139], v[8:11]
    v_mfma_f32_16x16x32_bf16 v[8:11], v[100:103], v[132:135], v[8:11]
    v_mfma_f32_16x16x32_bf16 v[8:11], v[104:107], v[128:131], v[8:11]
    v_mfma_f32_16x16x32_bf16 v[12:15], v[96:99], v[140:143], v[12:15]
    v_mfma_f32_16x16x32_bf16 v[12:15], v[100:103], v[136:139], v[12:15]
    v_mfma_f32_16x16x32_bf16 v[12:15], v[104:107], v[132:135], v[12:15]
    v_mfma_f32_16x16x32_bf16 v[12:15], v[108:111], v[128:131], v[12:15]
    v_mfma_f32_16x16x32_bf16 v[16:19], v[96:99], v[144:147], v[16:19]
    v_mfma_f32_16x16x32_bf16 v[16:19], v[100:103], v[140:143], v[16:19]
    v_mfma_f32_16x16x32_bf16 v[16:19], v[104:107], v[136:139], v[16:19]
    v_mfma_f32_16x16x32_bf16 v[16:19], v[108:111], v[132:135], v[16:19]
    v_mfma_f32_16x16x32_bf16 v[16:19], v[112:115], v[128:131], v[16:19]
    v_mfma_f32_16x16x32_bf16 v[20:23], v[96:99], v[148:151], v[20:23]
    v_mfma_f32_16x16x32_bf16 v[20:23], v[100:103], v[144:147], v[20:23]
    v_mfma_f32_16x16x32_bf16 v[20:23], v[104:107], v[140:143], v[20:23]
    v_mfma_f32_16x16x32_bf16 v[20:23], v[108:111], v[136:139], v[20:23]
    v_mfma_f32_16x16x32_bf16 v[20:23], v[112:115], v[132:135], v[20:23]
    v_mfma_f32_16x16x32_bf16 v[20:23], v[116:119], v[128:131], v[20:23]
    v_mfma_f32_16x16x32_bf16 v[24:27], v[96:99], v[152:155], v[24:27]
    v_mfma_f32_16x16x32_bf16 v[24:27], v[100:103], v[148:151], v[24:27]
    v_mfma_f32_16x16x32_bf16 v[24:27], v[104:107], v[144:147], v[24:27]
    v_mfma_f32_16x16x32_bf16 v[24:27], v[108:111], v[140:143], v[24:27]
    v_mfma_f32_16x16x32_bf16 v[24:27], v[112:115], v[136:139], v[24:27]
    v_mfma_f32_16x16x32_bf16 v[24:27], v[116:119], v[132:135], v[24:27]
    v_mfma_f32_16x16x32_bf16 v[24:27], v[120:123], v[128:131], v[24:27]
    v_mfma_f32_16x16x32_bf16 v[28:31], v[96:99], v[156:159], v[28:31]
    v_mfma_f32_16x16x32_bf16 v[28:31], v[100:103], v[152:155], v[28:31]
    v_mfma_f32_16x16x32_bf16 v[28:31], v[104:107], v[148:151], v[28:31]
    v_mfma_f32_16x16x32_bf16 v[28:31], v[108:111], v[144:147], v[28:31]
    v_mfma_f32_16x16x32_bf16 v[28:31], v[112:115], v[140:143], v[28:31]
    v_mfma_f32_16x16x32_bf16 v[28:31], v[116:119], v[136:139], v[28:31]
    v_mfma_f32_16x16x32_bf16 v[28:31], v[120:123], v[132:135], v[28:31]
    v_mfma_f32_16x16x32_bf16 v[28:31], v[124:127], v[128:131], v[28:31]
    v_lshlrev_b32 v208, 16, v208
    v_lshlrev_b32 v163, 4, v246
    v_and_b32 v247, 3, v245
    v_lshlrev_b32 v247, 1, v247
    v_add_u32 v163, v163, v247
    v_lshrrev_b32 v247, 2, v245
    v_lshlrev_b32 v247, 6, v247
    v_add_u32 v163, v163, v247
    v_lshlrev_b32 v163, 1, v163
    s_add_u32 s36, s38, 23372
    v_sub_u32 v162, s36, v163
    ds_read_b32 v32, v162 offset:3600
    ds_read_b32 v33, v162 offset:3584
    ds_read_b32 v34, v162 offset:3088
    ds_read_b32 v35, v162 offset:3072
    ds_read_b32 v36, v162 offset:2576
    ds_read_b32 v37, v162 offset:2560
    ds_read_b32 v38, v162 offset:2064
    ds_read_b32 v39, v162 offset:2048
    ds_read_b32 v40, v162 offset:1552
    ds_read_b32 v41, v162 offset:1536
    ds_read_b32 v42, v162 offset:1040
    ds_read_b32 v43, v162 offset:1024
    ds_read_b32 v44, v162 offset:528
    ds_read_b32 v45, v162 offset:512
    ds_read_b32 v46, v162 offset:16
    ds_read_b32 v47, v162 offset:0
    s_lshl_b32 s36, s35, 12
    s_add_u32 s36, s36, 29360128
    v_add_u32 v163, s36, v163
    s_waitcnt lgkmcnt(0)
    s_nop 3
    v_and_b32 v64, 0xffff0000, v32
    v_lshlrev_b32 v65, 16, v32
    v_mul_f32 v64, v64, v208
    v_mul_f32 v65, v65, v208
    v_cvt_pk_bf16_f32 v64, 0, v64
    v_cvt_pk_bf16_f32 v65, 0, v65
    v_cvt_pk_bf16_f32 v0, 0, v0
    v_cvt_pk_bf16_f32 v1, 0, v1
    v_add_f32 v64, v64, v0
    v_add_f32 v65, v65, v1
    v_cvt_pk_bf16_f32 v96, v64, v65
    v_and_b32 v64, 0xffff0000, v33
    v_lshlrev_b32 v65, 16, v33
    v_mul_f32 v64, v64, v208
    v_mul_f32 v65, v65, v208
    v_cvt_pk_bf16_f32 v64, 0, v64
    v_cvt_pk_bf16_f32 v65, 0, v65
    v_cvt_pk_bf16_f32 v2, 0, v2
    v_cvt_pk_bf16_f32 v3, 0, v3
    v_add_f32 v64, v64, v2
    v_add_f32 v65, v65, v3
    v_cvt_pk_bf16_f32 v97, v64, v65
    v_and_b32 v64, 0xffff0000, v34
    v_lshlrev_b32 v65, 16, v34
    v_mul_f32 v64, v64, v208
    v_mul_f32 v65, v65, v208
    v_cvt_pk_bf16_f32 v64, 0, v64
    v_cvt_pk_bf16_f32 v65, 0, v65
    v_cvt_pk_bf16_f32 v4, 0, v4
    v_cvt_pk_bf16_f32 v5, 0, v5
    v_add_f32 v64, v64, v4
    v_add_f32 v65, v65, v5
    v_cvt_pk_bf16_f32 v98, v64, v65
    v_and_b32 v64, 0xffff0000, v35
    v_lshlrev_b32 v65, 16, v35
    v_mul_f32 v64, v64, v208
    v_mul_f32 v65, v65, v208
    v_cvt_pk_bf16_f32 v64, 0, v64
    v_cvt_pk_bf16_f32 v65, 0, v65
    v_cvt_pk_bf16_f32 v6, 0, v6
    v_cvt_pk_bf16_f32 v7, 0, v7
    v_add_f32 v64, v64, v6
    v_add_f32 v65, v65, v7
    v_cvt_pk_bf16_f32 v99, v64, v65
    v_and_b32 v64, 0xffff0000, v36
    v_lshlrev_b32 v65, 16, v36
    v_mul_f32 v64, v64, v208
    v_mul_f32 v65, v65, v208
    v_cvt_pk_bf16_f32 v64, 0, v64
    v_cvt_pk_bf16_f32 v65, 0, v65
    v_cvt_pk_bf16_f32 v8, 0, v8
    v_cvt_pk_bf16_f32 v9, 0, v9
    v_add_f32 v64, v64, v8
    v_add_f32 v65, v65, v9
    v_cvt_pk_bf16_f32 v100, v64, v65
    v_and_b32 v64, 0xffff0000, v37
    v_lshlrev_b32 v65, 16, v37
    v_mul_f32 v64, v64, v208
    v_mul_f32 v65, v65, v208
    v_cvt_pk_bf16_f32 v64, 0, v64
    v_cvt_pk_bf16_f32 v65, 0, v65
    v_cvt_pk_bf16_f32 v10, 0, v10
    v_cvt_pk_bf16_f32 v11, 0, v11
    v_add_f32 v64, v64, v10
    v_add_f32 v65, v65, v11
    v_cvt_pk_bf16_f32 v101, v64, v65
    v_and_b32 v64, 0xffff0000, v38
    v_lshlrev_b32 v65, 16, v38
    v_mul_f32 v64, v64, v208
    v_mul_f32 v65, v65, v208
    v_cvt_pk_bf16_f32 v64, 0, v64
    v_cvt_pk_bf16_f32 v65, 0, v65
    v_cvt_pk_bf16_f32 v12, 0, v12
    v_cvt_pk_bf16_f32 v13, 0, v13
    v_add_f32 v64, v64, v12
    v_add_f32 v65, v65, v13
    v_cvt_pk_bf16_f32 v102, v64, v65
    v_and_b32 v64, 0xffff0000, v39
    v_lshlrev_b32 v65, 16, v39
    v_mul_f32 v64, v64, v208
    v_mul_f32 v65, v65, v208
    v_cvt_pk_bf16_f32 v64, 0, v64
    v_cvt_pk_bf16_f32 v65, 0, v65
    v_cvt_pk_bf16_f32 v14, 0, v14
    v_cvt_pk_bf16_f32 v15, 0, v15
    v_add_f32 v64, v64, v14
    v_add_f32 v65, v65, v15
    v_cvt_pk_bf16_f32 v103, v64, v65
    v_and_b32 v64, 0xffff0000, v40
    v_lshlrev_b32 v65, 16, v40
    v_mul_f32 v64, v64, v208
    v_mul_f32 v65, v65, v208
    v_cvt_pk_bf16_f32 v64, 0, v64
    v_cvt_pk_bf16_f32 v65, 0, v65
    v_cvt_pk_bf16_f32 v16, 0, v16
    v_cvt_pk_bf16_f32 v17, 0, v17
    v_add_f32 v64, v64, v16
    v_add_f32 v65, v65, v17
    v_cvt_pk_bf16_f32 v104, v64, v65
    v_and_b32 v64, 0xffff0000, v41
    v_lshlrev_b32 v65, 16, v41
    v_mul_f32 v64, v64, v208
    v_mul_f32 v65, v65, v208
    v_cvt_pk_bf16_f32 v64, 0, v64
    v_cvt_pk_bf16_f32 v65, 0, v65
    v_cvt_pk_bf16_f32 v18, 0, v18
    v_cvt_pk_bf16_f32 v19, 0, v19
    v_add_f32 v64, v64, v18
    v_add_f32 v65, v65, v19
    v_cvt_pk_bf16_f32 v105, v64, v65
    v_and_b32 v64, 0xffff0000, v42
    v_lshlrev_b32 v65, 16, v42
    v_mul_f32 v64, v64, v208
    v_mul_f32 v65, v65, v208
    v_cvt_pk_bf16_f32 v64, 0, v64
    v_cvt_pk_bf16_f32 v65, 0, v65
    v_cvt_pk_bf16_f32 v20, 0, v20
    v_cvt_pk_bf16_f32 v21, 0, v21
    v_add_f32 v64, v64, v20
    v_add_f32 v65, v65, v21
    v_cvt_pk_bf16_f32 v106, v64, v65
    v_and_b32 v64, 0xffff0000, v43
    v_lshlrev_b32 v65, 16, v43
    v_mul_f32 v64, v64, v208
    v_mul_f32 v65, v65, v208
    v_cvt_pk_bf16_f32 v64, 0, v64
    v_cvt_pk_bf16_f32 v65, 0, v65
    v_cvt_pk_bf16_f32 v22, 0, v22
    v_cvt_pk_bf16_f32 v23, 0, v23
    v_add_f32 v64, v64, v22
    v_add_f32 v65, v65, v23
    v_cvt_pk_bf16_f32 v107, v64, v65
    v_and_b32 v64, 0xffff0000, v44
    v_lshlrev_b32 v65, 16, v44
    v_mul_f32 v64, v64, v208
    v_mul_f32 v65, v65, v208
    v_cvt_pk_bf16_f32 v64, 0, v64
    v_cvt_pk_bf16_f32 v65, 0, v65
    v_cvt_pk_bf16_f32 v24, 0, v24
    v_cvt_pk_bf16_f32 v25, 0, v25
    v_add_f32 v64, v64, v24
    v_add_f32 v65, v65, v25
    v_cvt_pk_bf16_f32 v108, v64, v65
    v_and_b32 v64, 0xffff0000, v45
    v_lshlrev_b32 v65, 16, v45
    v_mul_f32 v64, v64, v208
    v_mul_f32 v65, v65, v208
    v_cvt_pk_bf16_f32 v64, 0, v64
    v_cvt_pk_bf16_f32 v65, 0, v65
    v_cvt_pk_bf16_f32 v26, 0, v26
    v_cvt_pk_bf16_f32 v27, 0, v27
    v_add_f32 v64, v64, v26
    v_add_f32 v65, v65, v27
    v_cvt_pk_bf16_f32 v109, v64, v65
    v_and_b32 v64, 0xffff0000, v46
    v_lshlrev_b32 v65, 16, v46
    v_mul_f32 v64, v64, v208
    v_mul_f32 v65, v65, v208
    v_cvt_pk_bf16_f32 v64, 0, v64
    v_cvt_pk_bf16_f32 v65, 0, v65
    v_cvt_pk_bf16_f32 v28, 0, v28
    v_cvt_pk_bf16_f32 v29, 0, v29
    v_add_f32 v64, v64, v28
    v_add_f32 v65, v65, v29
    v_cvt_pk_bf16_f32 v110, v64, v65
    v_and_b32 v64, 0xffff0000, v47
    v_lshlrev_b32 v65, 16, v47
    v_mul_f32 v64, v64, v208
    v_mul_f32 v65, v65, v208
    v_cvt_pk_bf16_f32 v64, 0, v64
    v_cvt_pk_bf16_f32 v65, 0, v65
    v_cvt_pk_bf16_f32 v30, 0, v30
    v_cvt_pk_bf16_f32 v31, 0, v31
    v_add_f32 v64, v64, v30
    v_add_f32 v65, v65, v31
    v_cvt_pk_bf16_f32 v111, v64, v65
    buffer_store_dword v96, v163, s[4:7], 0 offen offset:0
    buffer_store_dword v97, v163, s[4:7], 0 offen offset:16
    buffer_store_dword v98, v163, s[4:7], 0 offen offset:512
    buffer_store_dword v99, v163, s[4:7], 0 offen offset:528
    buffer_store_dword v100, v163, s[4:7], 0 offen offset:1024
    buffer_store_dword v101, v163, s[4:7], 0 offen offset:1040
    buffer_store_dword v102, v163, s[4:7], 0 offen offset:1536
    buffer_store_dword v103, v163, s[4:7], 0 offen offset:1552
    buffer_store_dword v104, v163, s[4:7], 0 offen offset:2048
    buffer_store_dword v105, v163, s[4:7], 0 offen offset:2064
    buffer_store_dword v106, v163, s[4:7], 0 offen offset:2560
    buffer_store_dword v107, v163, s[4:7], 0 offen offset:2576
    buffer_store_dword v108, v163, s[4:7], 0 offen offset:3072
    buffer_store_dword v109, v163, s[4:7], 0 offen offset:3088
    buffer_store_dword v110, v163, s[4:7], 0 offen offset:3584
    buffer_store_dword v111, v163, s[4:7], 0 offen offset:3600
    s_branch K2_END
K2_O:
    s_mov_b32 s16, s68
    s_and_b32 s17, s69, 0xffff
    s_mov_b32 s18, 65536
    s_mov_b32 s19, 0x00020000
    s_mov_b32 s40, 1069066811
    s_and_b32 s36, s2, 7
    s_lshl_b32 s33, s36, 2
    s_bfe_u32 s36, s2, 0x20003
    s_add_u32 s33, s33, s36
    s_lshr_b32 s34, s2, 5
    s_lshl_b32 s37, s33, 7
    s_lshl_b32 s46, s34, 4
    s_add_u32 s37, s37, s46
    s_lshl_b32 s46, s39, 2
    s_add_u32 s37, s37, s46
    s_lshl_b32 s37, s37, 10
    s_add_u32 s37, s37, 8388608
    buffer_load_dwordx4 v[192:195], v244, s[4:7], s37 offen offset:0
    buffer_load_dwordx4 v[196:199], v244, s[4:7], s37 offen offset:1024
    buffer_load_dwordx4 v[200:203], v244, s[4:7], s37 offen offset:2048
    buffer_load_dwordx4 v[204:207], v244, s[4:7], s37 offen offset:3072
    v_lshrrev_b32 v247, 4, v250
    v_lshlrev_b32 v247, 8, v247
    v_and_b32 v248, 15, v250
    v_lshlrev_b32 v248, 1, v248
    v_add_u32 v247, v247, v248
    s_lshl_b32 s37, s33, 11
    buffer_load_ushort v208, v247, s[16:19], s37 offen offset:0
    buffer_load_ushort v209, v247, s[16:19], s37 offen offset:64
    buffer_load_ushort v210, v247, s[16:19], s37 offen offset:128
    buffer_load_ushort v211, v247, s[16:19], s37 offen offset:192
    buffer_load_ushort v212, v247, s[16:19], s37 offen offset:1024
    buffer_load_ushort v213, v247, s[16:19], s37 offen offset:1088
    buffer_load_ushort v214, v247, s[16:19], s37 offen offset:1152
    buffer_load_ushort v215, v247, s[16:19], s37 offen offset:1216
    buffer_load_ushort v216, v247, s[16:19], s37 offen offset:32
    buffer_load_ushort v217, v247, s[16:19], s37 offen offset:96
    buffer_load_ushort v218, v247, s[16:19], s37 offen offset:160
    buffer_load_ushort v219, v247, s[16:19], s37 offen offset:224
    buffer_load_ushort v220, v247, s[16:19], s37 offen offset:1056
    buffer_load_ushort v221, v247, s[16:19], s37 offen offset:1120
    buffer_load_ushort v222, v247, s[16:19], s37 offen offset:1184
    buffer_load_ushort v223, v247, s[16:19], s37 offen offset:1248
    s_lshl_b32 s36, s33, 4
    s_mul_i32 s36, s36, 8448
    s_add_u32 s36, s36, 16777216
    s_lshl_b32 s37, s39, 11
    v_add_u32 v245, s37, v244
    v_lshrrev_b32 v246, 4, v250
    v_lshlrev_b32 v246, 4, v246
    s_lshl_b32 s37, s39, 6
    s_add_u32 s37, s37, 8192
    v_add_u32 v246, s37, v246
    buffer_load_dwordx4 v[0:3], v245, s[4:7], s36 offen
    buffer_load_dwordx4 v[4:7], v245, s[4:7], s36 offen offset:1024
    buffer_load_dwordx4 v[8:11], v246, s[4:7], s36 offen
    s_add_u32 s36, s36, 8448
    buffer_load_dwordx4 v[12:15], v245, s[4:7], s36 offen
    buffer_load_dwordx4 v[16:19], v245, s[4:7], s36 offen offset:1024
    buffer_load_dwordx4 v[20:23], v246, s[4:7], s36 offen
    s_add_u32 s36, s36, 8448
    buffer_load_dwordx4 v[24:27], v245, s[4:7], s36 offen
    buffer_load_dwordx4 v[28:31], v245, s[4:7], s36 offen offset:1024
    buffer_load_dwordx4 v[32:35], v246, s[4:7], s36 offen
    s_add_u32 s36, s36, 8448
    buffer_load_dwordx4 v[36:39], v245, s[4:7], s36 offen
    buffer_load_dwordx4 v[40:43], v245, s[4:7], s36 offen offset:1024
    buffer_load_dwordx4 v[44:47], v246, s[4:7], s36 offen
    s_add_u32 s36, s36, 8448
    buffer_load_dwordx4 v[48:51], v245, s[4:7], s36 offen
    buffer_load_dwordx4 v[52:55], v245, s[4:7], s36 offen offset:1024
    buffer_load_dwordx4 v[56:59], v246, s[4:7], s36 offen
    s_add_u32 s36, s36, 8448
    buffer_load_dwordx4 v[60:63], v245, s[4:7], s36 offen
    buffer_load_dwordx4 v[64:67], v245, s[4:7], s36 offen offset:1024
    buffer_load_dwordx4 v[68:71], v246, s[4:7], s36 offen
    s_add_u32 s36, s36, 8448
    buffer_load_dwordx4 v[72:75], v245, s[4:7], s36 offen
    buffer_load_dwordx4 v[76:79], v245, s[4:7], s36 offen offset:1024
    buffer_load_dwordx4 v[80:83], v246, s[4:7], s36 offen
    s_add_u32 s36, s36, 8448
    buffer_load_dwordx4 v[84:87], v245, s[4:7], s36 offen
    buffer_load_dwordx4 v[88:91], v245, s[4:7], s36 offen offset:1024
    buffer_load_dwordx4 v[92:95], v246, s[4:7], s36 offen
    s_add_u32 s36, s36, 8448
    buffer_load_dwordx4 v[96:99], v245, s[4:7], s36 offen
    buffer_load_dwordx4 v[100:103], v245, s[4:7], s36 offen offset:1024
    buffer_load_dwordx4 v[104:107], v246, s[4:7], s36 offen
    s_add_u32 s36, s36, 8448
    buffer_load_dwordx4 v[108:111], v245, s[4:7], s36 offen
    buffer_load_dwordx4 v[112:115], v245, s[4:7], s36 offen offset:1024
    buffer_load_dwordx4 v[116:119], v246, s[4:7], s36 offen
    s_add_u32 s36, s36, 8448
    s_waitcnt vmcnt(30)
    s_setprio 2
    v_lshl_or_b32 v224, v209, 16, v208
    v_lshl_or_b32 v225, v211, 16, v210
    v_lshl_or_b32 v226, v213, 16, v212
    v_lshl_or_b32 v227, v215, 16, v214
    v_lshl_or_b32 v228, v217, 16, v216
    v_lshl_or_b32 v229, v219, 16, v218
    v_lshl_or_b32 v230, v221, 16, v220
    v_lshl_or_b32 v231, v223, 16, v222
    s_nop 1
    v_mfma_f32_16x16x32_bf16 v[152:155], v[224:227], v[192:195], 0
    v_mfma_f32_16x16x32_bf16 v[156:159], v[228:231], v[192:195], 0
    s_nop 8
    v_cvt_pk_bf16_f32 v160, 0, v152
    v_cvt_pk_bf16_f32 v161, 0, v153
    v_cvt_pk_bf16_f32 v162, 0, v154
    v_cvt_pk_bf16_f32 v163, 0, v155
    v_cvt_pk_bf16_f32 v164, 0, v156
    v_cvt_pk_bf16_f32 v165, 0, v157
    v_cvt_pk_bf16_f32 v166, 0, v158
    v_cvt_pk_bf16_f32 v167, 0, v159
    v_max3_f32 v184, v160, v161, v162
    v_min3_f32 v185, v160, v161, v162
    v_max3_f32 v184, v184, v163, v164
    v_min3_f32 v185, v185, v163, v164
    v_max3_f32 v184, v184, v165, v166
    v_min3_f32 v185, v185, v165, v166
    v_max_f32 v184, v184, v167
    v_min_f32 v185, v185, v167
    v_sub_f32 v185, 0, v185
    s_nop 1
    v_permlane16_swap_b32 v184, v185
    v_max_f32 v186, v184, v185
    v_mov_b32 v187, v186
    s_nop 1
    v_permlane32_swap_b32 v186, v187
    v_max_f32 v184, v186, v187
    v_mov_b32 v185, v184
    s_nop 1
    v_permlane16_swap_b32 v184, v185
    v_mul_f32 v184, s40, v184
    v_mul_f32 v185, s40, v185
    v_fma_f32 v168, v160, s40, -v184
    v_fma_f32 v176, -v160, s40, -v185
    v_fma_f32 v169, v161, s40, -v184
    v_fma_f32 v177, -v161, s40, -v185
    v_fma_f32 v170, v162, s40, -v184
    v_fma_f32 v178, -v162, s40, -v185
    v_fma_f32 v171, v163, s40, -v184
    v_fma_f32 v179, -v163, s40, -v185
    v_fma_f32 v172, v164, s40, -v184
    v_fma_f32 v180, -v164, s40, -v185
    v_fma_f32 v173, v165, s40, -v184
    v_fma_f32 v181, -v165, s40, -v185
    v_fma_f32 v174, v166, s40, -v184
    v_fma_f32 v182, -v166, s40, -v185
    v_fma_f32 v175, v167, s40, -v184
    v_fma_f32 v183, -v167, s40, -v185
    v_exp_f32 v168, v168
    v_exp_f32 v176, v176
    v_exp_f32 v169, v169
    v_exp_f32 v177, v177
    v_exp_f32 v170, v170
    v_exp_f32 v178, v178
    v_exp_f32 v171, v171
    v_exp_f32 v179, v179
    v_exp_f32 v172, v172
    v_exp_f32 v180, v180
    v_exp_f32 v173, v173
    v_exp_f32 v181, v181
    v_exp_f32 v174, v174
    v_exp_f32 v182, v182
    v_exp_f32 v175, v175
    v_exp_f32 v183, v183
    s_nop 0
    v_add_f32 v188, v168, v169
    v_add_f32 v189, v176, v177
    v_add_f32 v188, v188, v170
    v_add_f32 v189, v189, v178
    v_add_f32 v188, v188, v171
    v_add_f32 v189, v189, v179
    v_add_f32 v188, v188, v172
    v_add_f32 v189, v189, v180
    v_add_f32 v188, v188, v173
    v_add_f32 v189, v189, v181
    v_add_f32 v188, v188, v174
    v_add_f32 v189, v189, v182
    v_add_f32 v188, v188, v175
    v_add_f32 v189, v189, v183
    s_nop 1
    v_permlane16_swap_b32 v188, v189
    v_add_f32 v186, v188, v189
    v_mov_b32 v187, v186
    s_nop 1
    v_permlane32_swap_b32 v186, v187
    v_add_f32 v188, v186, v187
    v_mov_b32 v189, v188
    s_nop 1
    v_permlane16_swap_b32 v188, v189
    v_rcp_f32 v188, v188
    v_rcp_f32 v189, v189
    s_nop 0
    v_mul_f32 v168, v168, v188
    v_mul_f32 v176, v176, v189
    v_mul_f32 v169, v169, v188
    v_mul_f32 v177, v177, v189
    v_mul_f32 v170, v170, v188
    v_mul_f32 v178, v178, v189
    v_mul_f32 v171, v171, v188
    v_mul_f32 v179, v179, v189
    v_mul_f32 v172, v172, v188
    v_mul_f32 v180, v180, v189
    v_mul_f32 v173, v173, v188
    v_mul_f32 v181, v181, v189
    v_mul_f32 v174, v174, v188
    v_mul_f32 v182, v182, v189
    v_mul_f32 v175, v175, v188
    v_mul_f32 v183, v183, v189
    v_cvt_pk_bf16_f32 v120, v168, v169
    v_cvt_pk_bf16_f32 v124, v176, v177
    v_cvt_pk_bf16_f32 v121, v170, v171
    v_cvt_pk_bf16_f32 v125, v178, v179
    v_cvt_pk_bf16_f32 v122, v172, v173
    v_cvt_pk_bf16_f32 v126, v180, v181
    v_cvt_pk_bf16_f32 v123, v174, v175
    v_cvt_pk_bf16_f32 v127, v182, v183
    v_mfma_f32_16x16x32_bf16 v[152:155], v[224:227], v[196:199], 0
    v_mfma_f32_16x16x32_bf16 v[156:159], v[228:231], v[196:199], 0
    s_nop 8
    v_cvt_pk_bf16_f32 v160, 0, v152
    v_cvt_pk_bf16_f32 v161, 0, v153
    v_cvt_pk_bf16_f32 v162, 0, v154
    v_cvt_pk_bf16_f32 v163, 0, v155
    v_cvt_pk_bf16_f32 v164, 0, v156
    v_cvt_pk_bf16_f32 v165, 0, v157
    v_cvt_pk_bf16_f32 v166, 0, v158
    v_cvt_pk_bf16_f32 v167, 0, v159
    v_max3_f32 v184, v160, v161, v162
    v_min3_f32 v185, v160, v161, v162
    v_max3_f32 v184, v184, v163, v164
    v_min3_f32 v185, v185, v163, v164
    v_max3_f32 v184, v184, v165, v166
    v_min3_f32 v185, v185, v165, v166
    v_max_f32 v184, v184, v167
    v_min_f32 v185, v185, v167
    v_sub_f32 v185, 0, v185
    s_nop 1
    v_permlane16_swap_b32 v184, v185
    v_max_f32 v186, v184, v185
    v_mov_b32 v187, v186
    s_nop 1
    v_permlane32_swap_b32 v186, v187
    v_max_f32 v184, v186, v187
    v_mov_b32 v185, v184
    s_nop 1
    v_permlane16_swap_b32 v184, v185
    v_mul_f32 v184, s40, v184
    v_mul_f32 v185, s40, v185
    v_fma_f32 v168, v160, s40, -v184
    v_fma_f32 v176, -v160, s40, -v185
    v_fma_f32 v169, v161, s40, -v184
    v_fma_f32 v177, -v161, s40, -v185
    v_fma_f32 v170, v162, s40, -v184
    v_fma_f32 v178, -v162, s40, -v185
    v_fma_f32 v171, v163, s40, -v184
    v_fma_f32 v179, -v163, s40, -v185
    v_fma_f32 v172, v164, s40, -v184
    v_fma_f32 v180, -v164, s40, -v185
    v_fma_f32 v173, v165, s40, -v184
    v_fma_f32 v181, -v165, s40, -v185
    v_fma_f32 v174, v166, s40, -v184
    v_fma_f32 v182, -v166, s40, -v185
    v_fma_f32 v175, v167, s40, -v184
    v_fma_f32 v183, -v167, s40, -v185
    v_exp_f32 v168, v168
    v_exp_f32 v176, v176
    v_exp_f32 v169, v169
    v_exp_f32 v177, v177
    v_exp_f32 v170, v170
    v_exp_f32 v178, v178
    v_exp_f32 v171, v171
    v_exp_f32 v179, v179
    v_exp_f32 v172, v172
    v_exp_f32 v180, v180
    v_exp_f32 v173, v173
    v_exp_f32 v181, v181
    v_exp_f32 v174, v174
    v_exp_f32 v182, v182
    v_exp_f32 v175, v175
    v_exp_f32 v183, v183
    s_nop 0
    v_add_f32 v188, v168, v169
    v_add_f32 v189, v176, v177
    v_add_f32 v188, v188, v170
    v_add_f32 v189, v189, v178
    v_add_f32 v188, v188, v171
    v_add_f32 v189, v189, v179
    v_add_f32 v188, v188, v172
    v_add_f32 v189, v189, v180
    v_add_f32 v188, v188, v173
    v_add_f32 v189, v189, v181
    v_add_f32 v188, v188, v174
    v_add_f32 v189, v189, v182
    v_add_f32 v188, v188, v175
    v_add_f32 v189, v189, v183
    s_nop 1
    v_permlane16_swap_b32 v188, v189
    v_add_f32 v186, v188, v189
    v_mov_b32 v187, v186
    s_nop 1
    v_permlane32_swap_b32 v186, v187
    v_add_f32 v188, v186, v187
    v_mov_b32 v189, v188
    s_nop 1
    v_permlane16_swap_b32 v188, v189
    v_rcp_f32 v188, v188
    v_rcp_f32 v189, v189
    s_nop 0
    v_mul_f32 v168, v168, v188
    v_mul_f32 v176, v176, v189
    v_mul_f32 v169, v169, v188
    v_mul_f32 v177, v177, v189
    v_mul_f32 v170, v170, v188
    v_mul_f32 v178, v178, v189
    v_mul_f32 v171, v171, v188
    v_mul_f32 v179, v179, v189
    v_mul_f32 v172, v172, v188
    v_mul_f32 v180, v180, v189
    v_mul_f32 v173, v173, v188
    v_mul_f32 v181, v181, v189
    v_mul_f32 v174, v174, v188
    v_mul_f32 v182, v182, v189
    v_mul_f32 v175, v175, v188
    v_mul_f32 v183, v183, v189
    v_cvt_pk_bf16_f32 v128, v168, v169
    v_cvt_pk_bf16_f32 v132, v176, v177
    v_cvt_pk_bf16_f32 v129, v170, v171
    v_cvt_pk_bf16_f32 v133, v178, v179
    v_cvt_pk_bf16_f32 v130, v172, v173
    v_cvt_pk_bf16_f32 v134, v180, v181
    v_cvt_pk_bf16_f32 v131, v174, v175
    v_cvt_pk_bf16_f32 v135, v182, v183
    v_mfma_f32_16x16x32_bf16 v[152:155], v[224:227], v[200:203], 0
    v_mfma_f32_16x16x32_bf16 v[156:159], v[228:231], v[200:203], 0
    s_nop 8
    v_cvt_pk_bf16_f32 v160, 0, v152
    v_cvt_pk_bf16_f32 v161, 0, v153
    v_cvt_pk_bf16_f32 v162, 0, v154
    v_cvt_pk_bf16_f32 v163, 0, v155
    v_cvt_pk_bf16_f32 v164, 0, v156
    v_cvt_pk_bf16_f32 v165, 0, v157
    v_cvt_pk_bf16_f32 v166, 0, v158
    v_cvt_pk_bf16_f32 v167, 0, v159
    v_max3_f32 v184, v160, v161, v162
    v_min3_f32 v185, v160, v161, v162
    v_max3_f32 v184, v184, v163, v164
    v_min3_f32 v185, v185, v163, v164
    v_max3_f32 v184, v184, v165, v166
    v_min3_f32 v185, v185, v165, v166
    v_max_f32 v184, v184, v167
    v_min_f32 v185, v185, v167
    v_sub_f32 v185, 0, v185
    s_nop 1
    v_permlane16_swap_b32 v184, v185
    v_max_f32 v186, v184, v185
    v_mov_b32 v187, v186
    s_nop 1
    v_permlane32_swap_b32 v186, v187
    v_max_f32 v184, v186, v187
    v_mov_b32 v185, v184
    s_nop 1
    v_permlane16_swap_b32 v184, v185
    v_mul_f32 v184, s40, v184
    v_mul_f32 v185, s40, v185
    v_fma_f32 v168, v160, s40, -v184
    v_fma_f32 v176, -v160, s40, -v185
    v_fma_f32 v169, v161, s40, -v184
    v_fma_f32 v177, -v161, s40, -v185
    v_fma_f32 v170, v162, s40, -v184
    v_fma_f32 v178, -v162, s40, -v185
    v_fma_f32 v171, v163, s40, -v184
    v_fma_f32 v179, -v163, s40, -v185
    v_fma_f32 v172, v164, s40, -v184
    v_fma_f32 v180, -v164, s40, -v185
    v_fma_f32 v173, v165, s40, -v184
    v_fma_f32 v181, -v165, s40, -v185
    v_fma_f32 v174, v166, s40, -v184
    v_fma_f32 v182, -v166, s40, -v185
    v_fma_f32 v175, v167, s40, -v184
    v_fma_f32 v183, -v167, s40, -v185
    v_exp_f32 v168, v168
    v_exp_f32 v176, v176
    v_exp_f32 v169, v169
    v_exp_f32 v177, v177
    v_exp_f32 v170, v170
    v_exp_f32 v178, v178
    v_exp_f32 v171, v171
    v_exp_f32 v179, v179
    v_exp_f32 v172, v172
    v_exp_f32 v180, v180
    v_exp_f32 v173, v173
    v_exp_f32 v181, v181
    v_exp_f32 v174, v174
    v_exp_f32 v182, v182
    v_exp_f32 v175, v175
    v_exp_f32 v183, v183
    s_nop 0
    v_add_f32 v188, v168, v169
    v_add_f32 v189, v176, v177
    v_add_f32 v188, v188, v170
    v_add_f32 v189, v189, v178
    v_add_f32 v188, v188, v171
    v_add_f32 v189, v189, v179
    v_add_f32 v188, v188, v172
    v_add_f32 v189, v189, v180
    v_add_f32 v188, v188, v173
    v_add_f32 v189, v189, v181
    v_add_f32 v188, v188, v174
    v_add_f32 v189, v189, v182
    v_add_f32 v188, v188, v175
    v_add_f32 v189, v189, v183
    s_nop 1
    v_permlane16_swap_b32 v188, v189
    v_add_f32 v186, v188, v189
    v_mov_b32 v187, v186
    s_nop 1
    v_permlane32_swap_b32 v186, v187
    v_add_f32 v188, v186, v187
    v_mov_b32 v189, v188
    s_nop 1
    v_permlane16_swap_b32 v188, v189
    v_rcp_f32 v188, v188
    v_rcp_f32 v189, v189
    s_nop 0
    v_mul_f32 v168, v168, v188
    v_mul_f32 v176, v176, v189
    v_mul_f32 v169, v169, v188
    v_mul_f32 v177, v177, v189
    v_mul_f32 v170, v170, v188
    v_mul_f32 v178, v178, v189
    v_mul_f32 v171, v171, v188
    v_mul_f32 v179, v179, v189
    v_mul_f32 v172, v172, v188
    v_mul_f32 v180, v180, v189
    v_mul_f32 v173, v173, v188
    v_mul_f32 v181, v181, v189
    v_mul_f32 v174, v174, v188
    v_mul_f32 v182, v182, v189
    v_mul_f32 v175, v175, v188
    v_mul_f32 v183, v183, v189
    v_cvt_pk_bf16_f32 v136, v168, v169
    v_cvt_pk_bf16_f32 v140, v176, v177
    v_cvt_pk_bf16_f32 v137, v170, v171
    v_cvt_pk_bf16_f32 v141, v178, v179
    v_cvt_pk_bf16_f32 v138, v172, v173
    v_cvt_pk_bf16_f32 v142, v180, v181
    v_cvt_pk_bf16_f32 v139, v174, v175
    v_cvt_pk_bf16_f32 v143, v182, v183
    v_mfma_f32_16x16x32_bf16 v[152:155], v[224:227], v[204:207], 0
    v_mfma_f32_16x16x32_bf16 v[156:159], v[228:231], v[204:207], 0
    s_nop 8
    v_cvt_pk_bf16_f32 v160, 0, v152
    v_cvt_pk_bf16_f32 v161, 0, v153
    v_cvt_pk_bf16_f32 v162, 0, v154
    v_cvt_pk_bf16_f32 v163, 0, v155
    v_cvt_pk_bf16_f32 v164, 0, v156
    v_cvt_pk_bf16_f32 v165, 0, v157
    v_cvt_pk_bf16_f32 v166, 0, v158
    v_cvt_pk_bf16_f32 v167, 0, v159
    v_max3_f32 v184, v160, v161, v162
    v_min3_f32 v185, v160, v161, v162
    v_max3_f32 v184, v184, v163, v164
    v_min3_f32 v185, v185, v163, v164
    v_max3_f32 v184, v184, v165, v166
    v_min3_f32 v185, v185, v165, v166
    v_max_f32 v184, v184, v167
    v_min_f32 v185, v185, v167
    v_sub_f32 v185, 0, v185
    s_nop 1
    v_permlane16_swap_b32 v184, v185
    v_max_f32 v186, v184, v185
    v_mov_b32 v187, v186
    s_nop 1
    v_permlane32_swap_b32 v186, v187
    v_max_f32 v184, v186, v187
    v_mov_b32 v185, v184
    s_nop 1
    v_permlane16_swap_b32 v184, v185
    v_mul_f32 v184, s40, v184
    v_mul_f32 v185, s40, v185
    v_fma_f32 v168, v160, s40, -v184
    v_fma_f32 v176, -v160, s40, -v185
    v_fma_f32 v169, v161, s40, -v184
    v_fma_f32 v177, -v161, s40, -v185
    v_fma_f32 v170, v162, s40, -v184
    v_fma_f32 v178, -v162, s40, -v185
    v_fma_f32 v171, v163, s40, -v184
    v_fma_f32 v179, -v163, s40, -v185
    v_fma_f32 v172, v164, s40, -v184
    v_fma_f32 v180, -v164, s40, -v185
    v_fma_f32 v173, v165, s40, -v184
    v_fma_f32 v181, -v165, s40, -v185
    v_fma_f32 v174, v166, s40, -v184
    v_fma_f32 v182, -v166, s40, -v185
    v_fma_f32 v175, v167, s40, -v184
    v_fma_f32 v183, -v167, s40, -v185
    v_exp_f32 v168, v168
    v_exp_f32 v176, v176
    v_exp_f32 v169, v169
    v_exp_f32 v177, v177
    v_exp_f32 v170, v170
    v_exp_f32 v178, v178
    v_exp_f32 v171, v171
    v_exp_f32 v179, v179
    v_exp_f32 v172, v172
    v_exp_f32 v180, v180
    v_exp_f32 v173, v173
    v_exp_f32 v181, v181
    v_exp_f32 v174, v174
    v_exp_f32 v182, v182
    v_exp_f32 v175, v175
    v_exp_f32 v183, v183
    s_nop 0
    v_add_f32 v188, v168, v169
    v_add_f32 v189, v176, v177
    v_add_f32 v188, v188, v170
    v_add_f32 v189, v189, v178
    v_add_f32 v188, v188, v171
    v_add_f32 v189, v189, v179
    v_add_f32 v188, v188, v172
    v_add_f32 v189, v189, v180
    v_add_f32 v188, v188, v173
    v_add_f32 v189, v189, v181
    v_add_f32 v188, v188, v174
    v_add_f32 v189, v189, v182
    v_add_f32 v188, v188, v175
    v_add_f32 v189, v189, v183
    s_nop 1
    v_permlane16_swap_b32 v188, v189
    v_add_f32 v186, v188, v189
    v_mov_b32 v187, v186
    s_nop 1
    v_permlane32_swap_b32 v186, v187
    v_add_f32 v188, v186, v187
    v_mov_b32 v189, v188
    s_nop 1
    v_permlane16_swap_b32 v188, v189
    v_rcp_f32 v188, v188
    v_rcp_f32 v189, v189
    s_nop 0
    v_mul_f32 v168, v168, v188
    v_mul_f32 v176, v176, v189
    v_mul_f32 v169, v169, v188
    v_mul_f32 v177, v177, v189
    v_mul_f32 v170, v170, v188
    v_mul_f32 v178, v178, v189
    v_mul_f32 v171, v171, v188
    v_mul_f32 v179, v179, v189
    v_mul_f32 v172, v172, v188
    v_mul_f32 v180, v180, v189
    v_mul_f32 v173, v173, v188
    v_mul_f32 v181, v181, v189
    v_mul_f32 v174, v174, v188
    v_mul_f32 v182, v182, v189
    v_mul_f32 v175, v175, v188
    v_mul_f32 v183, v183, v189
    v_cvt_pk_bf16_f32 v144, v168, v169
    v_cvt_pk_bf16_f32 v148, v176, v177
    v_cvt_pk_bf16_f32 v145, v170, v171
    v_cvt_pk_bf16_f32 v149, v178, v179
    v_cvt_pk_bf16_f32 v146, v172, v173
    v_cvt_pk_bf16_f32 v150, v180, v181
    v_cvt_pk_bf16_f32 v147, v174, v175
    v_cvt_pk_bf16_f32 v151, v182, v183
    s_waitcnt vmcnt(24)
    v_add_f32 v232, v0, v12
    v_add_f32 v233, v1, v13
    v_add_f32 v234, v2, v14
    v_add_f32 v235, v3, v15
    v_add_f32 v236, v4, v16
    v_add_f32 v237, v5, v17
    v_add_f32 v238, v6, v18
    v_add_f32 v239, v7, v19
    v_add_f32 v240, v8, v20
    v_add_f32 v241, v9, v21
    v_add_f32 v242, v10, v22
    v_add_f32 v243, v11, v23
    s_nop 0
    buffer_load_dwordx4 v[0:3], v245, s[4:7], s36 offen
    buffer_load_dwordx4 v[4:7], v245, s[4:7], s36 offen offset:1024
    buffer_load_dwordx4 v[8:11], v246, s[4:7], s36 offen
    s_add_u32 s36, s36, 8448
    s_nop 0
    buffer_load_dwordx4 v[12:15], v245, s[4:7], s36 offen
    buffer_load_dwordx4 v[16:19], v245, s[4:7], s36 offen offset:1024
    buffer_load_dwordx4 v[20:23], v246, s[4:7], s36 offen
    s_add_u32 s36, s36, 8448
    s_waitcnt vmcnt(27)
    v_add_f32 v232, v232, v24
    v_add_f32 v233, v233, v25
    v_add_f32 v234, v234, v26
    v_add_f32 v235, v235, v27
    v_add_f32 v236, v236, v28
    v_add_f32 v237, v237, v29
    v_add_f32 v238, v238, v30
    v_add_f32 v239, v239, v31
    v_add_f32 v240, v240, v32
    v_add_f32 v241, v241, v33
    v_add_f32 v242, v242, v34
    v_add_f32 v243, v243, v35
    s_nop 0
    buffer_load_dwordx4 v[24:27], v245, s[4:7], s36 offen
    buffer_load_dwordx4 v[28:31], v245, s[4:7], s36 offen offset:1024
    buffer_load_dwordx4 v[32:35], v246, s[4:7], s36 offen
    s_add_u32 s36, s36, 8448
    s_waitcnt vmcnt(27)
    v_add_f32 v232, v232, v36
    v_add_f32 v233, v233, v37
    v_add_f32 v234, v234, v38
    v_add_f32 v235, v235, v39
    v_add_f32 v236, v236, v40
    v_add_f32 v237, v237, v41
    v_add_f32 v238, v238, v42
    v_add_f32 v239, v239, v43
    v_add_f32 v240, v240, v44
    v_add_f32 v241, v241, v45
    v_add_f32 v242, v242, v46
    v_add_f32 v243, v243, v47
    s_nop 0
    buffer_load_dwordx4 v[36:39], v245, s[4:7], s36 offen
    buffer_load_dwordx4 v[40:43], v245, s[4:7], s36 offen offset:1024
    buffer_load_dwordx4 v[44:47], v246, s[4:7], s36 offen
    s_add_u32 s36, s36, 8448
    s_waitcnt vmcnt(27)
    v_add_f32 v232, v232, v48
    v_add_f32 v233, v233, v49
    v_add_f32 v234, v234, v50
    v_add_f32 v235, v235, v51
    v_add_f32 v236, v236, v52
    v_add_f32 v237, v237, v53
    v_add_f32 v238, v238, v54
    v_add_f32 v239, v239, v55
    v_add_f32 v240, v240, v56
    v_add_f32 v241, v241, v57
    v_add_f32 v242, v242, v58
    v_add_f32 v243, v243, v59
    s_nop 0
    buffer_load_dwordx4 v[48:51], v245, s[4:7], s36 offen
    buffer_load_dwordx4 v[52:55], v245, s[4:7], s36 offen offset:1024
    buffer_load_dwordx4 v[56:59], v246, s[4:7], s36 offen
    s_add_u32 s36, s36, 8448
    s_waitcnt vmcnt(27)
    v_add_f32 v232, v232, v60
    v_add_f32 v233, v233, v61
    v_add_f32 v234, v234, v62
    v_add_f32 v235, v235, v63
    v_add_f32 v236, v236, v64
    v_add_f32 v237, v237, v65
    v_add_f32 v238, v238, v66
    v_add_f32 v239, v239, v67
    v_add_f32 v240, v240, v68
    v_add_f32 v241, v241, v69
    v_add_f32 v242, v242, v70
    v_add_f32 v243, v243, v71
    s_nop 0
    buffer_load_dwordx4 v[60:63], v245, s[4:7], s36 offen
    buffer_load_dwordx4 v[64:67], v245, s[4:7], s36 offen offset:1024
    buffer_load_dwordx4 v[68:71], v246, s[4:7], s36 offen
    s_add_u32 s36, s36, 8448
    s_waitcnt vmcnt(27)
    v_add_f32 v232, v232, v72
    v_add_f32 v233, v233, v73
    v_add_f32 v234, v234, v74
    v_add_f32 v235, v235, v75
    v_add_f32 v236, v236, v76
    v_add_f32 v237, v237, v77
    v_add_f32 v238, v238, v78
    v_add_f32 v239, v239, v79
    v_add_f32 v240, v240, v80
    v_add_f32 v241, v241, v81
    v_add_f32 v242, v242, v82
    v_add_f32 v243, v243, v83
    s_waitcnt vmcnt(24)
    v_add_f32 v232, v232, v84
    v_add_f32 v233, v233, v85
    v_add_f32 v234, v234, v86
    v_add_f32 v235, v235, v87
    v_add_f32 v236, v236, v88
    v_add_f32 v237, v237, v89
    v_add_f32 v238, v238, v90
    v_add_f32 v239, v239, v91
    v_add_f32 v240, v240, v92
    v_add_f32 v241, v241, v93
    v_add_f32 v242, v242, v94
    v_add_f32 v243, v243, v95
    s_waitcnt vmcnt(21)
    v_add_f32 v232, v232, v96
    v_add_f32 v233, v233, v97
    v_add_f32 v234, v234, v98
    v_add_f32 v235, v235, v99
    v_add_f32 v236, v236, v100
    v_add_f32 v237, v237, v101
    v_add_f32 v238, v238, v102
    v_add_f32 v239, v239, v103
    v_add_f32 v240, v240, v104
    v_add_f32 v241, v241, v105
    v_add_f32 v242, v242, v106
    v_add_f32 v243, v243, v107
    s_waitcnt vmcnt(18)
    v_add_f32 v232, v232, v108
    v_add_f32 v233, v233, v109
    v_add_f32 v234, v234, v110
    v_add_f32 v235, v235, v111
    v_add_f32 v236, v236, v112
    v_add_f32 v237, v237, v113
    v_add_f32 v238, v238, v114
    v_add_f32 v239, v239, v115
    v_add_f32 v240, v240, v116
    v_add_f32 v241, v241, v117
    v_add_f32 v242, v242, v118
    v_add_f32 v243, v243, v119
    s_waitcnt vmcnt(15)
    v_add_f32 v232, v232, v0
    v_add_f32 v233, v233, v1
    v_add_f32 v234, v234, v2
    v_add_f32 v235, v235, v3
    v_add_f32 v236, v236, v4
    v_add_f32 v237, v237, v5
    v_add_f32 v238, v238, v6
    v_add_f32 v239, v239, v7
    v_add_f32 v240, v240, v8
    v_add_f32 v241, v241, v9
    v_add_f32 v242, v242, v10
    v_add_f32 v243, v243, v11
    s_waitcnt vmcnt(12)
    v_add_f32 v232, v232, v12
    v_add_f32 v233, v233, v13
    v_add_f32 v234, v234, v14
    v_add_f32 v235, v235, v15
    v_add_f32 v236, v236, v16
    v_add_f32 v237, v237, v17
    v_add_f32 v238, v238, v18
    v_add_f32 v239, v239, v19
    v_add_f32 v240, v240, v20
    v_add_f32 v241, v241, v21
    v_add_f32 v242, v242, v22
    v_add_f32 v243, v243, v23
    s_waitcnt vmcnt(9)
    v_add_f32 v232, v232, v24
    v_add_f32 v233, v233, v25
    v_add_f32 v234, v234, v26
    v_add_f32 v235, v235, v27
    v_add_f32 v236, v236, v28
    v_add_f32 v237, v237, v29
    v_add_f32 v238, v238, v30
    v_add_f32 v239, v239, v31
    v_add_f32 v240, v240, v32
    v_add_f32 v241, v241, v33
    v_add_f32 v242, v242, v34
    v_add_f32 v243, v243, v35
    s_waitcnt vmcnt(6)
    v_add_f32 v232, v232, v36
    v_add_f32 v233, v233, v37
    v_add_f32 v234, v234, v38
    v_add_f32 v235, v235, v39
    v_add_f32 v236, v236, v40
    v_add_f32 v237, v237, v41
    v_add_f32 v238, v238, v42
    v_add_f32 v239, v239, v43
    v_add_f32 v240, v240, v44
    v_add_f32 v241, v241, v45
    v_add_f32 v242, v242, v46
    v_add_f32 v243, v243, v47
    s_waitcnt vmcnt(3)
    v_add_f32 v232, v232, v48
    v_add_f32 v233, v233, v49
    v_add_f32 v234, v234, v50
    v_add_f32 v235, v235, v51
    v_add_f32 v236, v236, v52
    v_add_f32 v237, v237, v53
    v_add_f32 v238, v238, v54
    v_add_f32 v239, v239, v55
    v_add_f32 v240, v240, v56
    v_add_f32 v241, v241, v57
    v_add_f32 v242, v242, v58
    v_add_f32 v243, v243, v59
    s_waitcnt vmcnt(0)
    v_add_f32 v232, v232, v60
    v_add_f32 v233, v233, v61
    v_add_f32 v234, v234, v62
    v_add_f32 v235, v235, v63
    v_add_f32 v236, v236, v64
    v_add_f32 v237, v237, v65
    v_add_f32 v238, v238, v66
    v_add_f32 v239, v239, v67
    v_add_f32 v240, v240, v68
    v_add_f32 v241, v241, v69
    v_add_f32 v242, v242, v70
    v_add_f32 v243, v243, v71
    v_cvt_pk_bf16_f32 v0, v232, v233
    v_cvt_pk_bf16_f32 v1, v234, v235
    v_cvt_pk_bf16_f32 v2, v236, v237
    v_cvt_pk_bf16_f32 v3, v238, v239
    v_cvt_pk_bf16_f32 v4, v240, v241
    v_cvt_pk_bf16_f32 v5, v242, v243
    s_lshr_b32 s36, s39, 1
    s_lshl_b32 s36, s36, 10
    s_and_b32 s37, s39, 1
    s_lshl_b32 s37, s37, 3
    s_add_u32 s36, s36, s37
    s_add_u32 s36, s36, 110592
    v_add_u32 v247, s36, v244
    ds_write_b64 v247, v[0:1] offset:0
    ds_write_b64 v247, v[2:3] offset:2048
    ds_write_b64 v247, v[4:5] offset:4096
    v_mov_b32 v249, 116736
    v_mov_b32 v8, 1
    s_mov_b64 exec, 1
    ds_add_u32 v249, v8
    s_mov_b64 exec, -1
    s_waitcnt lgkmcnt(0)
K2_POLL:
    ds_read_b32 v8, v249
    s_waitcnt lgkmcnt(0)
    v_readfirstlane_b32 s36, v8
    s_cmp_lt_u32 s36, 4
    s_cbranch_scc1 K2_POLL
    v_add_u32 v247, 110592, v244
    ds_read_b128 v[16:19], v247 offset:0
    ds_read_b128 v[20:23], v247 offset:1024
    ds_read_b128 v[24:27], v247 offset:2048
    ds_read_b128 v[28:31], v247 offset:3072
    ds_read_b128 v[32:35], v247 offset:4096
    ds_read_b128 v[36:39], v247 offset:5120
    s_lshl_b32 s36, s34, 8
    s_lshl_b32 s37, s39, 6
    s_add_u32 s36, s36, s37
    v_and_b32 v245, 15, v250
    v_add_u32 v245, s36, v245
    v_lshlrev_b32 v245, 11, v245
    v_lshrrev_b32 v246, 4, v250
    v_lshlrev_b32 v246, 4, v246
    v_add_u32 v245, v245, v246
    s_lshl_b32 s36, s33, 6
    s_add_u32 s36, s36, 25165824
    v_add_u32 v245, s36, v245
    s_mov_b32 s37, 0x358637bd
    s_waitcnt lgkmcnt(0)
    v_mfma_f32_16x16x32_bf16 v[48:51], v[16:19], v[120:123], 0
    v_mfma_f32_16x16x32_bf16 v[48:51], v[20:23], v[124:127], v[48:51]
    v_mfma_f32_16x16x32_bf16 v[52:55], v[24:27], v[120:123], 0
    v_mfma_f32_16x16x32_bf16 v[52:55], v[28:31], v[124:127], v[52:55]
    v_mfma_f32_16x16x32_bf16 v[56:59], v[32:35], v[120:123], 0
    v_mfma_f32_16x16x32_bf16 v[56:59], v[36:39], v[124:127], v[56:59]
    v_mfma_f32_16x16x32_bf16 v[60:63], v[16:19], v[128:131], 0
    v_mfma_f32_16x16x32_bf16 v[60:63], v[20:23], v[132:135], v[60:63]
    v_mfma_f32_16x16x32_bf16 v[64:67], v[24:27], v[128:131], 0
    v_mfma_f32_16x16x32_bf16 v[64:67], v[28:31], v[132:135], v[64:67]
    v_mfma_f32_16x16x32_bf16 v[68:71], v[32:35], v[128:131], 0
    v_mfma_f32_16x16x32_bf16 v[68:71], v[36:39], v[132:135], v[68:71]
    v_mfma_f32_16x16x32_bf16 v[72:75], v[16:19], v[136:139], 0
    v_mfma_f32_16x16x32_bf16 v[72:75], v[20:23], v[140:143], v[72:75]
    v_mfma_f32_16x16x32_bf16 v[76:79], v[24:27], v[136:139], 0
    v_mfma_f32_16x16x32_bf16 v[76:79], v[28:31], v[140:143], v[76:79]
    v_mfma_f32_16x16x32_bf16 v[80:83], v[32:35], v[136:139], 0
    v_mfma_f32_16x16x32_bf16 v[80:83], v[36:39], v[140:143], v[80:83]
    v_mfma_f32_16x16x32_bf16 v[84:87], v[16:19], v[144:147], 0
    v_mfma_f32_16x16x32_bf16 v[84:87], v[20:23], v[148:151], v[84:87]
    v_mfma_f32_16x16x32_bf16 v[88:91], v[24:27], v[144:147], 0
    v_mfma_f32_16x16x32_bf16 v[88:91], v[28:31], v[148:151], v[88:91]
    v_mfma_f32_16x16x32_bf16 v[92:95], v[32:35], v[144:147], 0
    v_mfma_f32_16x16x32_bf16 v[92:95], v[36:39], v[148:151], v[92:95]
    s_nop 8
    v_cvt_pk_bf16_f32 v56, 0, v56
    v_add_f32 v56, s37, v56
    v_cvt_pk_bf16_f32 v56, 0, v56
    v_rcp_f32 v56, v56
    v_cvt_pk_bf16_f32 v48, 0, v48
    v_cvt_pk_bf16_f32 v49, 0, v49
    v_cvt_pk_bf16_f32 v50, 0, v50
    v_cvt_pk_bf16_f32 v51, 0, v51
    v_cvt_pk_bf16_f32 v52, 0, v52
    v_cvt_pk_bf16_f32 v53, 0, v53
    v_cvt_pk_bf16_f32 v54, 0, v54
    v_cvt_pk_bf16_f32 v55, 0, v55
    v_mul_f32 v48, v48, v56
    v_mul_f32 v49, v49, v56
    v_mul_f32 v50, v50, v56
    v_mul_f32 v51, v51, v56
    v_mul_f32 v52, v52, v56
    v_mul_f32 v53, v53, v56
    v_mul_f32 v54, v54, v56
    v_mul_f32 v55, v55, v56
    v_cvt_pk_bf16_f32 v96, v48, v49
    v_cvt_pk_bf16_f32 v97, v50, v51
    v_cvt_pk_bf16_f32 v98, v52, v53
    v_cvt_pk_bf16_f32 v99, v54, v55
    buffer_store_dwordx4 v[96:99], v245, s[4:7], 0 offen
    v_add_u32 v245, 32768, v245
    v_cvt_pk_bf16_f32 v68, 0, v68
    v_add_f32 v68, s37, v68
    v_cvt_pk_bf16_f32 v68, 0, v68
    v_rcp_f32 v68, v68
    v_cvt_pk_bf16_f32 v60, 0, v60
    v_cvt_pk_bf16_f32 v61, 0, v61
    v_cvt_pk_bf16_f32 v62, 0, v62
    v_cvt_pk_bf16_f32 v63, 0, v63
    v_cvt_pk_bf16_f32 v64, 0, v64
    v_cvt_pk_bf16_f32 v65, 0, v65
    v_cvt_pk_bf16_f32 v66, 0, v66
    v_cvt_pk_bf16_f32 v67, 0, v67
    v_mul_f32 v60, v60, v68
    v_mul_f32 v61, v61, v68
    v_mul_f32 v62, v62, v68
    v_mul_f32 v63, v63, v68
    v_mul_f32 v64, v64, v68
    v_mul_f32 v65, v65, v68
    v_mul_f32 v66, v66, v68
    v_mul_f32 v67, v67, v68
    v_cvt_pk_bf16_f32 v100, v60, v61
    v_cvt_pk_bf16_f32 v101, v62, v63
    v_cvt_pk_bf16_f32 v102, v64, v65
    v_cvt_pk_bf16_f32 v103, v66, v67
    buffer_store_dwordx4 v[100:103], v245, s[4:7], 0 offen
    v_add_u32 v245, 32768, v245
    v_cvt_pk_bf16_f32 v80, 0, v80
    v_add_f32 v80, s37, v80
    v_cvt_pk_bf16_f32 v80, 0, v80
    v_rcp_f32 v80, v80
    v_cvt_pk_bf16_f32 v72, 0, v72
    v_cvt_pk_bf16_f32 v73, 0, v73
    v_cvt_pk_bf16_f32 v74, 0, v74
    v_cvt_pk_bf16_f32 v75, 0, v75
    v_cvt_pk_bf16_f32 v76, 0, v76
    v_cvt_pk_bf16_f32 v77, 0, v77
    v_cvt_pk_bf16_f32 v78, 0, v78
    v_cvt_pk_bf16_f32 v79, 0, v79
    v_mul_f32 v72, v72, v80
    v_mul_f32 v73, v73, v80
    v_mul_f32 v74, v74, v80
    v_mul_f32 v75, v75, v80
    v_mul_f32 v76, v76, v80
    v_mul_f32 v77, v77, v80
    v_mul_f32 v78, v78, v80
    v_mul_f32 v79, v79, v80
    v_cvt_pk_bf16_f32 v104, v72, v73
    v_cvt_pk_bf16_f32 v105, v74, v75
    v_cvt_pk_bf16_f32 v106, v76, v77
    v_cvt_pk_bf16_f32 v107, v78, v79
    buffer_store_dwordx4 v[104:107], v245, s[4:7], 0 offen
    v_add_u32 v245, 32768, v245
    v_cvt_pk_bf16_f32 v92, 0, v92
    v_add_f32 v92, s37, v92
    v_cvt_pk_bf16_f32 v92, 0, v92
    v_rcp_f32 v92, v92
    v_cvt_pk_bf16_f32 v84, 0, v84
    v_cvt_pk_bf16_f32 v85, 0, v85
    v_cvt_pk_bf16_f32 v86, 0, v86
    v_cvt_pk_bf16_f32 v87, 0, v87
    v_cvt_pk_bf16_f32 v88, 0, v88
    v_cvt_pk_bf16_f32 v89, 0, v89
    v_cvt_pk_bf16_f32 v90, 0, v90
    v_cvt_pk_bf16_f32 v91, 0, v91
    v_mul_f32 v84, v84, v92
    v_mul_f32 v85, v85, v92
    v_mul_f32 v86, v86, v92
    v_mul_f32 v87, v87, v92
    v_mul_f32 v88, v88, v92
    v_mul_f32 v89, v89, v92
    v_mul_f32 v90, v90, v92
    v_mul_f32 v91, v91, v92
    v_cvt_pk_bf16_f32 v108, v84, v85
    v_cvt_pk_bf16_f32 v109, v86, v87
    v_cvt_pk_bf16_f32 v110, v88, v89
    v_cvt_pk_bf16_f32 v111, v90, v91
    buffer_store_dwordx4 v[108:111], v245, s[4:7], 0 offen
K2_END:
    s_endpgm
.globl k3_kernel
.p2align 8
.type k3_kernel,@function
k3_kernel:
    s_cmp_ge_u32 s2, 256
    s_cbranch_scc1 K3_END
    s_load_dwordx2 s[60:61], s[0:1], 96
    s_load_dwordx4 s[64:67], s[0:1], 72
    s_load_dwordx2 s[68:69], s[0:1], 0
    v_and_b32 v91, 255, v0
    v_and_b32 v90, 63, v0
    v_lshrrev_b32 v92, 6, v0
    s_nop 0
    v_readfirstlane_b32 s32, v92
    s_and_b32 s35, s2, 3
    s_lshl_b32 s35, s35, 2
    s_bfe_u32 s41, s2, 0x20003
    s_add_u32 s35, s35, s41
    s_bfe_u32 s36, s2, 0x10002
    s_lshl_b32 s36, s36, 3
    s_lshr_b32 s41, s2, 5
    s_add_u32 s36, s36, s41
    s_and_b32 s43, s32, 3
    s_waitcnt lgkmcnt(0)
    s_mov_b32 s12, s66
    s_and_b32 s13, s67, 0xffff
    s_mov_b32 s14, 8388608
    s_mov_b32 s15, 0x00020000
    s_cmp_ge_u32 s32, 4
    s_cbranch_scc1 K3_AUX
    s_lshr_b32 s33, s32, 1
    s_and_b32 s34, s32, 1
    v_and_b32 v92, 15, v90
    v_lshrrev_b32 v93, 4, v90
    v_lshrrev_b32 v94, 1, v92
    v_xor_b32 v94, v94, v93
    v_lshlrev_b32 v94, 4, v94
    s_lshl_b32 s41, s33, 6
    v_add_u32 v95, s41, v92
    v_lshlrev_b32 v95, 7, v95
    v_add_u32 v86, v95, v94
    v_xor_b32 v87, 64, v86
    v_bfe_u32 v92, v90, 2, 2
    v_lshrrev_b32 v94, 1, v92
    v_and_b32 v95, 1, v93
    v_lshlrev_b32 v95, 1, v95
    v_or_b32 v94, v94, v95
    v_bfe_u32 v95, v90, 1, 1
    s_lshl_b32 s41, s34, 1
    v_add_u32 v95, s41, v95
    v_xor_b32 v94, v94, v95
    v_lshlrev_b32 v94, 5, v94
    v_lshlrev_b32 v95, 2, v93
    v_add_u32 v95, v95, v92
    v_lshlrev_b32 v95, 7, v95
    v_add_u32 v94, v94, v95
    v_and_b32 v95, 1, v90
    v_lshlrev_b32 v95, 4, v95
    v_add_u32 v94, v94, v95
    v_add_u32 v88, 65536, v94
    s_mov_b32 s4, s60
    s_and_b32 s5, s61, 0xffff
    s_mov_b32 s6, 268435456
    s_mov_b32 s7, 0x00020000
    s_mov_b32 s8, s64
    s_and_b32 s9, s65, 0xffff
    s_mov_b32 s10, 2097152
    s_mov_b32 s11, 0x00020000
    s_mov_b32 s16, s68
    s_and_b32 s17, s69, 0xffff
    s_mov_b32 s18, 4194304
    s_mov_b32 s19, 0x00020000
    s_barrier
    ds_read_b128 v[32:35], v86 offset:0
    ds_read_b128 v[36:39], v86 offset:2048
    ds_read_b128 v[40:43], v86 offset:4096
    ds_read_b128 v[44:47], v86 offset:6144
    ds_read_b64_tr_b16 v[48:49], v88 offset:0
    ds_read_b64_tr_b16 v[50:51], v88 offset:2048
    ds_read_b64_tr_b16 v[52:53], v88 offset:8
    ds_read_b64_tr_b16 v[54:55], v88 offset:2056
    s_waitcnt lgkmcnt(0)
    v_mfma_f32_16x16x32_bf16 v[0:3], v[48:51], v[32:35], 0
    ds_read_b128 v[56:59], v87 offset:0
    ds_read_b128 v[60:63], v87 offset:2048
    ds_read_b128 v[64:67], v87 offset:4096
    v_mfma_f32_16x16x32_bf16 v[4:7], v[52:55], v[32:35], 0
    ds_read_b128 v[68:71], v87 offset:6144
    v_mfma_f32_16x16x32_bf16 v[8:11], v[48:51], v[36:39], 0
    ds_read_b64_tr_b16 v[72:73], v88 offset:4096
    v_mfma_f32_16x16x32_bf16 v[12:15], v[52:55], v[36:39], 0
    ds_read_b64_tr_b16 v[74:75], v88 offset:6144
    v_mfma_f32_16x16x32_bf16 v[16:19], v[48:51], v[40:43], 0
    ds_read_b64_tr_b16 v[76:77], v88 offset:4104
    v_mfma_f32_16x16x32_bf16 v[20:23], v[52:55], v[40:43], 0
    ds_read_b64_tr_b16 v[78:79], v88 offset:6152
    v_mfma_f32_16x16x32_bf16 v[24:27], v[48:51], v[44:47], 0
    v_mfma_f32_16x16x32_bf16 v[28:31], v[52:55], v[44:47], 0
    s_waitcnt lgkmcnt(0)
    s_barrier
    v_mfma_f32_16x16x32_bf16 v[0:3], v[72:75], v[56:59], v[0:3]
    ds_read_b128 v[32:35], v86 offset:16384
    ds_read_b128 v[36:39], v86 offset:18432
    ds_read_b128 v[40:43], v86 offset:20480
    ds_read_b128 v[44:47], v86 offset:22528
    v_mfma_f32_16x16x32_bf16 v[4:7], v[76:79], v[56:59], v[4:7]
    ds_read_b64_tr_b16 v[48:49], v88 offset:8192
    v_mfma_f32_16x16x32_bf16 v[8:11], v[72:75], v[60:63], v[8:11]
    ds_read_b64_tr_b16 v[50:51], v88 offset:10240
    v_mfma_f32_16x16x32_bf16 v[12:15], v[76:79], v[60:63], v[12:15]
    ds_read_b64_tr_b16 v[52:53], v88 offset:8200
    v_mfma_f32_16x16x32_bf16 v[16:19], v[72:75], v[64:67], v[16:19]
    ds_read_b64_tr_b16 v[54:55], v88 offset:10248
    v_mfma_f32_16x16x32_bf16 v[20:23], v[76:79], v[64:67], v[20:23]
    v_mfma_f32_16x16x32_bf16 v[24:27], v[72:75], v[68:71], v[24:27]
    v_mfma_f32_16x16x32_bf16 v[28:31], v[76:79], v[68:71], v[28:31]
    s_waitcnt lgkmcnt(0)
    v_mfma_f32_16x16x32_bf16 v[0:3], v[48:51], v[32:35], v[0:3]
    ds_read_b128 v[56:59], v87 offset:16384
    ds_read_b128 v[60:63], v87 offset:18432
    ds_read_b128 v[64:67], v87 offset:20480
    v_mfma_f32_16x16x32_bf16 v[4:7], v[52:55], v[32:35], v[4:7]
    ds_read_b128 v[68:71], v87 offset:22528
    v_mfma_f32_16x16x32_bf16 v[8:11], v[48:51], v[36:39], v[8:11]
    ds_read_b64_tr_b16 v[72:73], v88 offset:12288
    v_mfma_f32_16x16x32_bf16 v[12:15], v[52:55], v[36:39], v[12:15]
    ds_read_b64_tr_b16 v[74:75], v88 offset:14336
    v_mfma_f32_16x16x32_bf16 v[16:19], v[48:51], v[40:43], v[16:19]
    ds_read_b64_tr_b16 v[76:77], v88 offset:12296
    v_mfma_f32_16x16x32_bf16 v[20:23], v[52:55], v[40:43], v[20:23]
    ds_read_b64_tr_b16 v[78:79], v88 offset:14344
    v_mfma_f32_16x16x32_bf16 v[24:27], v[48:51], v[44:47], v[24:27]
    v_mfma_f32_16x16x32_bf16 v[28:31], v[52:55], v[44:47], v[28:31]
    s_waitcnt lgkmcnt(0)
    s_barrier
    v_mfma_f32_16x16x32_bf16 v[0:3], v[72:75], v[56:59], v[0:3]
    ds_read_b128 v[32:35], v86 offset:32768
    ds_read_b128 v[36:39], v86 offset:34816
    ds_read_b128 v[40:43], v86 offset:36864
    ds_read_b128 v[44:47], v86 offset:38912
    v_mfma_f32_16x16x32_bf16 v[4:7], v[76:79], v[56:59], v[4:7]
    ds_read_b64_tr_b16 v[48:49], v88 offset:16384
    v_mfma_f32_16x16x32_bf16 v[8:11], v[72:75], v[60:63], v[8:11]
    ds_read_b64_tr_b16 v[50:51], v88 offset:18432
    v_mfma_f32_16x16x32_bf16 v[12:15], v[76:79], v[60:63], v[12:15]
    ds_read_b64_tr_b16 v[52:53], v88 offset:16392
    v_mfma_f32_16x16x32_bf16 v[16:19], v[72:75], v[64:67], v[16:19]
    ds_read_b64_tr_b16 v[54:55], v88 offset:18440
    v_mfma_f32_16x16x32_bf16 v[20:23], v[76:79], v[64:67], v[20:23]
    v_mfma_f32_16x16x32_bf16 v[24:27], v[72:75], v[68:71], v[24:27]
    v_mfma_f32_16x16x32_bf16 v[28:31], v[76:79], v[68:71], v[28:31]
    s_waitcnt lgkmcnt(0)
    v_mfma_f32_16x16x32_bf16 v[0:3], v[48:51], v[32:35], v[0:3]
    ds_read_b128 v[56:59], v87 offset:32768
    ds_read_b128 v[60:63], v87 offset:34816
    ds_read_b128 v[64:67], v87 offset:36864
    v_mfma_f32_16x16x32_bf16 v[4:7], v[52:55], v[32:35], v[4:7]
    ds_read_b128 v[68:71], v87 offset:38912
    v_mfma_f32_16x16x32_bf16 v[8:11], v[48:51], v[36:39], v[8:11]
    ds_read_b64_tr_b16 v[72:73], v88 offset:20480
    v_mfma_f32_16x16x32_bf16 v[12:15], v[52:55], v[36:39], v[12:15]
    ds_read_b64_tr_b16 v[74:75], v88 offset:22528
    v_mfma_f32_16x16x32_bf16 v[16:19], v[48:51], v[40:43], v[16:19]
    ds_read_b64_tr_b16 v[76:77], v88 offset:20488
    v_mfma_f32_16x16x32_bf16 v[20:23], v[52:55], v[40:43], v[20:23]
    ds_read_b64_tr_b16 v[78:79], v88 offset:22536
    v_mfma_f32_16x16x32_bf16 v[24:27], v[48:51], v[44:47], v[24:27]
    v_mfma_f32_16x16x32_bf16 v[28:31], v[52:55], v[44:47], v[28:31]
    s_waitcnt lgkmcnt(0)
    s_barrier
    v_mfma_f32_16x16x32_bf16 v[0:3], v[72:75], v[56:59], v[0:3]
    ds_read_b128 v[32:35], v86 offset:49152
    ds_read_b128 v[36:39], v86 offset:51200
    ds_read_b128 v[40:43], v86 offset:53248
    ds_read_b128 v[44:47], v86 offset:55296
    v_mfma_f32_16x16x32_bf16 v[4:7], v[76:79], v[56:59], v[4:7]
    ds_read_b64_tr_b16 v[48:49], v88 offset:24576
    v_mfma_f32_16x16x32_bf16 v[8:11], v[72:75], v[60:63], v[8:11]
    ds_read_b64_tr_b16 v[50:51], v88 offset:26624
    v_mfma_f32_16x16x32_bf16 v[12:15], v[76:79], v[60:63], v[12:15]
    ds_read_b64_tr_b16 v[52:53], v88 offset:24584
    v_mfma_f32_16x16x32_bf16 v[16:19], v[72:75], v[64:67], v[16:19]
    ds_read_b64_tr_b16 v[54:55], v88 offset:26632
    v_mfma_f32_16x16x32_bf16 v[20:23], v[76:79], v[64:67], v[20:23]
    v_mfma_f32_16x16x32_bf16 v[24:27], v[72:75], v[68:71], v[24:27]
    v_mfma_f32_16x16x32_bf16 v[28:31], v[76:79], v[68:71], v[28:31]
    s_waitcnt lgkmcnt(0)
    v_mfma_f32_16x16x32_bf16 v[0:3], v[48:51], v[32:35], v[0:3]
    ds_read_b128 v[56:59], v87 offset:49152
    ds_read_b128 v[60:63], v87 offset:51200
    ds_read_b128 v[64:67], v87 offset:53248
    v_mfma_f32_16x16x32_bf16 v[4:7], v[52:55], v[32:35], v[4:7]
    ds_read_b128 v[68:71], v87 offset:55296
    v_mfma_f32_16x16x32_bf16 v[8:11], v[48:51], v[36:39], v[8:11]
    ds_read_b64_tr_b16 v[72:73], v88 offset:28672
    v_mfma_f32_16x16x32_bf16 v[12:15], v[52:55], v[36:39], v[12:15]
    ds_read_b64_tr_b16 v[74:75], v88 offset:30720
    v_mfma_f32_16x16x32_bf16 v[16:19], v[48:51], v[40:43], v[16:19]
    ds_read_b64_tr_b16 v[76:77], v88 offset:28680
    v_mfma_f32_16x16x32_bf16 v[20:23], v[52:55], v[40:43], v[20:23]
    ds_read_b64_tr_b16 v[78:79], v88 offset:30728
    v_mfma_f32_16x16x32_bf16 v[24:27], v[48:51], v[44:47], v[24:27]
    v_mfma_f32_16x16x32_bf16 v[28:31], v[52:55], v[44:47], v[28:31]
    s_waitcnt lgkmcnt(0)
    s_barrier
    v_mfma_f32_16x16x32_bf16 v[0:3], v[72:75], v[56:59], v[0:3]
    ds_read_b128 v[32:35], v86 offset:0
    ds_read_b128 v[36:39], v86 offset:2048
    ds_read_b128 v[40:43], v86 offset:4096
    ds_read_b128 v[44:47], v86 offset:6144
    v_mfma_f32_16x16x32_bf16 v[4:7], v[76:79], v[56:59], v[4:7]
    ds_read_b64_tr_b16 v[48:49], v88 offset:0
    v_mfma_f32_16x16x32_bf16 v[8:11], v[72:75], v[60:63], v[8:11]
    ds_read_b64_tr_b16 v[50:51], v88 offset:2048
    v_mfma_f32_16x16x32_bf16 v[12:15], v[76:79], v[60:63], v[12:15]
    ds_read_b64_tr_b16 v[52:53], v88 offset:8
    v_mfma_f32_16x16x32_bf16 v[16:19], v[72:75], v[64:67], v[16:19]
    ds_read_b64_tr_b16 v[54:55], v88 offset:2056
    v_mfma_f32_16x16x32_bf16 v[20:23], v[76:79], v[64:67], v[20:23]
    v_mfma_f32_16x16x32_bf16 v[24:27], v[72:75], v[68:71], v[24:27]
    v_mfma_f32_16x16x32_bf16 v[28:31], v[76:79], v[68:71], v[28:31]
    s_waitcnt lgkmcnt(0)
    s_lshr_b32 s41, s2, 4
    s_lshl_b32 s41, s41, 7
    s_and_b32 s42, s2, 15
    s_lshl_b32 s42, s42, 6
    v_lshrrev_b32 v148, 3, v91
    v_lshlrev_b32 v148, 2, v148
    v_add_u32 v148, s41, v148
    v_and_b32 v149, 7, v91
    v_lshlrev_b32 v149, 3, v149
    v_add_u32 v149, s42, v149
    v_lshlrev_b32 v150, 12, v149
    v_lshlrev_b32 v151, 1, v148
    v_add_u32 v150, v150, v151
    v_add_u32 v150, 29360128, v150
    buffer_load_dwordx2 v[100:101], v150, s[4:7], 0 offen
    v_add_u32 v150, 4096, v150
    buffer_load_dwordx2 v[102:103], v150, s[4:7], 0 offen
    v_add_u32 v150, 4096, v150
    buffer_load_dwordx2 v[104:105], v150, s[4:7], 0 offen
    v_add_u32 v150, 4096, v150
    buffer_load_dwordx2 v[106:107], v150, s[4:7], 0 offen
    v_add_u32 v150, 4096, v150
    buffer_load_dwordx2 v[108:109], v150, s[4:7], 0 offen
    v_add_u32 v150, 4096, v150
    buffer_load_dwordx2 v[110:111], v150, s[4:7], 0 offen
    v_add_u32 v150, 4096, v150
    buffer_load_dwordx2 v[112:113], v150, s[4:7], 0 offen
    v_add_u32 v150, 4096, v150
    buffer_load_dwordx2 v[114:115], v150, s[4:7], 0 offen
    v_lshlrev_b32 v150, 11, v148
    v_lshlrev_b32 v151, 1, v149
    v_add_u32 v150, v150, v151
    v_add_u32 v152, 4096, v150
    buffer_load_dwordx4 v[116:119], v150, s[16:19], 0 offen offset:0 nt
    buffer_load_dwordx4 v[120:123], v150, s[16:19], 0 offen offset:2048 nt
    buffer_load_dwordx4 v[124:127], v152, s[16:19], 0 offen offset:0 nt
    buffer_load_dwordx4 v[128:131], v152, s[16:19], 0 offen offset:2048 nt
    v_lshlrev_b32 v150, 12, v148
    v_add_u32 v150, v150, v151
    v_mfma_f32_16x16x32_bf16 v[0:3], v[48:51], v[32:35], v[0:3]
    ds_read_b128 v[56:59], v87 offset:0
    ds_read_b128 v[60:63], v87 offset:2048
    ds_read_b128 v[64:67], v87 offset:4096
    v_mfma_f32_16x16x32_bf16 v[4:7], v[52:55], v[32:35], v[4:7]
    ds_read_b128 v[68:71], v87 offset:6144
    v_mfma_f32_16x16x32_bf16 v[8:11], v[48:51], v[36:39], v[8:11]
    ds_read_b64_tr_b16 v[72:73], v88 offset:4096
    v_mfma_f32_16x16x32_bf16 v[12:15], v[52:55], v[36:39], v[12:15]
    ds_read_b64_tr_b16 v[74:75], v88 offset:6144
    v_mfma_f32_16x16x32_bf16 v[16:19], v[48:51], v[40:43], v[16:19]
    ds_read_b64_tr_b16 v[76:77], v88 offset:4104
    v_mfma_f32_16x16x32_bf16 v[20:23], v[52:55], v[40:43], v[20:23]
    ds_read_b64_tr_b16 v[78:79], v88 offset:6152
    v_mfma_f32_16x16x32_bf16 v[24:27], v[48:51], v[44:47], v[24:27]
    v_mfma_f32_16x16x32_bf16 v[28:31], v[52:55], v[44:47], v[28:31]
    s_waitcnt lgkmcnt(0)
    s_barrier
    v_mfma_f32_16x16x32_bf16 v[0:3], v[72:75], v[56:59], v[0:3]
    ds_read_b128 v[32:35], v86 offset:16384
    ds_read_b128 v[36:39], v86 offset:18432
    ds_read_b128 v[40:43], v86 offset:20480
    ds_read_b128 v[44:47], v86 offset:22528
    v_mfma_f32_16x16x32_bf16 v[4:7], v[76:79], v[56:59], v[4:7]
    ds_read_b64_tr_b16 v[48:49], v88 offset:8192
    v_mfma_f32_16x16x32_bf16 v[8:11], v[72:75], v[60:63], v[8:11]
    ds_read_b64_tr_b16 v[50:51], v88 offset:10240
    v_mfma_f32_16x16x32_bf16 v[12:15], v[76:79], v[60:63], v[12:15]
    ds_read_b64_tr_b16 v[52:53], v88 offset:8200
    v_mfma_f32_16x16x32_bf16 v[16:19], v[72:75], v[64:67], v[16:19]
    ds_read_b64_tr_b16 v[54:55], v88 offset:10248
    v_mfma_f32_16x16x32_bf16 v[20:23], v[76:79], v[64:67], v[20:23]
    v_mfma_f32_16x16x32_bf16 v[24:27], v[72:75], v[68:71], v[24:27]
    v_mfma_f32_16x16x32_bf16 v[28:31], v[76:79], v[68:71], v[28:31]
    s_waitcnt lgkmcnt(0)
    v_mfma_f32_16x16x32_bf16 v[0:3], v[48:51], v[32:35], v[0:3]
    ds_read_b128 v[56:59], v87 offset:16384
    ds_read_b128 v[60:63], v87 offset:18432
    ds_read_b128 v[64:67], v87 offset:20480
    v_mfma_f32_16x16x32_bf16 v[4:7], v[52:55], v[32:35], v[4:7]
    ds_read_b128 v[68:71], v87 offset:22528
    v_mfma_f32_16x16x32_bf16 v[8:11], v[48:51], v[36:39], v[8:11]
    ds_read_b64_tr_b16 v[72:73], v88 offset:12288
    v_mfma_f32_16x16x32_bf16 v[12:15], v[52:55], v[36:39], v[12:15]
    ds_read_b64_tr_b16 v[74:75], v88 offset:14336
    v_mfma_f32_16x16x32_bf16 v[16:19], v[48:51], v[40:43], v[16:19]
    ds_read_b64_tr_b16 v[76:77], v88 offset:12296
    v_mfma_f32_16x16x32_bf16 v[20:23], v[52:55], v[40:43], v[20:23]
    ds_read_b64_tr_b16 v[78:79], v88 offset:14344
    v_mfma_f32_16x16x32_bf16 v[24:27], v[48:51], v[44:47], v[24:27]
    v_mfma_f32_16x16x32_bf16 v[28:31], v[52:55], v[44:47], v[28:31]
    s_waitcnt lgkmcnt(0)
    s_barrier
    v_mfma_f32_16x16x32_bf16 v[0:3], v[72:75], v[56:59], v[0:3]
    ds_read_b128 v[32:35], v86 offset:32768
    ds_read_b128 v[36:39], v86 offset:34816
    ds_read_b128 v[40:43], v86 offset:36864
    ds_read_b128 v[44:47], v86 offset:38912
    v_mfma_f32_16x16x32_bf16 v[4:7], v[76:79], v[56:59], v[4:7]
    ds_read_b64_tr_b16 v[48:49], v88 offset:16384
    v_mfma_f32_16x16x32_bf16 v[8:11], v[72:75], v[60:63], v[8:11]
    ds_read_b64_tr_b16 v[50:51], v88 offset:18432
    v_mfma_f32_16x16x32_bf16 v[12:15], v[76:79], v[60:63], v[12:15]
    ds_read_b64_tr_b16 v[52:53], v88 offset:16392
    v_mfma_f32_16x16x32_bf16 v[16:19], v[72:75], v[64:67], v[16:19]
    ds_read_b64_tr_b16 v[54:55], v88 offset:18440
    v_mfma_f32_16x16x32_bf16 v[20:23], v[76:79], v[64:67], v[20:23]
    v_mfma_f32_16x16x32_bf16 v[24:27], v[72:75], v[68:71], v[24:27]
    v_mfma_f32_16x16x32_bf16 v[28:31], v[76:79], v[68:71], v[28:31]
    s_waitcnt lgkmcnt(0)
    v_mfma_f32_16x16x32_bf16 v[0:3], v[48:51], v[32:35], v[0:3]
    ds_read_b128 v[56:59], v87 offset:32768
    ds_read_b128 v[60:63], v87 offset:34816
    ds_read_b128 v[64:67], v87 offset:36864
    v_mfma_f32_16x16x32_bf16 v[4:7], v[52:55], v[32:35], v[4:7]
    ds_read_b128 v[68:71], v87 offset:38912
    v_mfma_f32_16x16x32_bf16 v[8:11], v[48:51], v[36:39], v[8:11]
    ds_read_b64_tr_b16 v[72:73], v88 offset:20480
    v_mfma_f32_16x16x32_bf16 v[12:15], v[52:55], v[36:39], v[12:15]
    ds_read_b64_tr_b16 v[74:75], v88 offset:22528
    v_mfma_f32_16x16x32_bf16 v[16:19], v[48:51], v[40:43], v[16:19]
    ds_read_b64_tr_b16 v[76:77], v88 offset:20488
    v_mfma_f32_16x16x32_bf16 v[20:23], v[52:55], v[40:43], v[20:23]
    ds_read_b64_tr_b16 v[78:79], v88 offset:22536
    v_mfma_f32_16x16x32_bf16 v[24:27], v[48:51], v[44:47], v[24:27]
    v_mfma_f32_16x16x32_bf16 v[28:31], v[52:55], v[44:47], v[28:31]
    s_waitcnt lgkmcnt(0)
    s_barrier
    v_mfma_f32_16x16x32_bf16 v[0:3], v[72:75], v[56:59], v[0:3]
    ds_read_b128 v[32:35], v86 offset:49152
    ds_read_b128 v[36:39], v86 offset:51200
    ds_read_b128 v[40:43], v86 offset:53248
    ds_read_b128 v[44:47], v86 offset:55296
    v_mfma_f32_16x16x32_bf16 v[4:7], v[76:79], v[56:59], v[4:7]
    ds_read_b64_tr_b16 v[48:49], v88 offset:24576
    v_mfma_f32_16x16x32_bf16 v[8:11], v[72:75], v[60:63], v[8:11]
    ds_read_b64_tr_b16 v[50:51], v88 offset:26624
    v_mfma_f32_16x16x32_bf16 v[12:15], v[76:79], v[60:63], v[12:15]
    ds_read_b64_tr_b16 v[52:53], v88 offset:24584
    v_mfma_f32_16x16x32_bf16 v[16:19], v[72:75], v[64:67], v[16:19]
    ds_read_b64_tr_b16 v[54:55], v88 offset:26632
    v_mfma_f32_16x16x32_bf16 v[20:23], v[76:79], v[64:67], v[20:23]
    v_mfma_f32_16x16x32_bf16 v[24:27], v[72:75], v[68:71], v[24:27]
    v_mfma_f32_16x16x32_bf16 v[28:31], v[76:79], v[68:71], v[28:31]
    s_waitcnt lgkmcnt(0)
    v_mfma_f32_16x16x32_bf16 v[0:3], v[48:51], v[32:35], v[0:3]
    ds_read_b128 v[56:59], v87 offset:49152
    ds_read_b128 v[60:63], v87 offset:51200
    ds_read_b128 v[64:67], v87 offset:53248
    v_mfma_f32_16x16x32_bf16 v[4:7], v[52:55], v[32:35], v[4:7]
    ds_read_b128 v[68:71], v87 offset:55296
    v_mfma_f32_16x16x32_bf16 v[8:11], v[48:51], v[36:39], v[8:11]
    ds_read_b64_tr_b16 v[72:73], v88 offset:28672
    v_mfma_f32_16x16x32_bf16 v[12:15], v[52:55], v[36:39], v[12:15]
    ds_read_b64_tr_b16 v[74:75], v88 offset:30720
    v_mfma_f32_16x16x32_bf16 v[16:19], v[48:51], v[40:43], v[16:19]
    ds_read_b64_tr_b16 v[76:77], v88 offset:28680
    v_mfma_f32_16x16x32_bf16 v[20:23], v[52:55], v[40:43], v[20:23]
    ds_read_b64_tr_b16 v[78:79], v88 offset:30728
    v_mfma_f32_16x16x32_bf16 v[24:27], v[48:51], v[44:47], v[24:27]
    v_mfma_f32_16x16x32_bf16 v[28:31], v[52:55], v[44:47], v[28:31]
    s_waitcnt lgkmcnt(0)
    s_barrier
    v_mfma_f32_16x16x32_bf16 v[0:3], v[72:75], v[56:59], v[0:3]
    ds_read_b128 v[32:35], v86 offset:0
    ds_read_b128 v[36:39], v86 offset:2048
    ds_read_b128 v[40:43], v86 offset:4096
    ds_read_b128 v[44:47], v86 offset:6144
    v_mfma_f32_16x16x32_bf16 v[4:7], v[76:79], v[56:59], v[4:7]
    ds_read_b64_tr_b16 v[48:49], v88 offset:0
    v_mfma_f32_16x16x32_bf16 v[8:11], v[72:75], v[60:63], v[8:11]
    ds_read_b64_tr_b16 v[50:51], v88 offset:2048
    v_mfma_f32_16x16x32_bf16 v[12:15], v[76:79], v[60:63], v[12:15]
    ds_read_b64_tr_b16 v[52:53], v88 offset:8
    v_mfma_f32_16x16x32_bf16 v[16:19], v[72:75], v[64:67], v[16:19]
    ds_read_b64_tr_b16 v[54:55], v88 offset:2056
    v_mfma_f32_16x16x32_bf16 v[20:23], v[76:79], v[64:67], v[20:23]
    v_mfma_f32_16x16x32_bf16 v[24:27], v[72:75], v[68:71], v[24:27]
    v_mfma_f32_16x16x32_bf16 v[28:31], v[76:79], v[68:71], v[28:31]
    s_waitcnt lgkmcnt(0)
    v_mfma_f32_16x16x32_bf16 v[0:3], v[48:51], v[32:35], v[0:3]
    ds_read_b128 v[56:59], v87 offset:0
    ds_read_b128 v[60:63], v87 offset:2048
    ds_read_b128 v[64:67], v87 offset:4096
    v_mfma_f32_16x16x32_bf16 v[4:7], v[52:55], v[32:35], v[4:7]
    ds_read_b128 v[68:71], v87 offset:6144
    v_mfma_f32_16x16x32_bf16 v[8:11], v[48:51], v[36:39], v[8:11]
    ds_read_b64_tr_b16 v[72:73], v88 offset:4096
    v_mfma_f32_16x16x32_bf16 v[12:15], v[52:55], v[36:39], v[12:15]
    ds_read_b64_tr_b16 v[74:75], v88 offset:6144
    v_mfma_f32_16x16x32_bf16 v[16:19], v[48:51], v[40:43], v[16:19]
    ds_read_b64_tr_b16 v[76:77], v88 offset:4104
    v_mfma_f32_16x16x32_bf16 v[20:23], v[52:55], v[40:43], v[20:23]
    ds_read_b64_tr_b16 v[78:79], v88 offset:6152
    v_mfma_f32_16x16x32_bf16 v[24:27], v[48:51], v[44:47], v[24:27]
    v_mfma_f32_16x16x32_bf16 v[28:31], v[52:55], v[44:47], v[28:31]
    s_waitcnt lgkmcnt(0)
    s_barrier
    v_mfma_f32_16x16x32_bf16 v[0:3], v[72:75], v[56:59], v[0:3]
    ds_read_b128 v[32:35], v86 offset:16384
    ds_read_b128 v[36:39], v86 offset:18432
    ds_read_b128 v[40:43], v86 offset:20480
    ds_read_b128 v[44:47], v86 offset:22528
    v_mfma_f32_16x16x32_bf16 v[4:7], v[76:79], v[56:59], v[4:7]
    ds_read_b64_tr_b16 v[48:49], v88 offset:8192
    v_mfma_f32_16x16x32_bf16 v[8:11], v[72:75], v[60:63], v[8:11]
    ds_read_b64_tr_b16 v[50:51], v88 offset:10240
    v_mfma_f32_16x16x32_bf16 v[12:15], v[76:79], v[60:63], v[12:15]
    ds_read_b64_tr_b16 v[52:53], v88 offset:8200
    v_mfma_f32_16x16x32_bf16 v[16:19], v[72:75], v[64:67], v[16:19]
    ds_read_b64_tr_b16 v[54:55], v88 offset:10248
    v_mfma_f32_16x16x32_bf16 v[20:23], v[76:79], v[64:67], v[20:23]
    v_mfma_f32_16x16x32_bf16 v[24:27], v[72:75], v[68:71], v[24:27]
    v_mfma_f32_16x16x32_bf16 v[28:31], v[76:79], v[68:71], v[28:31]
    s_waitcnt lgkmcnt(0)
    v_mfma_f32_16x16x32_bf16 v[0:3], v[48:51], v[32:35], v[0:3]
    ds_read_b128 v[56:59], v87 offset:16384
    ds_read_b128 v[60:63], v87 offset:18432
    ds_read_b128 v[64:67], v87 offset:20480
    v_mfma_f32_16x16x32_bf16 v[4:7], v[52:55], v[32:35], v[4:7]
    ds_read_b128 v[68:71], v87 offset:22528
    v_mfma_f32_16x16x32_bf16 v[8:11], v[48:51], v[36:39], v[8:11]
    ds_read_b64_tr_b16 v[72:73], v88 offset:12288
    v_mfma_f32_16x16x32_bf16 v[12:15], v[52:55], v[36:39], v[12:15]
    ds_read_b64_tr_b16 v[74:75], v88 offset:14336
    v_mfma_f32_16x16x32_bf16 v[16:19], v[48:51], v[40:43], v[16:19]
    ds_read_b64_tr_b16 v[76:77], v88 offset:12296
    v_mfma_f32_16x16x32_bf16 v[20:23], v[52:55], v[40:43], v[20:23]
    ds_read_b64_tr_b16 v[78:79], v88 offset:14344
    v_mfma_f32_16x16x32_bf16 v[24:27], v[48:51], v[44:47], v[24:27]
    v_mfma_f32_16x16x32_bf16 v[28:31], v[52:55], v[44:47], v[28:31]
    s_waitcnt lgkmcnt(0)
    s_barrier
    v_mfma_f32_16x16x32_bf16 v[0:3], v[72:75], v[56:59], v[0:3]
    ds_read_b128 v[32:35], v86 offset:32768
    ds_read_b128 v[36:39], v86 offset:34816
    ds_read_b128 v[40:43], v86 offset:36864
    ds_read_b128 v[44:47], v86 offset:38912
    v_mfma_f32_16x16x32_bf16 v[4:7], v[76:79], v[56:59], v[4:7]
    ds_read_b64_tr_b16 v[48:49], v88 offset:16384
    v_mfma_f32_16x16x32_bf16 v[8:11], v[72:75], v[60:63], v[8:11]
    ds_read_b64_tr_b16 v[50:51], v88 offset:18432
    v_mfma_f32_16x16x32_bf16 v[12:15], v[76:79], v[60:63], v[12:15]
    ds_read_b64_tr_b16 v[52:53], v88 offset:16392
    v_mfma_f32_16x16x32_bf16 v[16:19], v[72:75], v[64:67], v[16:19]
    ds_read_b64_tr_b16 v[54:55], v88 offset:18440
    v_mfma_f32_16x16x32_bf16 v[20:23], v[76:79], v[64:67], v[20:23]
    v_mfma_f32_16x16x32_bf16 v[24:27], v[72:75], v[68:71], v[24:27]
    v_mfma_f32_16x16x32_bf16 v[28:31], v[76:79], v[68:71], v[28:31]
    s_waitcnt lgkmcnt(0)
    v_mfma_f32_16x16x32_bf16 v[0:3], v[48:51], v[32:35], v[0:3]
    ds_read_b128 v[56:59], v87 offset:32768
    ds_read_b128 v[60:63], v87 offset:34816
    ds_read_b128 v[64:67], v87 offset:36864
    v_mfma_f32_16x16x32_bf16 v[4:7], v[52:55], v[32:35], v[4:7]
    ds_read_b128 v[68:71], v87 offset:38912
    v_mfma_f32_16x16x32_bf16 v[8:11], v[48:51], v[36:39], v[8:11]
    ds_read_b64_tr_b16 v[72:73], v88 offset:20480
    v_mfma_f32_16x16x32_bf16 v[12:15], v[52:55], v[36:39], v[12:15]
    ds_read_b64_tr_b16 v[74:75], v88 offset:22528
    v_mfma_f32_16x16x32_bf16 v[16:19], v[48:51], v[40:43], v[16:19]
    ds_read_b64_tr_b16 v[76:77], v88 offset:20488
    v_mfma_f32_16x16x32_bf16 v[20:23], v[52:55], v[40:43], v[20:23]
    ds_read_b64_tr_b16 v[78:79], v88 offset:22536
    v_mfma_f32_16x16x32_bf16 v[24:27], v[48:51], v[44:47], v[24:27]
    v_mfma_f32_16x16x32_bf16 v[28:31], v[52:55], v[44:47], v[28:31]
    s_waitcnt lgkmcnt(0)
    s_barrier
    v_mfma_f32_16x16x32_bf16 v[0:3], v[72:75], v[56:59], v[0:3]
    ds_read_b128 v[32:35], v86 offset:49152
    ds_read_b128 v[36:39], v86 offset:51200
    ds_read_b128 v[40:43], v86 offset:53248
    ds_read_b128 v[44:47], v86 offset:55296
    v_mfma_f32_16x16x32_bf16 v[4:7], v[76:79], v[56:59], v[4:7]
    ds_read_b64_tr_b16 v[48:49], v88 offset:24576
    v_mfma_f32_16x16x32_bf16 v[8:11], v[72:75], v[60:63], v[8:11]
    ds_read_b64_tr_b16 v[50:51], v88 offset:26624
    v_mfma_f32_16x16x32_bf16 v[12:15], v[76:79], v[60:63], v[12:15]
    ds_read_b64_tr_b16 v[52:53], v88 offset:24584
    v_mfma_f32_16x16x32_bf16 v[16:19], v[72:75], v[64:67], v[16:19]
    ds_read_b64_tr_b16 v[54:55], v88 offset:26632
    v_mfma_f32_16x16x32_bf16 v[20:23], v[76:79], v[64:67], v[20:23]
    v_mfma_f32_16x16x32_bf16 v[24:27], v[72:75], v[68:71], v[24:27]
    v_mfma_f32_16x16x32_bf16 v[28:31], v[76:79], v[68:71], v[28:31]
    s_waitcnt lgkmcnt(0)
    v_mfma_f32_16x16x32_bf16 v[0:3], v[48:51], v[32:35], v[0:3]
    ds_read_b128 v[56:59], v87 offset:49152
    ds_read_b128 v[60:63], v87 offset:51200
    ds_read_b128 v[64:67], v87 offset:53248
    v_mfma_f32_16x16x32_bf16 v[4:7], v[52:55], v[32:35], v[4:7]
    ds_read_b128 v[68:71], v87 offset:55296
    v_mfma_f32_16x16x32_bf16 v[8:11], v[48:51], v[36:39], v[8:11]
    ds_read_b64_tr_b16 v[72:73], v88 offset:28672
    v_mfma_f32_16x16x32_bf16 v[12:15], v[52:55], v[36:39], v[12:15]
    ds_read_b64_tr_b16 v[74:75], v88 offset:30720
    v_mfma_f32_16x16x32_bf16 v[16:19], v[48:51], v[40:43], v[16:19]
    ds_read_b64_tr_b16 v[76:77], v88 offset:28680
    v_mfma_f32_16x16x32_bf16 v[20:23], v[52:55], v[40:43], v[20:23]
    ds_read_b64_tr_b16 v[78:79], v88 offset:30728
    v_mfma_f32_16x16x32_bf16 v[24:27], v[48:51], v[44:47], v[24:27]
    v_mfma_f32_16x16x32_bf16 v[28:31], v[52:55], v[44:47], v[28:31]
    s_waitcnt lgkmcnt(0)
    s_barrier
    v_mfma_f32_16x16x32_bf16 v[0:3], v[72:75], v[56:59], v[0:3]
    ds_read_b128 v[32:35], v86 offset:0
    ds_read_b128 v[36:39], v86 offset:2048
    ds_read_b128 v[40:43], v86 offset:4096
    ds_read_b128 v[44:47], v86 offset:6144
    v_mfma_f32_16x16x32_bf16 v[4:7], v[76:79], v[56:59], v[4:7]
    ds_read_b64_tr_b16 v[48:49], v88 offset:0
    v_mfma_f32_16x16x32_bf16 v[8:11], v[72:75], v[60:63], v[8:11]
    ds_read_b64_tr_b16 v[50:51], v88 offset:2048
    v_mfma_f32_16x16x32_bf16 v[12:15], v[76:79], v[60:63], v[12:15]
    ds_read_b64_tr_b16 v[52:53], v88 offset:8
    v_mfma_f32_16x16x32_bf16 v[16:19], v[72:75], v[64:67], v[16:19]
    ds_read_b64_tr_b16 v[54:55], v88 offset:2056
    v_mfma_f32_16x16x32_bf16 v[20:23], v[76:79], v[64:67], v[20:23]
    v_mfma_f32_16x16x32_bf16 v[24:27], v[72:75], v[68:71], v[24:27]
    v_mfma_f32_16x16x32_bf16 v[28:31], v[76:79], v[68:71], v[28:31]
    s_waitcnt lgkmcnt(0)
    s_waitcnt vmcnt(0)
    v_lshlrev_b32 v156, 16, v100
    v_lshlrev_b32 v158, 16, v116
    v_mul_f32 v156, v156, v158
    v_lshlrev_b32 v157, 16, v102
    v_and_b32 v159, 0xffff0000, v116
    v_mul_f32 v157, v157, v159
    v_cvt_pk_bf16_f32 v132, v156, v157
    v_lshlrev_b32 v156, 16, v104
    v_lshlrev_b32 v158, 16, v117
    v_mul_f32 v156, v156, v158
    v_lshlrev_b32 v157, 16, v106
    v_and_b32 v159, 0xffff0000, v117
    v_mul_f32 v157, v157, v159
    v_cvt_pk_bf16_f32 v133, v156, v157
    v_lshlrev_b32 v156, 16, v108
    v_lshlrev_b32 v158, 16, v118
    v_mul_f32 v156, v156, v158
    v_lshlrev_b32 v157, 16, v110
    v_and_b32 v159, 0xffff0000, v118
    v_mul_f32 v157, v157, v159
    v_cvt_pk_bf16_f32 v134, v156, v157
    v_lshlrev_b32 v156, 16, v112
    v_lshlrev_b32 v158, 16, v119
    v_mul_f32 v156, v156, v158
    v_lshlrev_b32 v157, 16, v114
    v_and_b32 v159, 0xffff0000, v119
    v_mul_f32 v157, v157, v159
    v_cvt_pk_bf16_f32 v135, v156, v157
    v_and_b32 v156, 0xffff0000, v100
    v_lshlrev_b32 v158, 16, v120
    v_mul_f32 v156, v156, v158
    v_and_b32 v157, 0xffff0000, v102
    v_and_b32 v159, 0xffff0000, v120
    v_mul_f32 v157, v157, v159
    v_cvt_pk_bf16_f32 v136, v156, v157
    v_and_b32 v156, 0xffff0000, v104
    v_lshlrev_b32 v158, 16, v121
    v_mul_f32 v156, v156, v158
    v_and_b32 v157, 0xffff0000, v106
    v_and_b32 v159, 0xffff0000, v121
    v_mul_f32 v157, v157, v159
    v_cvt_pk_bf16_f32 v137, v156, v157
    v_and_b32 v156, 0xffff0000, v108
    v_lshlrev_b32 v158, 16, v122
    v_mul_f32 v156, v156, v158
    v_and_b32 v157, 0xffff0000, v110
    v_and_b32 v159, 0xffff0000, v122
    v_mul_f32 v157, v157, v159
    v_cvt_pk_bf16_f32 v138, v156, v157
    v_and_b32 v156, 0xffff0000, v112
    v_lshlrev_b32 v158, 16, v123
    v_mul_f32 v156, v156, v158
    v_and_b32 v157, 0xffff0000, v114
    v_and_b32 v159, 0xffff0000, v123
    v_mul_f32 v157, v157, v159
    v_cvt_pk_bf16_f32 v139, v156, v157
    v_lshlrev_b32 v156, 16, v101
    v_lshlrev_b32 v158, 16, v124
    v_mul_f32 v156, v156, v158
    v_lshlrev_b32 v157, 16, v103
    v_and_b32 v159, 0xffff0000, v124
    v_mul_f32 v157, v157, v159
    v_cvt_pk_bf16_f32 v140, v156, v157
    v_lshlrev_b32 v156, 16, v105
    v_lshlrev_b32 v158, 16, v125
    v_mul_f32 v156, v156, v158
    v_lshlrev_b32 v157, 16, v107
    v_and_b32 v159, 0xffff0000, v125
    v_mul_f32 v157, v157, v159
    v_cvt_pk_bf16_f32 v141, v156, v157
    v_lshlrev_b32 v156, 16, v109
    v_lshlrev_b32 v158, 16, v126
    v_mul_f32 v156, v156, v158
    v_lshlrev_b32 v157, 16, v111
    v_and_b32 v159, 0xffff0000, v126
    v_mul_f32 v157, v157, v159
    v_cvt_pk_bf16_f32 v142, v156, v157
    v_lshlrev_b32 v156, 16, v113
    v_lshlrev_b32 v158, 16, v127
    v_mul_f32 v156, v156, v158
    v_lshlrev_b32 v157, 16, v115
    v_and_b32 v159, 0xffff0000, v127
    v_mul_f32 v157, v157, v159
    v_cvt_pk_bf16_f32 v143, v156, v157
    v_and_b32 v156, 0xffff0000, v101
    v_lshlrev_b32 v158, 16, v128
    v_mul_f32 v156, v156, v158
    v_and_b32 v157, 0xffff0000, v103
    v_and_b32 v159, 0xffff0000, v128
    v_mul_f32 v157, v157, v159
    v_cvt_pk_bf16_f32 v144, v156, v157
    v_and_b32 v156, 0xffff0000, v105
    v_lshlrev_b32 v158, 16, v129
    v_mul_f32 v156, v156, v158
    v_and_b32 v157, 0xffff0000, v107
    v_and_b32 v159, 0xffff0000, v129
    v_mul_f32 v157, v157, v159
    v_cvt_pk_bf16_f32 v145, v156, v157
    v_and_b32 v156, 0xffff0000, v109
    v_lshlrev_b32 v158, 16, v130
    v_mul_f32 v156, v156, v158
    v_and_b32 v157, 0xffff0000, v111
    v_and_b32 v159, 0xffff0000, v130
    v_mul_f32 v157, v157, v159
    v_cvt_pk_bf16_f32 v146, v156, v157
    v_and_b32 v156, 0xffff0000, v113
    v_lshlrev_b32 v158, 16, v131
    v_mul_f32 v156, v156, v158
    v_and_b32 v157, 0xffff0000, v115
    v_and_b32 v159, 0xffff0000, v131
    v_mul_f32 v157, v157, v159
    v_cvt_pk_bf16_f32 v147, v156, v157
    buffer_store_dwordx4 v[132:135], v150, s[12:15], 0 offen nt
    v_add_u32 v150, 4096, v150
    buffer_store_dwordx4 v[136:139], v150, s[12:15], 0 offen nt
    v_add_u32 v150, 4096, v150
    buffer_store_dwordx4 v[140:143], v150, s[12:15], 0 offen nt
    v_add_u32 v150, 4096, v150
    buffer_store_dwordx4 v[144:147], v150, s[12:15], 0 offen nt
    v_mfma_f32_16x16x32_bf16 v[0:3], v[48:51], v[32:35], v[0:3]
    ds_read_b128 v[56:59], v87 offset:0
    ds_read_b128 v[60:63], v87 offset:2048
    ds_read_b128 v[64:67], v87 offset:4096
    v_mfma_f32_16x16x32_bf16 v[4:7], v[52:55], v[32:35], v[4:7]
    ds_read_b128 v[68:71], v87 offset:6144
    v_mfma_f32_16x16x32_bf16 v[8:11], v[48:51], v[36:39], v[8:11]
    ds_read_b64_tr_b16 v[72:73], v88 offset:4096
    v_mfma_f32_16x16x32_bf16 v[12:15], v[52:55], v[36:39], v[12:15]
    ds_read_b64_tr_b16 v[74:75], v88 offset:6144
    v_mfma_f32_16x16x32_bf16 v[16:19], v[48:51], v[40:43], v[16:19]
    ds_read_b64_tr_b16 v[76:77], v88 offset:4104
    v_mfma_f32_16x16x32_bf16 v[20:23], v[52:55], v[40:43], v[20:23]
    ds_read_b64_tr_b16 v[78:79], v88 offset:6152
    v_mfma_f32_16x16x32_bf16 v[24:27], v[48:51], v[44:47], v[24:27]
    v_mfma_f32_16x16x32_bf16 v[28:31], v[52:55], v[44:47], v[28:31]
    s_waitcnt lgkmcnt(0)
    s_barrier
    v_mfma_f32_16x16x32_bf16 v[0:3], v[72:75], v[56:59], v[0:3]
    ds_read_b128 v[32:35], v86 offset:16384
    ds_read_b128 v[36:39], v86 offset:18432
    ds_read_b128 v[40:43], v86 offset:20480
    ds_read_b128 v[44:47], v86 offset:22528
    v_mfma_f32_16x16x32_bf16 v[4:7], v[76:79], v[56:59], v[4:7]
    ds_read_b64_tr_b16 v[48:49], v88 offset:8192
    v_mfma_f32_16x16x32_bf16 v[8:11], v[72:75], v[60:63], v[8:11]
    ds_read_b64_tr_b16 v[50:51], v88 offset:10240
    v_mfma_f32_16x16x32_bf16 v[12:15], v[76:79], v[60:63], v[12:15]
    ds_read_b64_tr_b16 v[52:53], v88 offset:8200
    v_mfma_f32_16x16x32_bf16 v[16:19], v[72:75], v[64:67], v[16:19]
    ds_read_b64_tr_b16 v[54:55], v88 offset:10248
    v_mfma_f32_16x16x32_bf16 v[20:23], v[76:79], v[64:67], v[20:23]
    v_mfma_f32_16x16x32_bf16 v[24:27], v[72:75], v[68:71], v[24:27]
    v_mfma_f32_16x16x32_bf16 v[28:31], v[76:79], v[68:71], v[28:31]
    s_waitcnt lgkmcnt(0)
    v_mfma_f32_16x16x32_bf16 v[0:3], v[48:51], v[32:35], v[0:3]
    ds_read_b128 v[56:59], v87 offset:16384
    ds_read_b128 v[60:63], v87 offset:18432
    ds_read_b128 v[64:67], v87 offset:20480
    v_mfma_f32_16x16x32_bf16 v[4:7], v[52:55], v[32:35], v[4:7]
    ds_read_b128 v[68:71], v87 offset:22528
    v_mfma_f32_16x16x32_bf16 v[8:11], v[48:51], v[36:39], v[8:11]
    ds_read_b64_tr_b16 v[72:73], v88 offset:12288
    v_mfma_f32_16x16x32_bf16 v[12:15], v[52:55], v[36:39], v[12:15]
    ds_read_b64_tr_b16 v[74:75], v88 offset:14336
    v_mfma_f32_16x16x32_bf16 v[16:19], v[48:51], v[40:43], v[16:19]
    ds_read_b64_tr_b16 v[76:77], v88 offset:12296
    v_mfma_f32_16x16x32_bf16 v[20:23], v[52:55], v[40:43], v[20:23]
    ds_read_b64_tr_b16 v[78:79], v88 offset:14344
    v_mfma_f32_16x16x32_bf16 v[24:27], v[48:51], v[44:47], v[24:27]
    v_mfma_f32_16x16x32_bf16 v[28:31], v[52:55], v[44:47], v[28:31]
    s_waitcnt lgkmcnt(0)
    s_barrier
    v_mfma_f32_16x16x32_bf16 v[0:3], v[72:75], v[56:59], v[0:3]
    ds_read_b128 v[32:35], v86 offset:32768
    ds_read_b128 v[36:39], v86 offset:34816
    ds_read_b128 v[40:43], v86 offset:36864
    ds_read_b128 v[44:47], v86 offset:38912
    v_mfma_f32_16x16x32_bf16 v[4:7], v[76:79], v[56:59], v[4:7]
    ds_read_b64_tr_b16 v[48:49], v88 offset:16384
    v_mfma_f32_16x16x32_bf16 v[8:11], v[72:75], v[60:63], v[8:11]
    ds_read_b64_tr_b16 v[50:51], v88 offset:18432
    v_mfma_f32_16x16x32_bf16 v[12:15], v[76:79], v[60:63], v[12:15]
    ds_read_b64_tr_b16 v[52:53], v88 offset:16392
    v_mfma_f32_16x16x32_bf16 v[16:19], v[72:75], v[64:67], v[16:19]
    ds_read_b64_tr_b16 v[54:55], v88 offset:18440
    v_mfma_f32_16x16x32_bf16 v[20:23], v[76:79], v[64:67], v[20:23]
    v_mfma_f32_16x16x32_bf16 v[24:27], v[72:75], v[68:71], v[24:27]
    v_mfma_f32_16x16x32_bf16 v[28:31], v[76:79], v[68:71], v[28:31]
    s_waitcnt lgkmcnt(0)
    v_mfma_f32_16x16x32_bf16 v[0:3], v[48:51], v[32:35], v[0:3]
    ds_read_b128 v[56:59], v87 offset:32768
    ds_read_b128 v[60:63], v87 offset:34816
    ds_read_b128 v[64:67], v87 offset:36864
    v_mfma_f32_16x16x32_bf16 v[4:7], v[52:55], v[32:35], v[4:7]
    ds_read_b128 v[68:71], v87 offset:38912
    v_mfma_f32_16x16x32_bf16 v[8:11], v[48:51], v[36:39], v[8:11]
    ds_read_b64_tr_b16 v[72:73], v88 offset:20480
    v_mfma_f32_16x16x32_bf16 v[12:15], v[52:55], v[36:39], v[12:15]
    ds_read_b64_tr_b16 v[74:75], v88 offset:22528
    v_mfma_f32_16x16x32_bf16 v[16:19], v[48:51], v[40:43], v[16:19]
    ds_read_b64_tr_b16 v[76:77], v88 offset:20488
    v_mfma_f32_16x16x32_bf16 v[20:23], v[52:55], v[40:43], v[20:23]
    ds_read_b64_tr_b16 v[78:79], v88 offset:22536
    v_mfma_f32_16x16x32_bf16 v[24:27], v[48:51], v[44:47], v[24:27]
    v_mfma_f32_16x16x32_bf16 v[28:31], v[52:55], v[44:47], v[28:31]
    s_waitcnt lgkmcnt(0)
    s_barrier
    v_mfma_f32_16x16x32_bf16 v[0:3], v[72:75], v[56:59], v[0:3]
    ds_read_b128 v[32:35], v86 offset:49152
    ds_read_b128 v[36:39], v86 offset:51200
    ds_read_b128 v[40:43], v86 offset:53248
    ds_read_b128 v[44:47], v86 offset:55296
    v_mfma_f32_16x16x32_bf16 v[4:7], v[76:79], v[56:59], v[4:7]
    ds_read_b64_tr_b16 v[48:49], v88 offset:24576
    v_mfma_f32_16x16x32_bf16 v[8:11], v[72:75], v[60:63], v[8:11]
    ds_read_b64_tr_b16 v[50:51], v88 offset:26624
    v_mfma_f32_16x16x32_bf16 v[12:15], v[76:79], v[60:63], v[12:15]
    ds_read_b64_tr_b16 v[52:53], v88 offset:24584
    v_mfma_f32_16x16x32_bf16 v[16:19], v[72:75], v[64:67], v[16:19]
    ds_read_b64_tr_b16 v[54:55], v88 offset:26632
    v_mfma_f32_16x16x32_bf16 v[20:23], v[76:79], v[64:67], v[20:23]
    v_mfma_f32_16x16x32_bf16 v[24:27], v[72:75], v[68:71], v[24:27]
    v_mfma_f32_16x16x32_bf16 v[28:31], v[76:79], v[68:71], v[28:31]
    s_waitcnt lgkmcnt(0)
    v_mfma_f32_16x16x32_bf16 v[0:3], v[48:51], v[32:35], v[0:3]
    ds_read_b128 v[56:59], v87 offset:49152
    ds_read_b128 v[60:63], v87 offset:51200
    ds_read_b128 v[64:67], v87 offset:53248
    v_mfma_f32_16x16x32_bf16 v[4:7], v[52:55], v[32:35], v[4:7]
    ds_read_b128 v[68:71], v87 offset:55296
    v_mfma_f32_16x16x32_bf16 v[8:11], v[48:51], v[36:39], v[8:11]
    ds_read_b64_tr_b16 v[72:73], v88 offset:28672
    v_mfma_f32_16x16x32_bf16 v[12:15], v[52:55], v[36:39], v[12:15]
    ds_read_b64_tr_b16 v[74:75], v88 offset:30720
    v_mfma_f32_16x16x32_bf16 v[16:19], v[48:51], v[40:43], v[16:19]
    ds_read_b64_tr_b16 v[76:77], v88 offset:28680
    v_mfma_f32_16x16x32_bf16 v[20:23], v[52:55], v[40:43], v[20:23]
    ds_read_b64_tr_b16 v[78:79], v88 offset:30728
    v_mfma_f32_16x16x32_bf16 v[24:27], v[48:51], v[44:47], v[24:27]
    v_mfma_f32_16x16x32_bf16 v[28:31], v[52:55], v[44:47], v[28:31]
    s_waitcnt lgkmcnt(0)
    v_mfma_f32_16x16x32_bf16 v[0:3], v[72:75], v[56:59], v[0:3]
    v_mfma_f32_16x16x32_bf16 v[4:7], v[76:79], v[56:59], v[4:7]
    v_mfma_f32_16x16x32_bf16 v[8:11], v[72:75], v[60:63], v[8:11]
    v_mfma_f32_16x16x32_bf16 v[12:15], v[76:79], v[60:63], v[12:15]
    v_mfma_f32_16x16x32_bf16 v[16:19], v[72:75], v[64:67], v[16:19]
    v_mfma_f32_16x16x32_bf16 v[20:23], v[76:79], v[64:67], v[20:23]
    v_mfma_f32_16x16x32_bf16 v[24:27], v[72:75], v[68:71], v[24:27]
    v_mfma_f32_16x16x32_bf16 v[28:31], v[76:79], v[68:71], v[28:31]
    s_waitcnt lgkmcnt(0)
    s_nop 8
    s_lshl_b32 s41, s35, 7
    s_lshl_b32 s42, s33, 6
    s_add_u32 s41, s41, s42
    v_and_b32 v92, 15, v90
    v_add_u32 v92, s41, v92
    v_lshlrev_b32 v92, 12, v92
    v_lshrrev_b32 v93, 4, v90
    v_lshlrev_b32 v93, 4, v93
    v_add_u32 v92, v92, v93
    s_lshl_b32 s41, s36, 7
    s_lshl_b32 s42, s34, 6
    s_add_u32 s41, s41, s42
    s_add_u32 s41, s41, 2048
    v_add_u32 v92, s41, v92
    v_cvt_pk_bf16_f32 v32, v0, v1
    v_cvt_pk_bf16_f32 v33, v2, v3
    v_cvt_pk_bf16_f32 v34, v4, v5
    v_cvt_pk_bf16_f32 v35, v6, v7
    v_cvt_pk_bf16_f32 v36, v8, v9
    v_cvt_pk_bf16_f32 v37, v10, v11
    v_cvt_pk_bf16_f32 v38, v12, v13
    v_cvt_pk_bf16_f32 v39, v14, v15
    v_cvt_pk_bf16_f32 v40, v16, v17
    v_cvt_pk_bf16_f32 v41, v18, v19
    v_cvt_pk_bf16_f32 v42, v20, v21
    v_cvt_pk_bf16_f32 v43, v22, v23
    v_cvt_pk_bf16_f32 v44, v24, v25
    v_cvt_pk_bf16_f32 v45, v26, v27
    v_cvt_pk_bf16_f32 v46, v28, v29
    v_cvt_pk_bf16_f32 v47, v30, v31
    buffer_store_dwordx4 v[32:35], v92, s[12:15], 0 offen nt
    v_add_u32 v92, 65536, v92
    buffer_store_dwordx4 v[36:39], v92, s[12:15], 0 offen nt
    v_add_u32 v92, 65536, v92
    buffer_store_dwordx4 v[40:43], v92, s[12:15], 0 offen nt
    v_add_u32 v92, 65536, v92
    buffer_store_dwordx4 v[44:47], v92, s[12:15], 0 offen nt
    s_branch K3_END
K3_AUX:
    s_mov_b32 s4, s60
    s_and_b32 s5, s61, 0xffff
    s_mov_b32 s6, 268435456
    s_mov_b32 s7, 0x00020000
    s_mov_b32 s8, s64
    s_and_b32 s9, s65, 0xffff
    s_mov_b32 s10, 2097152
    s_mov_b32 s11, 0x00020000
    s_mov_b32 s16, s68
    s_and_b32 s17, s69, 0xffff
    s_mov_b32 s18, 4194304
    s_mov_b32 s19, 0x00020000
    s_lshl_b32 s37, s43, 12
    s_lshl_b32 s38, s43, 11
    s_add_u32 s38, s38, 65536
    s_lshl_b32 s41, s35, 7
    s_lshl_b32 s42, s43, 5
    s_add_u32 s41, s41, s42
    v_lshrrev_b32 v92, 3, v90
    v_add_u32 v92, s41, v92
    v_lshlrev_b32 v92, 11, v92
    v_add_u32 v92, 25165824, v92
    v_lshrrev_b32 v93, 4, v90
    v_and_b32 v94, 7, v90
    v_add_u32 v95, 0, v93
    v_xor_b32 v95, v95, v94
    v_lshlrev_b32 v95, 4, v95
    v_add_u32 v95, v95, v92
    v_add_u32 v80, 0, v95
    v_add_u32 v95, 4, v93
    v_xor_b32 v95, v95, v94
    v_lshlrev_b32 v95, 4, v95
    v_add_u32 v95, v95, v92
    v_add_u32 v81, 16384, v95
    v_add_u32 v95, 0, v93
    v_xor_b32 v95, v95, v94
    v_lshlrev_b32 v95, 4, v95
    v_add_u32 v95, v95, v92
    v_add_u32 v82, 32768, v95
    v_add_u32 v95, 4, v93
    v_xor_b32 v95, v95, v94
    v_lshlrev_b32 v95, 4, v95
    v_add_u32 v95, v95, v92
    v_add_u32 v83, 49152, v95
    s_lshl_b32 s41, s43, 4
    v_lshrrev_b32 v92, 3, v90
    v_add_u32 v92, s41, v92
    v_lshlrev_b32 v92, 11, v92
    s_lshl_b32 s41, s36, 7
    v_add_u32 v92, s41, v92
    v_bfe_u32 v93, v90, 4, 2
    v_bfe_u32 v94, v90, 1, 2
    v_xor_b32 v95, v93, v94
    v_lshlrev_b32 v95, 1, v95
    v_and_b32 v96, 1, v90
    v_or_b32 v95, v95, v96
    v_lshlrev_b32 v95, 4, v95
    v_add_u32 v84, v95, v92
    v_add_u32 v85, 16384, v84
    s_mov_b32 s39, 0
    s_mov_b32 s40, 0
    s_add_u32 m0, s37, 0
    s_nop 0
    buffer_load_dwordx4 v80, s[4:7], s39 offen lds
    s_add_u32 m0, s37, 1024
    s_nop 0
    buffer_load_dwordx4 v81, s[4:7], s39 offen lds
    s_add_u32 m0, s37, 2048
    s_nop 0
    buffer_load_dwordx4 v82, s[4:7], s39 offen lds
    s_add_u32 m0, s37, 3072
    s_nop 0
    buffer_load_dwordx4 v83, s[4:7], s39 offen lds
    s_add_u32 m0, s38, 0
    s_nop 0
    buffer_load_dwordx4 v84, s[8:11], s40 offen lds
    s_add_u32 m0, s38, 1024
    s_nop 0
    buffer_load_dwordx4 v85, s[8:11], s40 offen lds
    s_add_u32 s39, s39, 128
    s_add_u32 s40, s40, 131072
    s_add_u32 m0, s37, 16384
    s_nop 0
    buffer_load_dwordx4 v80, s[4:7], s39 offen lds
    s_add_u32 m0, s37, 17408
    s_nop 0
    buffer_load_dwordx4 v81, s[4:7], s39 offen lds
    s_add_u32 m0, s37, 18432
    s_nop 0
    buffer_load_dwordx4 v82, s[4:7], s39 offen lds
    s_add_u32 m0, s37, 19456
    s_nop 0
    buffer_load_dwordx4 v83, s[4:7], s39 offen lds
    s_add_u32 m0, s38, 8192
    s_nop 0
    buffer_load_dwordx4 v84, s[8:11], s40 offen lds
    s_add_u32 m0, s38, 9216
    s_nop 0
    buffer_load_dwordx4 v85, s[8:11], s40 offen lds
    s_add_u32 s39, s39, 128
    s_add_u32 s40, s40, 131072
    s_add_u32 m0, s37, 32768
    s_nop 0
    buffer_load_dwordx4 v80, s[4:7], s39 offen lds
    s_add_u32 m0, s37, 33792
    s_nop 0
    buffer_load_dwordx4 v81, s[4:7], s39 offen lds
    s_add_u32 m0, s37, 34816
    s_nop 0
    buffer_load_dwordx4 v82, s[4:7], s39 offen lds
    s_add_u32 m0, s37, 35840
    s_nop 0
    buffer_load_dwordx4 v83, s[4:7], s39 offen lds
    s_add_u32 m0, s38, 16384
    s_nop 0
    buffer_load_dwordx4 v84, s[8:11], s40 offen lds
    s_add_u32 m0, s38, 17408
    s_nop 0
    buffer_load_dwordx4 v85, s[8:11], s40 offen lds
    s_add_u32 s39, s39, 128
    s_add_u32 s40, s40, 131072
    s_add_u32 m0, s37, 49152
    s_nop 0
    buffer_load_dwordx4 v80, s[4:7], s39 offen lds
    s_add_u32 m0, s37, 50176
    s_nop 0
    buffer_load_dwordx4 v81, s[4:7], s39 offen lds
    s_add_u32 m0, s37, 51200
    s_nop 0
    buffer_load_dwordx4 v82, s[4:7], s39 offen lds
    s_add_u32 m0, s37, 52224
    s_nop 0
    buffer_load_dwordx4 v83, s[4:7], s39 offen lds
    s_add_u32 m0, s38, 24576
    s_nop 0
    buffer_load_dwordx4 v84, s[8:11], s40 offen lds
    s_add_u32 m0, s38, 25600
    s_nop 0
    buffer_load_dwordx4 v85, s[8:11], s40 offen lds
    s_add_u32 s39, s39, 128
    s_add_u32 s40, s40, 131072
    s_waitcnt vmcnt(18)
    s_barrier
    s_waitcnt vmcnt(12)
    s_barrier
    s_add_u32 m0, s37, 0
    s_nop 0
    buffer_load_dwordx4 v80, s[4:7], s39 offen lds
    s_add_u32 m0, s37, 1024
    s_nop 0
    buffer_load_dwordx4 v81, s[4:7], s39 offen lds
    s_add_u32 m0, s37, 2048
    s_nop 0
    buffer_load_dwordx4 v82, s[4:7], s39 offen lds
    s_add_u32 m0, s37, 3072
    s_nop 0
    buffer_load_dwordx4 v83, s[4:7], s39 offen lds
    s_add_u32 m0, s38, 0
    s_nop 0
    buffer_load_dwordx4 v84, s[8:11], s40 offen lds
    s_add_u32 m0, s38, 1024
    s_nop 0
    buffer_load_dwordx4 v85, s[8:11], s40 offen lds
    s_add_u32 s39, s39, 128
    s_add_u32 s40, s40, 131072
    s_waitcnt vmcnt(12)
    s_barrier
    s_add_u32 m0, s37, 16384
    s_nop 0
    buffer_load_dwordx4 v80, s[4:7], s39 offen lds
    s_add_u32 m0, s37, 17408
    s_nop 0
    buffer_load_dwordx4 v81, s[4:7], s39 offen lds
    s_add_u32 m0, s37, 18432
    s_nop 0
    buffer_load_dwordx4 v82, s[4:7], s39 offen lds
    s_add_u32 m0, s37, 19456
    s_nop 0
    buffer_load_dwordx4 v83, s[4:7], s39 offen lds
    s_add_u32 m0, s38, 8192
    s_nop 0
    buffer_load_dwordx4 v84, s[8:11], s40 offen lds
    s_add_u32 m0, s38, 9216
    s_nop 0
    buffer_load_dwordx4 v85, s[8:11], s40 offen lds
    s_add_u32 s39, s39, 128
    s_add_u32 s40, s40, 131072
    s_waitcnt vmcnt(12)
    s_barrier
    s_add_u32 m0, s37, 32768
    s_nop 0
    buffer_load_dwordx4 v80, s[4:7], s39 offen lds
    s_add_u32 m0, s37, 33792
    s_nop 0
    buffer_load_dwordx4 v81, s[4:7], s39 offen lds
    s_add_u32 m0, s37, 34816
    s_nop 0
    buffer_load_dwordx4 v82, s[4:7], s39 offen lds
    s_add_u32 m0, s37, 35840
    s_nop 0
    buffer_load_dwordx4 v83, s[4:7], s39 offen lds
    s_add_u32 m0, s38, 16384
    s_nop 0
    buffer_load_dwordx4 v84, s[8:11], s40 offen lds
    s_add_u32 m0, s38, 17408
    s_nop 0
    buffer_load_dwordx4 v85, s[8:11], s40 offen lds
    s_add_u32 s39, s39, 128
    s_add_u32 s40, s40, 131072
    s_waitcnt vmcnt(12)
    s_barrier
    s_add_u32 m0, s37, 49152
    s_nop 0
    buffer_load_dwordx4 v80, s[4:7], s39 offen lds
    s_add_u32 m0, s37, 50176
    s_nop 0
    buffer_load_dwordx4 v81, s[4:7], s39 offen lds
    s_add_u32 m0, s37, 51200
    s_nop 0
    buffer_load_dwordx4 v82, s[4:7], s39 offen lds
    s_add_u32 m0, s37, 52224
    s_nop 0
    buffer_load_dwordx4 v83, s[4:7], s39 offen lds
    s_add_u32 m0, s38, 24576
    s_nop 0
    buffer_load_dwordx4 v84, s[8:11], s40 offen lds
    s_add_u32 m0, s38, 25600
    s_nop 0
    buffer_load_dwordx4 v85, s[8:11], s40 offen lds
    s_add_u32 s39, s39, 128
    s_add_u32 s40, s40, 131072
    s_waitcnt vmcnt(12)
    s_barrier
    s_add_u32 m0, s37, 0
    s_nop 0
    buffer_load_dwordx4 v80, s[4:7], s39 offen lds
    s_add_u32 m0, s37, 1024
    s_nop 0
    buffer_load_dwordx4 v81, s[4:7], s39 offen lds
    s_add_u32 m0, s37, 2048
    s_nop 0
    buffer_load_dwordx4 v82, s[4:7], s39 offen lds
    s_add_u32 m0, s37, 3072
    s_nop 0
    buffer_load_dwordx4 v83, s[4:7], s39 offen lds
    s_add_u32 m0, s38, 0
    s_nop 0
    buffer_load_dwordx4 v84, s[8:11], s40 offen lds
    s_add_u32 m0, s38, 1024
    s_nop 0
    buffer_load_dwordx4 v85, s[8:11], s40 offen lds
    s_add_u32 s39, s39, 128
    s_add_u32 s40, s40, 131072
    s_waitcnt vmcnt(12)
    s_barrier
    s_add_u32 m0, s37, 16384
    s_nop 0
    buffer_load_dwordx4 v80, s[4:7], s39 offen lds
    s_add_u32 m0, s37, 17408
    s_nop 0
    buffer_load_dwordx4 v81, s[4:7], s39 offen lds
    s_add_u32 m0, s37, 18432
    s_nop 0
    buffer_load_dwordx4 v82, s[4:7], s39 offen lds
    s_add_u32 m0, s37, 19456
    s_nop 0
    buffer_load_dwordx4 v83, s[4:7], s39 offen lds
    s_add_u32 m0, s38, 8192
    s_nop 0
    buffer_load_dwordx4 v84, s[8:11], s40 offen lds
    s_add_u32 m0, s38, 9216
    s_nop 0
    buffer_load_dwordx4 v85, s[8:11], s40 offen lds
    s_add_u32 s39, s39, 128
    s_add_u32 s40, s40, 131072
    s_waitcnt vmcnt(12)
    s_barrier
    s_add_u32 m0, s37, 32768
    s_nop 0
    buffer_load_dwordx4 v80, s[4:7], s39 offen lds
    s_add_u32 m0, s37, 33792
    s_nop 0
    buffer_load_dwordx4 v81, s[4:7], s39 offen lds
    s_add_u32 m0, s37, 34816
    s_nop 0
    buffer_load_dwordx4 v82, s[4:7], s39 offen lds
    s_add_u32 m0, s37, 35840
    s_nop 0
    buffer_load_dwordx4 v83, s[4:7], s39 offen lds
    s_add_u32 m0, s38, 16384
    s_nop 0
    buffer_load_dwordx4 v84, s[8:11], s40 offen lds
    s_add_u32 m0, s38, 17408
    s_nop 0
    buffer_load_dwordx4 v85, s[8:11], s40 offen lds
    s_add_u32 s39, s39, 128
    s_add_u32 s40, s40, 131072
    s_waitcnt vmcnt(12)
    s_barrier
    s_add_u32 m0, s37, 49152
    s_nop 0
    buffer_load_dwordx4 v80, s[4:7], s39 offen lds
    s_add_u32 m0, s37, 50176
    s_nop 0
    buffer_load_dwordx4 v81, s[4:7], s39 offen lds
    s_add_u32 m0, s37, 51200
    s_nop 0
    buffer_load_dwordx4 v82, s[4:7], s39 offen lds
    s_add_u32 m0, s37, 52224
    s_nop 0
    buffer_load_dwordx4 v83, s[4:7], s39 offen lds
    s_add_u32 m0, s38, 24576
    s_nop 0
    buffer_load_dwordx4 v84, s[8:11], s40 offen lds
    s_add_u32 m0, s38, 25600
    s_nop 0
    buffer_load_dwordx4 v85, s[8:11], s40 offen lds
    s_add_u32 s39, s39, 128
    s_add_u32 s40, s40, 131072
    s_waitcnt vmcnt(12)
    s_barrier
    s_add_u32 m0, s37, 0
    s_nop 0
    buffer_load_dwordx4 v80, s[4:7], s39 offen lds
    s_add_u32 m0, s37, 1024
    s_nop 0
    buffer_load_dwordx4 v81, s[4:7], s39 offen lds
    s_add_u32 m0, s37, 2048
    s_nop 0
    buffer_load_dwordx4 v82, s[4:7], s39 offen lds
    s_add_u32 m0, s37, 3072
    s_nop 0
    buffer_load_dwordx4 v83, s[4:7], s39 offen lds
    s_add_u32 m0, s38, 0
    s_nop 0
    buffer_load_dwordx4 v84, s[8:11], s40 offen lds
    s_add_u32 m0, s38, 1024
    s_nop 0
    buffer_load_dwordx4 v85, s[8:11], s40 offen lds
    s_add_u32 s39, s39, 128
    s_add_u32 s40, s40, 131072
    s_waitcnt vmcnt(12)
    s_barrier
    s_add_u32 m0, s37, 16384
    s_nop 0
    buffer_load_dwordx4 v80, s[4:7], s39 offen lds
    s_add_u32 m0, s37, 17408
    s_nop 0
    buffer_load_dwordx4 v81, s[4:7], s39 offen lds
    s_add_u32 m0, s37, 18432
    s_nop 0
    buffer_load_dwordx4 v82, s[4:7], s39 offen lds
    s_add_u32 m0, s37, 19456
    s_nop 0
    buffer_load_dwordx4 v83, s[4:7], s39 offen lds
    s_add_u32 m0, s38, 8192
    s_nop 0
    buffer_load_dwordx4 v84, s[8:11], s40 offen lds
    s_add_u32 m0, s38, 9216
    s_nop 0
    buffer_load_dwordx4 v85, s[8:11], s40 offen lds
    s_add_u32 s39, s39, 128
    s_add_u32 s40, s40, 131072
    s_waitcnt vmcnt(12)
    s_barrier
    s_add_u32 m0, s37, 32768
    s_nop 0
    buffer_load_dwordx4 v80, s[4:7], s39 offen lds
    s_add_u32 m0, s37, 33792
    s_nop 0
    buffer_load_dwordx4 v81, s[4:7], s39 offen lds
    s_add_u32 m0, s37, 34816
    s_nop 0
    buffer_load_dwordx4 v82, s[4:7], s39 offen lds
    s_add_u32 m0, s37, 35840
    s_nop 0
    buffer_load_dwordx4 v83, s[4:7], s39 offen lds
    s_add_u32 m0, s38, 16384
    s_nop 0
    buffer_load_dwordx4 v84, s[8:11], s40 offen lds
    s_add_u32 m0, s38, 17408
    s_nop 0
    buffer_load_dwordx4 v85, s[8:11], s40 offen lds
    s_add_u32 s39, s39, 128
    s_add_u32 s40, s40, 131072
    s_waitcnt vmcnt(12)
    s_barrier
    s_add_u32 m0, s37, 49152
    s_nop 0
    buffer_load_dwordx4 v80, s[4:7], s39 offen lds
    s_add_u32 m0, s37, 50176
    s_nop 0
    buffer_load_dwordx4 v81, s[4:7], s39 offen lds
    s_add_u32 m0, s37, 51200
    s_nop 0
    buffer_load_dwordx4 v82, s[4:7], s39 offen lds
    s_add_u32 m0, s37, 52224
    s_nop 0
    buffer_load_dwordx4 v83, s[4:7], s39 offen lds
    s_add_u32 m0, s38, 24576
    s_nop 0
    buffer_load_dwordx4 v84, s[8:11], s40 offen lds
    s_add_u32 m0, s38, 25600
    s_nop 0
    buffer_load_dwordx4 v85, s[8:11], s40 offen lds
    s_add_u32 s39, s39, 128
    s_add_u32 s40, s40, 131072
    s_waitcnt vmcnt(12)
    s_barrier
    s_waitcnt vmcnt(6)
    s_barrier
    s_waitcnt vmcnt(0)
    s_barrier
K3_END:
    s_endpgm
.section .rodata,"a"
.p2align 6
.amdhsa_kernel k1_kernel
  .amdhsa_next_free_vgpr 224
  .amdhsa_next_free_sgpr 100
  .amdhsa_accum_offset 224
  .amdhsa_group_segment_fixed_size 0
  .amdhsa_kernarg_size 104
  .amdhsa_user_sgpr_count 2
  .amdhsa_user_sgpr_kernarg_segment_ptr 1
  .amdhsa_system_sgpr_workgroup_id_x 1
.end_amdhsa_kernel
.p2align 6
.amdhsa_kernel k2_kernel
  .amdhsa_next_free_vgpr 256
  .amdhsa_next_free_sgpr 100
  .amdhsa_accum_offset 256
  .amdhsa_group_segment_fixed_size 0
  .amdhsa_kernarg_size 104
  .amdhsa_user_sgpr_count 2
  .amdhsa_user_sgpr_kernarg_segment_ptr 1
  .amdhsa_system_sgpr_workgroup_id_x 1
.end_amdhsa_kernel
.p2align 6
.amdhsa_kernel k3_kernel
  .amdhsa_next_free_vgpr 164
  .amdhsa_next_free_sgpr 100
  .amdhsa_accum_offset 164
  .amdhsa_group_segment_fixed_size 0
  .amdhsa_kernarg_size 104
  .amdhsa_user_sgpr_count 2
  .amdhsa_user_sgpr_kernarg_segment_ptr 1
  .amdhsa_system_sgpr_workgroup_id_x 1
.end_amdhsa_kernel
```
